```python
import torch

def _softmax(x, axis=-1):
    return torch.softmax(x, dim=axis)
def _gelu(x):
    return torch.nn.functional.gelu(x, approximate="tanh")
def _silu(x):
    return torch.nn.functional.silu(x)
def _sigmoid(x):
    return torch.sigmoid(x)
def _layernorm(x, axis=-1, eps=1e-5):
    m = x.mean(dim=axis, keepdim=True)
    v = x.var(dim=axis, keepdim=True, unbiased=False)
    return (x - m) / torch.sqrt(v + eps)
def _scatter_add(tgt, idx, src, axis=0):
    return tgt.clone().index_add_(axis, idx, src)
def _segment_sum(src, seg, n):
    out = torch.zeros((n,) + src.shape[1:], dtype=src.dtype)
    return out.index_add_(0, seg, src)
def _pad(x, pw):
    flat = tuple(v for pair in reversed(pw) for v in pair)
    return torch.nn.functional.pad(x, flat)

kernel_name = 'parallel_sum__linear_kernel_hedgehog__dense_activation_silu__prompt'

def setup_inputs():

    _w = (lambda a: (lambda t: t.to(torch.bfloat16) if t.is_floating_point() else t)(torch.as_tensor(a)))
    def _A_setup():
        B, S, D, H = 1, 2048, 512, 32
        Dh = D // H
        return {
            "x": _w((lambda *s: torch.randn(*s, dtype=torch.bfloat16) * 0.05)(B, S, D)),
            "wqkv": _w((lambda *s: torch.randn(*s, dtype=torch.bfloat16) * 0.2)(D, 3 * D)),
            "w_phi": _w((lambda *s: torch.randn(*s, dtype=torch.bfloat16) * 0.2)(H, Dh, Dh) * (Dh ** -0.5)),
            "wo": _w((lambda *s: torch.randn(*s, dtype=torch.bfloat16) * 0.05)(D, D)),
        }
    _A_in = _A_setup()

    def _B_setup():
        B, S, D, F = 1, 2048, 512, 1792
        return {
            "x": _w((lambda *s: torch.randn(*s, dtype=torch.bfloat16) * 0.05)(B, S, D)),
            "w1": _w((lambda *s: torch.randn(*s, dtype=torch.bfloat16) * 0.8)(D, F) * (D ** -0.5)),
            "w2": _w((lambda *s: torch.randn(*s, dtype=torch.bfloat16) * 0.1)(F, D) * (F ** -0.5)),
        }
    _B_in = _B_setup()

    return {
        "A_x": _A_in["x"],
        "A_wqkv": _A_in["wqkv"],
        "A_w_phi": _A_in["w_phi"],
        "A_wo": _A_in["wo"],
        "B_x": _B_in["x"],
        "B_w1": _B_in["w1"],
        "B_w2": _B_in["w2"],
    }

def reference(A_x, A_wqkv, A_w_phi, A_wo, B_x, B_w1, B_w2):
    def _A_ref(x, wqkv, w_phi, wo):
        B, S, D = x.shape
        H = 32; Dh = D // H
        qkv = (lambda x, *d: x.permute(*d))((x @ wqkv).reshape(B, S, 3, H, Dh), 2, 0, 3, 1, 4)
        q, k, v = qkv[0], qkv[1], qkv[2]
        pq = torch.einsum("bhsd,hdf->bhsf", q, w_phi)
        pk = torch.einsum("bhsd,hdf->bhsf", k, w_phi)
        phi_q = torch.concatenate([_softmax(pq, axis=-1), _softmax(-pq, axis=-1)], axis=-1)
        phi_k = torch.concatenate([_softmax(pk, axis=-1), _softmax(-pk, axis=-1)], axis=-1)
        kv = torch.einsum("bhsf,bhsd->bhfd", phi_k, v)
        z  = torch.einsum("bhsf->bhf", phi_k)
        num = torch.einsum("bhqf,bhfd->bhqd", phi_q, kv)
        den = torch.einsum("bhqf,bhf->bhq", phi_q, z)[..., None] + 1e-6
        o = num / den
        return (lambda x, *d: x.permute(*d))(o, 0, 2, 1, 3).reshape(B, S, D) @ wo

    def _B_ref(x, w1, w2):
        h = torch.einsum("bsd,df->bsf", x, w1)
        h = _silu(h)
        out = torch.einsum("bsf,fd->bsd", h, w2)
        return out

    x = A_x
    xn = _layernorm(x, axis=-1)
    return x + _A_ref(xn, A_wqkv, A_w_phi, A_wo) + _B_ref(xn, B_w1, B_w2)
```

```asm
; @launch grid=(256,1,1) block=(512,1,1) lds=163840
.amdgcn_target "amdgcn-amd-amdhsa--gfx950"
.text
.globl parallel_sum__linear_kernel_hedgehog__dense_activation_silu__prompt_kernel
.p2align 8
.type parallel_sum__linear_kernel_hedgehog__dense_activation_silu__prompt_kernel,@function
parallel_sum__linear_kernel_hedgehog__dense_activation_silu__prompt_kernel:
    s_cmp_ge_u32 s2, 256
    s_cbranch_scc1 k_end
    s_load_dwordx2 s[8:9], s[0:1], 0
    s_load_dwordx2 s[12:13], s[0:1], 8
    s_load_dwordx2 s[16:17], s[0:1], 40
    s_load_dwordx2 s[24:25], s[0:1], 16
    s_load_dwordx2 s[32:33], s[0:1], 24
    s_load_dwordx2 s[28:29], s[0:1], 48
    s_load_dwordx2 s[36:37], s[0:1], 56
    s_load_dwordx2 s[40:41], s[0:1], 64
    s_load_dwordx2 s[20:21], s[0:1], 72
    s_memrealtime s[100:101]
    s_setprio 3
    v_lshrrev_b32 v2, 6, v0
    v_and_b32 v1, 63, v0
    v_readfirstlane_b32 s44, v2
    s_and_b32 s52, s2, 7
    s_lshr_b32 s53, s2, 3
    s_and_b32 s47, s52, 1
    s_lshl_b32 s47, s47, 3
    s_and_b32 s54, s53, 7
    s_add_u32 s47, s47, s54
    s_lshr_b32 s53, s53, 3
    s_lshr_b32 s49, s53, 1
    s_and_b32 s53, s53, 1
    s_lshr_b32 s48, s52, 1
    s_lshl_b32 s48, s48, 1
    s_add_u32 s48, s48, s53
    s_and_b32 s45, s44, 3
    s_lshr_b32 s46, s44, 2
    s_getpc_b64 s[84:85]
    s_and_b32 s84, s84, 0xffffff00
    s_mov_b32 s86, k_code_end-parallel_sum__linear_kernel_hedgehog__dense_activation_silu__prompt_kernel
    s_mov_b32 s87, 0x00020000
    v_lshlrev_b32 v2, 7, v0
    s_cmp_eq_u32 s54, s44
    s_cbranch_scc0 k_nocpf
    buffer_load_dword v255, v2, s[84:87], 0 offen
k_nocpf:
    s_mov_b32 s58, 0x3fb8aa3b
    s_mov_b32 s60, 0xffff0000
    s_mov_b32 s61, 0xffff0000
    s_lshl_b32 s50, s44, 11
    s_mul_i32 s51, s44, 1792
    v_mov_b32 v2, 161792
    v_mov_b32 v4, 0
    v_mov_b32 v5, 0
    ds_write_b64 v2, v[4:5]
    s_mov_b32 s10, 2097152
    s_mov_b32 s11, 0x00020000
    s_mov_b32 s14, 1572864
    s_mov_b32 s15, 0x00020000
    s_mov_b32 s18, 1835008
    s_mov_b32 s19, 0x00020000
    s_mov_b32 s26, 16384
    s_mov_b32 s27, 0x00020000
    s_mov_b32 s34, 524288
    s_mov_b32 s35, 0x00020000
    s_mov_b32 s30, 1835008
    s_mov_b32 s31, 0x00020000
    s_mov_b32 s38, 2097152
    s_mov_b32 s39, 0x00020000
    s_mov_b32 s42, 256
    s_mov_b32 s43, 0x00020000
    s_mov_b32 s22, 16777216
    s_mov_b32 s23, 0x00020000
    s_mov_b32 s67, 0
    s_mov_b32 s64, 0xffffffff
    s_mov_b32 s65, 0x00ffffff
    s_and_b32 s52, s2, 7
    s_lshr_b32 s53, s2, 3
    s_lshl_b32 s68, s52, 2
    s_and_b32 s54, s53, 3
    s_add_u32 s68, s68, s54
    s_lshr_b32 s69, s53, 2
    s_mov_b32 s77, 0x358637bd
    s_mul_i32 s72, s44, 20480
    s_mul_i32 s59, s69, 0
    s_add_u32 s59, s59, s44
    s_and_b32 s59, s59, 7
    s_mul_i32 s53, s59, 14
    s_lshl_b32 s73, s53, 14
    s_lshr_b32 s78, s68, 1
    s_lshl_b32 s78, s78, 3
    s_add_u32 s78, s78, s59
    s_lshl_b32 s78, s78, 7
    s_add_u32 s78, s78, 15204352
    s_mov_b32 s3, 0
    s_mov_b32 s79, 0x40000000
    s_lshl_b32 s54, s54, 13
    s_add_u32 s98, s73, s54
    s_lshl_b32 s99, s59, 16
    s_add_u32 s99, s99, s54
p1_start:
    s_and_b32 s52, s48, 1
    s_lshl_b32 s53, s49, 1
    s_add_u32 s52, s52, s53
    s_lshl_b32 s52, s52, 1
    s_add_u32 s52, s52, s47
    s_and_b32 s52, s52, 4
    s_lshl_b32 s56, s52, 7
    s_lshl_b32 s57, s52, 6
    s_lshl_b32 s52, s46, 1
    s_sub_u32 s52, s45, s52
    s_and_b32 s52, s52, 3
    s_lshl_b32 s62, 1, s52
    s_lshl_b32 s52, s47, 7
    s_lshl_b32 s53, s44, 4
    s_add_u32 s52, s52, s53
    v_lshrrev_b32 v136, 3, v1
    v_add_u32 v136, s52, v136
    v_lshlrev_b32 v136, 10, v136
    v_and_b32 v137, 7, v1
    v_lshrrev_b32 v138, 4, v1
    v_xor_b32 v139, v137, v138
    v_lshl_add_u32 v2, v139, 4, v136
    v_xor_b32 v139, 4, v139
    v_lshl_add_u32 v3, v139, 4, v136
    v_add_u32 v3, 0x2000, v3
    v_cmp_le_u32 vcc, 28, v1
    s_nop 1
    v_cndmask_b32 v136, 0, 1, vcc
    v_mul_u32_u24 v137, 28, v136
    v_sub_u32 v137, v1, v137
    s_lshl_b32 s52, s44, 2
    v_add_u32 v136, s52, v136
    s_cmp_eq_u32 s49, 0
    s_cbranch_scc0 p1_typeB
    v_mul_u32_u24 v4, 3072, v136
    v_lshrrev_b32 v138, 3, v137
    v_lshl_add_u32 v4, v138, 10, v4
    v_and_b32 v138, 7, v137
    v_lshl_add_u32 v4, v138, 4, v4
    s_lshl_b32 s52, s48, 7
    v_add_u32 v4, s52, v4
    v_cmp_le_u32 vcc, 24, v137
    v_mov_b32 v138, 0x40000000
    s_nop 0
    v_cndmask_b32 v4, v4, v138, vcc
    s_lshl_b32 s52, s48, 2
    s_lshl_b32 s53, s46, 1
    s_add_u32 s54, s52, s53
    v_lshlrev_b32 v138, 2, v0
    s_waitcnt lgkmcnt(0)
    s_add_u32 m0, s50, 1024
    s_nop 0
    buffer_load_dwordx4 v2, s[8:11], s56 offen lds
    s_add_u32 m0, s50, 2048
    s_nop 0
    buffer_load_dwordx4 v3, s[8:11], s56 offen lds
    s_add_u32 s56, s56, 128
    s_and_b32 s56, s56, 1023
    s_mul_i32 s66, s57, 3072
    s_add_u32 m0, s51, 66560
    s_mov_b64 exec, s[64:65]
    buffer_load_dwordx4 v4, s[12:15], s66 offen lds
    s_add_u32 s66, s66, 6144
    s_add_u32 m0, s51, 67456
    s_nop 0
    buffer_load_dwordx4 v4, s[12:15], s66 offen lds
    s_mov_b64 exec, -1
    s_add_u32 s57, s57, 32
    s_and_b32 s57, s57, 511
    s_mul_i32 s66, s57, 3072
    s_add_u32 m0, s51, 80896
    s_mov_b64 exec, s[64:65]
    buffer_load_dwordx4 v4, s[12:15], s66 offen lds
    s_add_u32 s66, s66, 6144
    s_add_u32 m0, s51, 81792
    s_nop 0
    buffer_load_dwordx4 v4, s[12:15], s66 offen lds
    s_mov_b64 exec, -1
    s_add_u32 s57, s57, 32
    s_and_b32 s57, s57, 511
    s_setprio 2
    s_lshl_b32 s52, s45, 5
    v_and_b32 v19, 31, v1
    v_add_u32 v19, s52, v19
    v_bfe_u32 v20, v19, 1, 3
    v_lshrrev_b32 v21, 5, v1
    v_xor_b32 v20, v20, v21
    v_lshlrev_b32 v19, 7, v19
    v_xor_b32 v22, 0, v20
    v_lshl_add_u32 v5, v22, 4, v19
    v_xor_b32 v22, 2, v20
    v_lshl_add_u32 v6, v22, 4, v19
    v_xor_b32 v22, 4, v20
    v_lshl_add_u32 v7, v22, 4, v19
    v_xor_b32 v22, 6, v20
    v_lshl_add_u32 v8, v22, 4, v19
    v_lshrrev_b32 v19, 5, v1
    s_add_u32 m0, s50, 17408
    s_nop 0
    buffer_load_dwordx4 v2, s[8:11], s56 offen lds
    s_add_u32 m0, s50, 18432
    s_nop 0
    buffer_load_dwordx4 v3, s[8:11], s56 offen lds
    s_add_u32 s56, s56, 128
    s_and_b32 s56, s56, 1023
    v_lshlrev_b32 v19, 3, v19
    v_bfe_u32 v20, v1, 2, 2
    v_add_u32 v19, v19, v20
    v_mul_u32_u24 v19, 448, v19
    v_bfe_u32 v20, v1, 4, 1
    v_lshl_add_u32 v19, v20, 5, v19
    v_and_b32 v20, 3, v1
    v_lshl_add_u32 v13, v20, 3, v19
    v_and_b32 v253, 7, v1
    v_bfe_u32 v254, v1, 4, 1
    v_lshlrev_b32 v254, 2, v254
    v_xor_b32 v253, v253, v254
    v_lshlrev_b32 v253, 4, v253
    s_lshl_b32 s52, s69, 7
    v_add_u32 v253, s52, v253
    v_lshrrev_b32 v254, 3, v1
    s_mul_i32 s66, s57, 3072
    s_add_u32 m0, s51, 95232
    s_mov_b64 exec, s[64:65]
    buffer_load_dwordx4 v4, s[12:15], s66 offen lds
    s_add_u32 s66, s66, 6144
    s_add_u32 m0, s51, 96128
    s_nop 0
    buffer_load_dwordx4 v4, s[12:15], s66 offen lds
    s_mov_b64 exec, -1
    s_add_u32 s57, s57, 32
    s_and_b32 s57, s57, 511
    v_lshl_add_u32 v252, v254, 10, v253
    v_mov_b32 v15, 0
    v_mov_b32 v16, 0
    v_mov_b32 v17, 0
    v_mov_b32 v18, 0
    v_mov_b32 v168, 0
    v_mov_b32 v169, 0
    v_mov_b32 v170, 0
    v_mov_b32 v171, 0
    v_mov_b32 v172, 0
    v_mov_b32 v173, 0
    v_mov_b32 v174, 0
    v_mov_b32 v175, 0
    v_mov_b32 v176, 0
    v_mov_b32 v177, 0
    v_mov_b32 v178, 0
    s_mul_i32 s66, s57, 3072
    s_add_u32 m0, s51, 109568
    s_mov_b64 exec, s[64:65]
    buffer_load_dwordx4 v4, s[12:15], s66 offen lds
    s_add_u32 s66, s66, 6144
    s_add_u32 m0, s51, 110464
    s_nop 0
    buffer_load_dwordx4 v4, s[12:15], s66 offen lds
    s_mov_b64 exec, -1
    s_add_u32 s57, s57, 32
    s_and_b32 s57, s57, 511
    s_setprio 1
    v_mov_b32 v179, 0
    v_mov_b32 v180, 0
    v_mov_b32 v181, 0
    v_mov_b32 v182, 0
    v_mov_b32 v183, 0
    v_lshrrev_b32 v19, 4, v1
    v_xor_b32 v19, v19, v1
    v_and_b32 v19, 1, v19
    v_cmp_eq_u32 vcc, 0, v19
    v_mov_b32 v20, 0x3f803f80
    s_nop 0
    v_cndmask_b32 v248, 0, v20, vcc
    v_mov_b32 v249, v248
    v_mov_b32 v250, v248
    v_mov_b32 v251, v248
    v_add_u32 v13, 66560, v13
    v_add_u32 v14, 57344, v13
    s_setprio 0
    s_lshl_b32 s66, s44, 8
    s_add_u32 m0, s66, 152576
    s_lshl_b32 s66, s48, 11
    buffer_load_dword v138, s[24:27], s66 offen lds
    s_or_b32 s52, s47, s46
    s_cbranch_scc1 p1_nolead
    s_lshl_b32 s66, s48, 2
    s_lshl_b32 s52, 0x10000, s44
    v_mov_b32 v164, s52
    s_mov_b64 exec, 1
    buffer_atomic_or v164, off, s[40:43], s66 sc0 sc1
    s_mov_b64 exec, -1
    s_or_b32 s52, s44, s67
    s_cbranch_scc1 p1_nolead
    s_add_u32 s100, s100, 600
    s_addc_u32 s101, s101, 0
    s_bitset1_b32 s101, 31
    v_mov_b32 v160, s100
    v_mov_b32 v161, s101
    v_mov_b32 v162, 0
    v_mov_b32 v163, 0
    s_mov_b64 exec, 1
    buffer_atomic_cmpswap_x2 v[160:163], off, s[40:43], 0 offset:32 sc0 sc1
    s_mov_b64 exec, -1
p1_nolead:
    s_lshl_b32 s53, s46, 6
    v_add_u32 v13, s53, v13
    v_add_u32 v14, s53, v14
    s_mul_i32 s55, s46, 384
    s_cmp_eq_u32 s46, 0
    s_cbranch_scc0 p1_typeA1
    s_waitcnt vmcnt(7)
    s_barrier
    ds_read_b128 v[32:35], v5 offset:1024
    ds_read_b64_tr_b16 v[36:37], v13 offset:0
    ds_read_b64_tr_b16 v[38:39], v13 offset:1792
    ds_read_b64_tr_b16 v[40:41], v13 offset:128
    ds_read_b64_tr_b16 v[42:43], v13 offset:1920
    ds_read_b64_tr_b16 v[44:45], v13 offset:256
    ds_read_b64_tr_b16 v[46:47], v13 offset:2048
    ds_read_b128 v[52:55], v6 offset:1024
    ds_read_b64_tr_b16 v[56:57], v13 offset:7168
    ds_read_b64_tr_b16 v[58:59], v13 offset:8960
    ds_read_b64_tr_b16 v[60:61], v13 offset:7296
    ds_read_b64_tr_b16 v[62:63], v13 offset:9088
    ds_read_b64_tr_b16 v[64:65], v13 offset:7424
    ds_read_b64_tr_b16 v[66:67], v13 offset:9216
    s_waitcnt lgkmcnt(11)
    v_mfma_f32_32x32x16_bf16 v[72:87], v[36:39], v[32:35], 0
    s_add_u32 m0, s50, 33792
    s_nop 0
    buffer_load_dwordx4 v2, s[8:11], s56 offen lds
    s_add_u32 m0, s50, 34816
    s_nop 0
    buffer_load_dwordx4 v3, s[8:11], s56 offen lds
    s_add_u32 s56, s56, 128
    s_and_b32 s56, s56, 1023
    v_lshlrev_b32 v19, 16, v32
    v_and_b32 v20, 0xffff0000, v32
    v_add_f32 v15, v15, v19
    v_fmac_f32 v16, v19, v19
    s_waitcnt lgkmcnt(9)
    v_mfma_f32_32x32x16_bf16 v[88:103], v[40:43], v[32:35], 0
    s_mul_i32 s66, s57, 3072
    s_add_u32 m0, s51, 123904
    s_mov_b64 exec, s[64:65]
    buffer_load_dwordx4 v4, s[12:15], s66 offen lds
    s_add_u32 s66, s66, 6144
    s_add_u32 m0, s51, 124800
    s_nop 0
    buffer_load_dwordx4 v4, s[12:15], s66 offen lds
    s_mov_b64 exec, -1
    s_add_u32 s57, s57, 32
    s_and_b32 s57, s57, 511
    s_waitcnt lgkmcnt(7)
    v_mfma_f32_32x32x16_bf16 v[104:119], v[44:47], v[32:35], 0
    v_add_f32 v17, v17, v20
    v_fmac_f32 v18, v20, v20
    v_lshlrev_b32 v21, 16, v33
    v_and_b32 v22, 0xffff0000, v33
    v_add_f32 v15, v15, v21
    v_fmac_f32 v16, v21, v21
    v_add_f32 v17, v17, v22
    v_fmac_f32 v18, v22, v22
    s_cmp_eq_u32 s45, 0
    s_cbranch_scc0 p1_loopA0_p
    v_mfma_f32_16x16x32_bf16 v[168:171], v[36:39], v[248:251], v[168:171]
    v_mfma_f32_16x16x32_bf16 v[172:175], v[40:43], v[248:251], v[172:175]
    v_mfma_f32_16x16x32_bf16 v[176:179], v[44:47], v[248:251], v[176:179]
p1_loopA0_p:
    s_waitcnt lgkmcnt(4)
    v_mfma_f32_32x32x16_bf16 v[72:87], v[56:59], v[52:55], v[72:87]
    ds_read_b128 v[32:35], v7 offset:1024
    ds_read_b64_tr_b16 v[36:37], v13 offset:14336
    ds_read_b64_tr_b16 v[38:39], v13 offset:16128
    ds_read_b64_tr_b16 v[40:41], v13 offset:14464
    ds_read_b64_tr_b16 v[42:43], v13 offset:16256
    ds_read_b64_tr_b16 v[44:45], v13 offset:14592
    ds_read_b64_tr_b16 v[46:47], v13 offset:16384
    v_lshlrev_b32 v19, 16, v52
    v_and_b32 v20, 0xffff0000, v52
    v_add_f32 v15, v15, v19
    s_waitcnt lgkmcnt(9)
    v_mfma_f32_32x32x16_bf16 v[88:103], v[60:63], v[52:55], v[88:103]
    s_mul_i32 s66, s57, 3072
    s_add_u32 m0, s51, 138240
    s_mov_b64 exec, s[64:65]
    buffer_load_dwordx4 v4, s[12:15], s66 offen lds
    s_add_u32 s66, s66, 6144
    s_add_u32 m0, s51, 139136
    s_nop 0
    buffer_load_dwordx4 v4, s[12:15], s66 offen lds
    s_mov_b64 exec, -1
    s_add_u32 s57, s57, 32
    s_and_b32 s57, s57, 511
    s_waitcnt lgkmcnt(7)
    v_mfma_f32_32x32x16_bf16 v[104:119], v[64:67], v[52:55], v[104:119]
    v_fmac_f32 v16, v19, v19
    v_add_f32 v17, v17, v20
    v_fmac_f32 v18, v20, v20
    v_lshlrev_b32 v21, 16, v53
    v_and_b32 v22, 0xffff0000, v53
    v_add_f32 v15, v15, v21
    v_fmac_f32 v16, v21, v21
    v_add_f32 v17, v17, v22
    v_fmac_f32 v18, v22, v22
    s_cmp_eq_u32 s45, 1
    s_cbranch_scc0 p1_loopA0_a0
    v_mfma_f32_16x16x32_bf16 v[168:171], v[56:59], v[248:251], v[168:171]
    v_mfma_f32_16x16x32_bf16 v[172:175], v[60:63], v[248:251], v[172:175]
    v_mfma_f32_16x16x32_bf16 v[176:179], v[64:67], v[248:251], v[176:179]
p1_loopA0_a0:
    s_waitcnt lgkmcnt(4)
    v_mfma_f32_32x32x16_bf16 v[72:87], v[36:39], v[32:35], v[72:87]
    ds_read_b128 v[52:55], v8 offset:1024
    ds_read_b64_tr_b16 v[56:57], v13 offset:21504
    ds_read_b64_tr_b16 v[58:59], v13 offset:23296
    ds_read_b64_tr_b16 v[60:61], v13 offset:21632
    ds_read_b64_tr_b16 v[62:63], v13 offset:23424
    ds_read_b64_tr_b16 v[64:65], v13 offset:21760
    ds_read_b64_tr_b16 v[66:67], v13 offset:23552
    s_add_u32 m0, s50, 50176
    s_nop 0
    buffer_load_dwordx4 v2, s[8:11], s56 offen lds
    s_waitcnt lgkmcnt(9)
    v_mfma_f32_32x32x16_bf16 v[88:103], v[40:43], v[32:35], v[88:103]
    s_add_u32 m0, s50, 51200
    s_nop 0
    buffer_load_dwordx4 v3, s[8:11], s56 offen lds
    s_add_u32 s56, s56, 128
    s_and_b32 s56, s56, 1023
    v_lshlrev_b32 v19, 16, v32
    v_and_b32 v20, 0xffff0000, v32
    v_add_f32 v15, v15, v19
    v_fmac_f32 v16, v19, v19
    v_add_f32 v17, v17, v20
    s_waitcnt lgkmcnt(7)
    v_mfma_f32_32x32x16_bf16 v[104:119], v[44:47], v[32:35], v[104:119]
    v_fmac_f32 v18, v20, v20
    v_lshlrev_b32 v21, 16, v33
    v_and_b32 v22, 0xffff0000, v33
    v_add_f32 v15, v15, v21
    v_fmac_f32 v16, v21, v21
    v_add_f32 v17, v17, v22
    v_fmac_f32 v18, v22, v22
    s_cmp_eq_u32 s45, 2
    s_cbranch_scc0 p1_loopA0_b0
    v_mfma_f32_16x16x32_bf16 v[168:171], v[36:39], v[248:251], v[168:171]
    v_mfma_f32_16x16x32_bf16 v[172:175], v[40:43], v[248:251], v[172:175]
    v_mfma_f32_16x16x32_bf16 v[176:179], v[44:47], v[248:251], v[176:179]
p1_loopA0_b0:
    s_waitcnt vmcnt(9) lgkmcnt(0)
    s_barrier
    v_mfma_f32_32x32x16_bf16 v[72:87], v[56:59], v[52:55], v[72:87]
    ds_read_b128 v[32:35], v5 offset:17408
    ds_read_b64_tr_b16 v[36:37], v13 offset:28672
    ds_read_b64_tr_b16 v[38:39], v13 offset:30464
    ds_read_b64_tr_b16 v[40:41], v13 offset:28800
    ds_read_b64_tr_b16 v[42:43], v13 offset:30592
    ds_read_b64_tr_b16 v[44:45], v13 offset:28928
    ds_read_b64_tr_b16 v[46:47], v13 offset:30720
    s_add_u32 m0, s50, 1024
    s_nop 0
    buffer_load_dwordx4 v2, s[8:11], s56 offen lds
    v_mfma_f32_32x32x16_bf16 v[88:103], v[60:63], v[52:55], v[88:103]
    s_add_u32 m0, s50, 2048
    s_nop 0
    buffer_load_dwordx4 v3, s[8:11], s56 offen lds
    s_add_u32 s56, s56, 128
    s_and_b32 s56, s56, 1023
    v_lshlrev_b32 v19, 16, v52
    v_and_b32 v20, 0xffff0000, v52
    v_add_f32 v15, v15, v19
    v_fmac_f32 v16, v19, v19
    v_add_f32 v17, v17, v20
    v_mfma_f32_32x32x16_bf16 v[104:119], v[64:67], v[52:55], v[104:119]
    v_fmac_f32 v18, v20, v20
    v_lshlrev_b32 v21, 16, v53
    v_and_b32 v22, 0xffff0000, v53
    v_add_f32 v15, v15, v21
    v_fmac_f32 v16, v21, v21
    v_add_f32 v17, v17, v22
    v_fmac_f32 v18, v22, v22
    s_cmp_eq_u32 s45, 3
    s_cbranch_scc0 p1_loopA0_a1
    v_mfma_f32_16x16x32_bf16 v[168:171], v[56:59], v[248:251], v[168:171]
    v_mfma_f32_16x16x32_bf16 v[172:175], v[60:63], v[248:251], v[172:175]
    v_mfma_f32_16x16x32_bf16 v[176:179], v[64:67], v[248:251], v[176:179]
p1_loopA0_a1:
    s_waitcnt lgkmcnt(4)
    v_mfma_f32_32x32x16_bf16 v[72:87], v[36:39], v[32:35], v[72:87]
    ds_read_b128 v[52:55], v6 offset:17408
    ds_read_b64_tr_b16 v[56:57], v13 offset:35840
    ds_read_b64_tr_b16 v[58:59], v13 offset:37632
    ds_read_b64_tr_b16 v[60:61], v13 offset:35968
    ds_read_b64_tr_b16 v[62:63], v13 offset:37760
    ds_read_b64_tr_b16 v[64:65], v13 offset:36096
    ds_read_b64_tr_b16 v[66:67], v13 offset:37888
    v_lshlrev_b32 v19, 16, v32
    v_and_b32 v20, 0xffff0000, v32
    v_add_f32 v15, v15, v19
    s_waitcnt lgkmcnt(9)
    v_mfma_f32_32x32x16_bf16 v[88:103], v[40:43], v[32:35], v[88:103]
    s_mul_i32 s66, s57, 3072
    s_add_u32 m0, s51, 66560
    s_mov_b64 exec, s[64:65]
    buffer_load_dwordx4 v4, s[12:15], s66 offen lds
    s_add_u32 s66, s66, 6144
    s_add_u32 m0, s51, 67456
    s_nop 0
    buffer_load_dwordx4 v4, s[12:15], s66 offen lds
    s_mov_b64 exec, -1
    s_add_u32 s57, s57, 32
    s_and_b32 s57, s57, 511
    s_waitcnt lgkmcnt(7)
    v_mfma_f32_32x32x16_bf16 v[104:119], v[44:47], v[32:35], v[104:119]
    v_fmac_f32 v16, v19, v19
    v_add_f32 v17, v17, v20
    v_fmac_f32 v18, v20, v20
    v_lshlrev_b32 v21, 16, v33
    v_and_b32 v22, 0xffff0000, v33
    v_add_f32 v15, v15, v21
    v_fmac_f32 v16, v21, v21
    v_add_f32 v17, v17, v22
    v_fmac_f32 v18, v22, v22
    s_cmp_eq_u32 s45, 0
    s_cbranch_scc0 p1_loopA0_b1
    v_mfma_f32_16x16x32_bf16 v[168:171], v[36:39], v[248:251], v[168:171]
    v_mfma_f32_16x16x32_bf16 v[172:175], v[40:43], v[248:251], v[172:175]
    v_mfma_f32_16x16x32_bf16 v[176:179], v[44:47], v[248:251], v[176:179]
p1_loopA0_b1:
    s_waitcnt lgkmcnt(4)
    v_mfma_f32_32x32x16_bf16 v[72:87], v[56:59], v[52:55], v[72:87]
    ds_read_b128 v[32:35], v7 offset:17408
    ds_read_b64_tr_b16 v[36:37], v13 offset:43008
    ds_read_b64_tr_b16 v[38:39], v13 offset:44800
    ds_read_b64_tr_b16 v[40:41], v13 offset:43136
    ds_read_b64_tr_b16 v[42:43], v13 offset:44928
    ds_read_b64_tr_b16 v[44:45], v13 offset:43264
    ds_read_b64_tr_b16 v[46:47], v13 offset:45056
    v_lshlrev_b32 v19, 16, v52
    v_and_b32 v20, 0xffff0000, v52
    v_add_f32 v15, v15, v19
    s_waitcnt lgkmcnt(9)
    v_mfma_f32_32x32x16_bf16 v[88:103], v[60:63], v[52:55], v[88:103]
    s_mul_i32 s66, s57, 3072
    s_add_u32 m0, s51, 80896
    s_mov_b64 exec, s[64:65]
    buffer_load_dwordx4 v4, s[12:15], s66 offen lds
    s_add_u32 s66, s66, 6144
    s_add_u32 m0, s51, 81792
    s_nop 0
    buffer_load_dwordx4 v4, s[12:15], s66 offen lds
    s_mov_b64 exec, -1
    s_add_u32 s57, s57, 32
    s_and_b32 s57, s57, 511
    s_waitcnt lgkmcnt(7)
    v_mfma_f32_32x32x16_bf16 v[104:119], v[64:67], v[52:55], v[104:119]
    v_fmac_f32 v16, v19, v19
    v_add_f32 v17, v17, v20
    v_fmac_f32 v18, v20, v20
    v_lshlrev_b32 v21, 16, v53
    v_and_b32 v22, 0xffff0000, v53
    v_add_f32 v15, v15, v21
    v_fmac_f32 v16, v21, v21
    v_add_f32 v17, v17, v22
    v_fmac_f32 v18, v22, v22
    s_cmp_eq_u32 s45, 1
    s_cbranch_scc0 p1_loopA0_a2
    v_mfma_f32_16x16x32_bf16 v[168:171], v[56:59], v[248:251], v[168:171]
    v_mfma_f32_16x16x32_bf16 v[172:175], v[60:63], v[248:251], v[172:175]
    v_mfma_f32_16x16x32_bf16 v[176:179], v[64:67], v[248:251], v[176:179]
p1_loopA0_a2:
    s_waitcnt lgkmcnt(4)
    v_mfma_f32_32x32x16_bf16 v[72:87], v[36:39], v[32:35], v[72:87]
    ds_read_b128 v[52:55], v8 offset:17408
    ds_read_b64_tr_b16 v[56:57], v13 offset:50176
    ds_read_b64_tr_b16 v[58:59], v13 offset:51968
    ds_read_b64_tr_b16 v[60:61], v13 offset:50304
    ds_read_b64_tr_b16 v[62:63], v13 offset:52096
    ds_read_b64_tr_b16 v[64:65], v13 offset:50432
    ds_read_b64_tr_b16 v[66:67], v13 offset:52224
    s_waitcnt lgkmcnt(9)
    v_mfma_f32_32x32x16_bf16 v[88:103], v[40:43], v[32:35], v[88:103]
    v_lshlrev_b32 v19, 16, v32
    v_and_b32 v20, 0xffff0000, v32
    v_add_f32 v15, v15, v19
    v_fmac_f32 v16, v19, v19
    v_add_f32 v17, v17, v20
    v_fmac_f32 v18, v20, v20
    v_lshlrev_b32 v21, 16, v33
    s_waitcnt lgkmcnt(7)
    v_mfma_f32_32x32x16_bf16 v[104:119], v[44:47], v[32:35], v[104:119]
    v_and_b32 v22, 0xffff0000, v33
    v_add_f32 v15, v15, v21
    v_fmac_f32 v16, v21, v21
    v_add_f32 v17, v17, v22
    v_fmac_f32 v18, v22, v22
    s_cmp_eq_u32 s45, 2
    s_cbranch_scc0 p1_loopA0_b2
    v_mfma_f32_16x16x32_bf16 v[168:171], v[36:39], v[248:251], v[168:171]
    v_mfma_f32_16x16x32_bf16 v[172:175], v[40:43], v[248:251], v[172:175]
    v_mfma_f32_16x16x32_bf16 v[176:179], v[44:47], v[248:251], v[176:179]
p1_loopA0_b2:
    s_waitcnt vmcnt(8) lgkmcnt(0)
    s_barrier
    v_mfma_f32_32x32x16_bf16 v[72:87], v[56:59], v[52:55], v[72:87]
    ds_read_b128 v[32:35], v5 offset:33792
    ds_read_b64_tr_b16 v[36:37], v14 offset:0
    ds_read_b64_tr_b16 v[38:39], v14 offset:1792
    ds_read_b64_tr_b16 v[40:41], v14 offset:128
    ds_read_b64_tr_b16 v[42:43], v14 offset:1920
    ds_read_b64_tr_b16 v[44:45], v14 offset:256
    ds_read_b64_tr_b16 v[46:47], v14 offset:2048
    s_add_u32 m0, s50, 17408
    s_nop 0
    buffer_load_dwordx4 v2, s[8:11], s56 offen lds
    v_mfma_f32_32x32x16_bf16 v[88:103], v[60:63], v[52:55], v[88:103]
    s_add_u32 m0, s50, 18432
    s_nop 0
    buffer_load_dwordx4 v3, s[8:11], s56 offen lds
    s_add_u32 s56, s56, 128
    s_and_b32 s56, s56, 1023
    v_lshlrev_b32 v19, 16, v52
    v_and_b32 v20, 0xffff0000, v52
    v_add_f32 v15, v15, v19
    v_fmac_f32 v16, v19, v19
    v_add_f32 v17, v17, v20
    v_mfma_f32_32x32x16_bf16 v[104:119], v[64:67], v[52:55], v[104:119]
    v_fmac_f32 v18, v20, v20
    v_lshlrev_b32 v21, 16, v53
    v_and_b32 v22, 0xffff0000, v53
    v_add_f32 v15, v15, v21
    v_fmac_f32 v16, v21, v21
    v_add_f32 v17, v17, v22
    v_fmac_f32 v18, v22, v22
    s_cmp_eq_u32 s45, 3
    s_cbranch_scc0 p1_loopA0_a3
    v_mfma_f32_16x16x32_bf16 v[168:171], v[56:59], v[248:251], v[168:171]
    v_mfma_f32_16x16x32_bf16 v[172:175], v[60:63], v[248:251], v[172:175]
    v_mfma_f32_16x16x32_bf16 v[176:179], v[64:67], v[248:251], v[176:179]
p1_loopA0_a3:
    s_waitcnt lgkmcnt(4)
    v_mfma_f32_32x32x16_bf16 v[72:87], v[36:39], v[32:35], v[72:87]
    ds_read_b128 v[52:55], v6 offset:33792
    ds_read_b64_tr_b16 v[56:57], v14 offset:7168
    ds_read_b64_tr_b16 v[58:59], v14 offset:8960
    ds_read_b64_tr_b16 v[60:61], v14 offset:7296
    ds_read_b64_tr_b16 v[62:63], v14 offset:9088
    ds_read_b64_tr_b16 v[64:65], v14 offset:7424
    ds_read_b64_tr_b16 v[66:67], v14 offset:9216
    s_mul_i32 s66, s57, 3072
    s_add_u32 m0, s51, 95232
    s_mov_b64 exec, s[64:65]
    buffer_load_dwordx4 v4, s[12:15], s66 offen lds
    s_add_u32 s66, s66, 6144
    s_add_u32 m0, s51, 96128
    s_nop 0
    buffer_load_dwordx4 v4, s[12:15], s66 offen lds
    s_mov_b64 exec, -1
    s_add_u32 s57, s57, 32
    s_and_b32 s57, s57, 511
    v_lshlrev_b32 v19, 16, v32
    v_and_b32 v20, 0xffff0000, v32
    v_add_f32 v15, v15, v19
    v_fmac_f32 v16, v19, v19
    v_add_f32 v17, v17, v20
    v_fmac_f32 v18, v20, v20
    v_lshlrev_b32 v21, 16, v33
    v_and_b32 v22, 0xffff0000, v33
    s_waitcnt lgkmcnt(9)
    v_mfma_f32_32x32x16_bf16 v[88:103], v[40:43], v[32:35], v[88:103]
    s_cmp_eq_u32 s47, 0
    s_cbranch_scc0 p1_nozero
    s_or_b32 s52, s44, s67
    s_cbranch_scc1 p1_nonrp
    v_readfirstlane_b32 s52, v160
    v_readfirstlane_b32 s53, v161
    s_nop 0
    s_cmp_eq_u32 s53, 0
    s_cselect_b32 s52, s100, s52
    s_cselect_b32 s53, s101, s53
    v_mov_b32 v160, s52
    v_mov_b32 v161, s53
    v_mov_b32 v165, 161792
    ds_write_b64 v165, v[160:161] offset:16
    v_lshlrev_b32 v165, 7, v1
    s_mov_b32 s52, 15319040
    buffer_store_dwordx2 v[160:161], v165, s[20:23], s52 offen sc0 sc1
p1_nonrp:
    v_readfirstlane_b32 s52, v164
    s_add_u32 s53, s44, 16
    s_bitcmp1_b32 s52, s53
    s_cbranch_scc1 p1_nozero
    s_mov_b32 s3, 1
    s_lshl_b32 s52, s48, 2
    s_add_u32 s52, s52, s44
    s_mul_i32 s52, s52, 2176
    s_add_u32 s52, s52, 14680064
    v_lshlrev_b32 v165, 3, v1
    v_mov_b32 v120, 0
    v_mov_b32 v121, 0
    v_mov_b32 v122, 0
    v_mov_b32 v123, 0
    v_mov_b32 v124, 0
    v_mov_b32 v125, 0
    v_mov_b32 v126, 0
    v_mov_b32 v127, 0
    v_mov_b32 v128, 0
    v_mov_b32 v129, 0
    buffer_atomic_swap_x2 v[120:121], v165, s[20:23], s52 offen offset:0 sc0 sc1
    buffer_atomic_swap_x2 v[122:123], v165, s[20:23], s52 offen offset:512 sc0 sc1
    buffer_atomic_swap_x2 v[124:125], v165, s[20:23], s52 offen offset:1024 sc0 sc1
    buffer_atomic_swap_x2 v[126:127], v165, s[20:23], s52 offen offset:1536 sc0 sc1
    s_mov_b64 exec, 0xffff
    buffer_atomic_swap_x2 v[128:129], v165, s[20:23], s52 offen offset:2048 sc0 sc1
    s_mov_b64 exec, -1
p1_nozero:
    s_waitcnt lgkmcnt(7)
    v_mfma_f32_32x32x16_bf16 v[104:119], v[44:47], v[32:35], v[104:119]
    v_add_f32 v15, v15, v21
    v_fmac_f32 v16, v21, v21
    v_add_f32 v17, v17, v22
    v_fmac_f32 v18, v22, v22
    s_cmp_eq_u32 s45, 0
    s_cbranch_scc0 p1_loopA0_b3
    v_mfma_f32_16x16x32_bf16 v[168:171], v[36:39], v[248:251], v[168:171]
    v_mfma_f32_16x16x32_bf16 v[172:175], v[40:43], v[248:251], v[172:175]
    v_mfma_f32_16x16x32_bf16 v[176:179], v[44:47], v[248:251], v[176:179]
p1_loopA0_b3:
    s_waitcnt lgkmcnt(4)
    v_mfma_f32_32x32x16_bf16 v[72:87], v[56:59], v[52:55], v[72:87]
    ds_read_b128 v[32:35], v7 offset:33792
    ds_read_b64_tr_b16 v[36:37], v14 offset:14336
    ds_read_b64_tr_b16 v[38:39], v14 offset:16128
    ds_read_b64_tr_b16 v[40:41], v14 offset:14464
    ds_read_b64_tr_b16 v[42:43], v14 offset:16256
    ds_read_b64_tr_b16 v[44:45], v14 offset:14592
    ds_read_b64_tr_b16 v[46:47], v14 offset:16384
    v_lshlrev_b32 v19, 16, v52
    v_and_b32 v20, 0xffff0000, v52
    v_add_f32 v15, v15, v19
    s_waitcnt lgkmcnt(9)
    v_mfma_f32_32x32x16_bf16 v[88:103], v[60:63], v[52:55], v[88:103]
    s_mul_i32 s66, s57, 3072
    s_add_u32 m0, s51, 109568
    s_mov_b64 exec, s[64:65]
    buffer_load_dwordx4 v4, s[12:15], s66 offen lds
    s_add_u32 s66, s66, 6144
    s_add_u32 m0, s51, 110464
    s_nop 0
    buffer_load_dwordx4 v4, s[12:15], s66 offen lds
    s_mov_b64 exec, -1
    s_add_u32 s57, s57, 32
    s_and_b32 s57, s57, 511
    s_waitcnt lgkmcnt(7)
    v_mfma_f32_32x32x16_bf16 v[104:119], v[64:67], v[52:55], v[104:119]
    v_fmac_f32 v16, v19, v19
    v_add_f32 v17, v17, v20
    v_fmac_f32 v18, v20, v20
    v_lshlrev_b32 v21, 16, v53
    v_and_b32 v22, 0xffff0000, v53
    v_add_f32 v15, v15, v21
    v_fmac_f32 v16, v21, v21
    v_add_f32 v17, v17, v22
    v_fmac_f32 v18, v22, v22
    s_cmp_eq_u32 s45, 1
    s_cbranch_scc0 p1_loopA0_a4
    v_mfma_f32_16x16x32_bf16 v[168:171], v[56:59], v[248:251], v[168:171]
    v_mfma_f32_16x16x32_bf16 v[172:175], v[60:63], v[248:251], v[172:175]
    v_mfma_f32_16x16x32_bf16 v[176:179], v[64:67], v[248:251], v[176:179]
p1_loopA0_a4:
    s_waitcnt lgkmcnt(4)
    v_mfma_f32_32x32x16_bf16 v[72:87], v[36:39], v[32:35], v[72:87]
    ds_read_b128 v[52:55], v8 offset:33792
    ds_read_b64_tr_b16 v[56:57], v14 offset:21504
    ds_read_b64_tr_b16 v[58:59], v14 offset:23296
    ds_read_b64_tr_b16 v[60:61], v14 offset:21632
    ds_read_b64_tr_b16 v[62:63], v14 offset:23424
    ds_read_b64_tr_b16 v[64:65], v14 offset:21760
    ds_read_b64_tr_b16 v[66:67], v14 offset:23552
    s_waitcnt lgkmcnt(9)
    v_mfma_f32_32x32x16_bf16 v[88:103], v[40:43], v[32:35], v[88:103]
    v_lshlrev_b32 v19, 16, v32
    v_and_b32 v20, 0xffff0000, v32
    v_add_f32 v15, v15, v19
    v_fmac_f32 v16, v19, v19
    v_add_f32 v17, v17, v20
    v_fmac_f32 v18, v20, v20
    v_lshlrev_b32 v21, 16, v33
    s_waitcnt lgkmcnt(7)
    v_mfma_f32_32x32x16_bf16 v[104:119], v[44:47], v[32:35], v[104:119]
    v_and_b32 v22, 0xffff0000, v33
    v_add_f32 v15, v15, v21
    v_fmac_f32 v16, v21, v21
    v_add_f32 v17, v17, v22
    v_fmac_f32 v18, v22, v22
    s_cmp_eq_u32 s45, 2
    s_cbranch_scc0 p1_loopA0_b4
    v_mfma_f32_16x16x32_bf16 v[168:171], v[36:39], v[248:251], v[168:171]
    v_mfma_f32_16x16x32_bf16 v[172:175], v[40:43], v[248:251], v[172:175]
    v_mfma_f32_16x16x32_bf16 v[176:179], v[44:47], v[248:251], v[176:179]
p1_loopA0_b4:
    s_waitcnt vmcnt(6) lgkmcnt(0)
    s_barrier
    v_mfma_f32_32x32x16_bf16 v[72:87], v[56:59], v[52:55], v[72:87]
    ds_read_b128 v[32:35], v5 offset:50176
    ds_read_b64_tr_b16 v[36:37], v13 offset:0
    ds_read_b64_tr_b16 v[38:39], v13 offset:1792
    ds_read_b64_tr_b16 v[40:41], v13 offset:128
    ds_read_b64_tr_b16 v[42:43], v13 offset:1920
    ds_read_b64_tr_b16 v[44:45], v13 offset:256
    ds_read_b64_tr_b16 v[46:47], v13 offset:2048
    s_add_u32 m0, s50, 33792
    s_nop 0
    buffer_load_dwordx4 v2, s[8:11], s56 offen lds
    v_mfma_f32_32x32x16_bf16 v[88:103], v[60:63], v[52:55], v[88:103]
    s_add_u32 m0, s50, 34816
    s_nop 0
    buffer_load_dwordx4 v3, s[8:11], s56 offen lds
    s_add_u32 s56, s56, 128
    s_and_b32 s56, s56, 1023
    v_lshlrev_b32 v19, 16, v52
    v_and_b32 v20, 0xffff0000, v52
    v_add_f32 v15, v15, v19
    v_fmac_f32 v16, v19, v19
    v_add_f32 v17, v17, v20
    v_mfma_f32_32x32x16_bf16 v[104:119], v[64:67], v[52:55], v[104:119]
    v_fmac_f32 v18, v20, v20
    v_lshlrev_b32 v21, 16, v53
    v_and_b32 v22, 0xffff0000, v53
    v_add_f32 v15, v15, v21
    v_fmac_f32 v16, v21, v21
    v_add_f32 v17, v17, v22
    v_fmac_f32 v18, v22, v22
    s_cmp_eq_u32 s45, 3
    s_cbranch_scc0 p1_loopA0_a5
    v_mfma_f32_16x16x32_bf16 v[168:171], v[56:59], v[248:251], v[168:171]
    v_mfma_f32_16x16x32_bf16 v[172:175], v[60:63], v[248:251], v[172:175]
    v_mfma_f32_16x16x32_bf16 v[176:179], v[64:67], v[248:251], v[176:179]
p1_loopA0_a5:
    s_waitcnt lgkmcnt(4)
    v_mfma_f32_32x32x16_bf16 v[72:87], v[36:39], v[32:35], v[72:87]
    ds_read_b128 v[52:55], v6 offset:50176
    ds_read_b64_tr_b16 v[56:57], v13 offset:7168
    ds_read_b64_tr_b16 v[58:59], v13 offset:8960
    ds_read_b64_tr_b16 v[60:61], v13 offset:7296
    ds_read_b64_tr_b16 v[62:63], v13 offset:9088
    ds_read_b64_tr_b16 v[64:65], v13 offset:7424
    ds_read_b64_tr_b16 v[66:67], v13 offset:9216
    v_lshlrev_b32 v19, 16, v32
    v_and_b32 v20, 0xffff0000, v32
    v_add_f32 v15, v15, v19
    v_fmac_f32 v16, v19, v19
    v_add_f32 v17, v17, v20
    s_waitcnt lgkmcnt(9)
    v_mfma_f32_32x32x16_bf16 v[88:103], v[40:43], v[32:35], v[88:103]
    s_mul_i32 s66, s57, 3072
    s_add_u32 m0, s51, 123904
    s_mov_b64 exec, s[64:65]
    buffer_load_dwordx4 v4, s[12:15], s66 offen lds
    s_add_u32 s66, s66, 6144
    s_add_u32 m0, s51, 124800
    s_nop 0
    buffer_load_dwordx4 v4, s[12:15], s66 offen lds
    s_mov_b64 exec, -1
    s_add_u32 s57, s57, 32
    s_and_b32 s57, s57, 511
    v_fmac_f32 v18, v20, v20
    v_lshlrev_b32 v21, 16, v33
    s_waitcnt lgkmcnt(7)
    v_mfma_f32_32x32x16_bf16 v[104:119], v[44:47], v[32:35], v[104:119]
    s_cmp_eq_u32 s3, 1
    s_cbranch_scc0 p1_nozn
    v_mov_b32 v165, 161792
    ds_read_b64 v[160:161], v165 offset:16
p1_nozn:
    v_and_b32 v22, 0xffff0000, v33
    v_add_f32 v15, v15, v21
    v_fmac_f32 v16, v21, v21
    v_add_f32 v17, v17, v22
    v_fmac_f32 v18, v22, v22
    s_cmp_eq_u32 s45, 0
    s_cbranch_scc0 p1_loopA0_b5
    v_mfma_f32_16x16x32_bf16 v[168:171], v[36:39], v[248:251], v[168:171]
    v_mfma_f32_16x16x32_bf16 v[172:175], v[40:43], v[248:251], v[172:175]
    v_mfma_f32_16x16x32_bf16 v[176:179], v[44:47], v[248:251], v[176:179]
p1_loopA0_b5:
    s_waitcnt lgkmcnt(4)
    v_mfma_f32_32x32x16_bf16 v[72:87], v[56:59], v[52:55], v[72:87]
    ds_read_b128 v[32:35], v7 offset:50176
    ds_read_b64_tr_b16 v[36:37], v13 offset:14336
    ds_read_b64_tr_b16 v[38:39], v13 offset:16128
    ds_read_b64_tr_b16 v[40:41], v13 offset:14464
    ds_read_b64_tr_b16 v[42:43], v13 offset:16256
    ds_read_b64_tr_b16 v[44:45], v13 offset:14592
    ds_read_b64_tr_b16 v[46:47], v13 offset:16384
    v_lshlrev_b32 v19, 16, v52
    v_and_b32 v20, 0xffff0000, v52
    v_add_f32 v15, v15, v19
    s_waitcnt lgkmcnt(9)
    v_mfma_f32_32x32x16_bf16 v[88:103], v[60:63], v[52:55], v[88:103]
    s_mul_i32 s66, s57, 3072
    s_add_u32 m0, s51, 138240
    s_mov_b64 exec, s[64:65]
    buffer_load_dwordx4 v4, s[12:15], s66 offen lds
    s_add_u32 s66, s66, 6144
    s_add_u32 m0, s51, 139136
    s_nop 0
    buffer_load_dwordx4 v4, s[12:15], s66 offen lds
    s_mov_b64 exec, -1
    s_add_u32 s57, s57, 32
    s_and_b32 s57, s57, 511
    s_waitcnt lgkmcnt(7)
    v_mfma_f32_32x32x16_bf16 v[104:119], v[64:67], v[52:55], v[104:119]
    v_fmac_f32 v16, v19, v19
    v_add_f32 v17, v17, v20
    v_fmac_f32 v18, v20, v20
    v_lshlrev_b32 v21, 16, v53
    v_and_b32 v22, 0xffff0000, v53
    v_add_f32 v15, v15, v21
    v_fmac_f32 v16, v21, v21
    v_add_f32 v17, v17, v22
    v_fmac_f32 v18, v22, v22
    s_cmp_eq_u32 s45, 1
    s_cbranch_scc0 p1_loopA0_a6
    v_mfma_f32_16x16x32_bf16 v[168:171], v[56:59], v[248:251], v[168:171]
    v_mfma_f32_16x16x32_bf16 v[172:175], v[60:63], v[248:251], v[172:175]
    v_mfma_f32_16x16x32_bf16 v[176:179], v[64:67], v[248:251], v[176:179]
p1_loopA0_a6:
    s_waitcnt lgkmcnt(4)
    v_mfma_f32_32x32x16_bf16 v[72:87], v[36:39], v[32:35], v[72:87]
    ds_read_b128 v[52:55], v8 offset:50176
    ds_read_b64_tr_b16 v[56:57], v13 offset:21504
    ds_read_b64_tr_b16 v[58:59], v13 offset:23296
    ds_read_b64_tr_b16 v[60:61], v13 offset:21632
    ds_read_b64_tr_b16 v[62:63], v13 offset:23424
    ds_read_b64_tr_b16 v[64:65], v13 offset:21760
    ds_read_b64_tr_b16 v[66:67], v13 offset:23552
    s_waitcnt lgkmcnt(9)
    v_mfma_f32_32x32x16_bf16 v[88:103], v[40:43], v[32:35], v[88:103]
    v_lshlrev_b32 v19, 16, v32
    v_and_b32 v20, 0xffff0000, v32
    v_add_f32 v15, v15, v19
    v_fmac_f32 v16, v19, v19
    v_add_f32 v17, v17, v20
    v_fmac_f32 v18, v20, v20
    v_lshlrev_b32 v21, 16, v33
    s_waitcnt lgkmcnt(7)
    v_mfma_f32_32x32x16_bf16 v[104:119], v[44:47], v[32:35], v[104:119]
    v_and_b32 v22, 0xffff0000, v33
    v_add_f32 v15, v15, v21
    v_fmac_f32 v16, v21, v21
    v_add_f32 v17, v17, v22
    v_fmac_f32 v18, v22, v22
    s_cmp_eq_u32 s45, 2
    s_cbranch_scc0 p1_loopA0_b6
    v_mfma_f32_16x16x32_bf16 v[168:171], v[36:39], v[248:251], v[168:171]
    v_mfma_f32_16x16x32_bf16 v[172:175], v[40:43], v[248:251], v[172:175]
    v_mfma_f32_16x16x32_bf16 v[176:179], v[44:47], v[248:251], v[176:179]
p1_loopA0_b6:
    s_waitcnt vmcnt(6) lgkmcnt(0)
    s_barrier
    v_mfma_f32_32x32x16_bf16 v[72:87], v[56:59], v[52:55], v[72:87]
    ds_read_b128 v[32:35], v5 offset:1024
    ds_read_b64_tr_b16 v[36:37], v13 offset:28672
    ds_read_b64_tr_b16 v[38:39], v13 offset:30464
    ds_read_b64_tr_b16 v[40:41], v13 offset:28800
    ds_read_b64_tr_b16 v[42:43], v13 offset:30592
    ds_read_b64_tr_b16 v[44:45], v13 offset:28928
    ds_read_b64_tr_b16 v[46:47], v13 offset:30720
    s_add_u32 m0, s50, 50176
    s_nop 0
    buffer_load_dwordx4 v2, s[8:11], s56 offen lds
    v_mfma_f32_32x32x16_bf16 v[88:103], v[60:63], v[52:55], v[88:103]
    s_add_u32 m0, s50, 51200
    s_nop 0
    buffer_load_dwordx4 v3, s[8:11], s56 offen lds
    s_add_u32 s56, s56, 128
    s_and_b32 s56, s56, 1023
    v_lshlrev_b32 v19, 16, v52
    v_and_b32 v20, 0xffff0000, v52
    v_add_f32 v15, v15, v19
    v_fmac_f32 v16, v19, v19
    v_add_f32 v17, v17, v20
    v_mfma_f32_32x32x16_bf16 v[104:119], v[64:67], v[52:55], v[104:119]
    v_fmac_f32 v18, v20, v20
    v_lshlrev_b32 v21, 16, v53
    v_and_b32 v22, 0xffff0000, v53
    v_add_f32 v15, v15, v21
    v_fmac_f32 v16, v21, v21
    v_add_f32 v17, v17, v22
    v_fmac_f32 v18, v22, v22
    s_cmp_eq_u32 s45, 3
    s_cbranch_scc0 p1_loopA0_a7
    v_mfma_f32_16x16x32_bf16 v[168:171], v[56:59], v[248:251], v[168:171]
    v_mfma_f32_16x16x32_bf16 v[172:175], v[60:63], v[248:251], v[172:175]
    v_mfma_f32_16x16x32_bf16 v[176:179], v[64:67], v[248:251], v[176:179]
p1_loopA0_a7:
    s_waitcnt lgkmcnt(4)
    v_mfma_f32_32x32x16_bf16 v[72:87], v[36:39], v[32:35], v[72:87]
    ds_read_b128 v[52:55], v6 offset:1024
    ds_read_b64_tr_b16 v[56:57], v13 offset:35840
    ds_read_b64_tr_b16 v[58:59], v13 offset:37632
    ds_read_b64_tr_b16 v[60:61], v13 offset:35968
    ds_read_b64_tr_b16 v[62:63], v13 offset:37760
    ds_read_b64_tr_b16 v[64:65], v13 offset:36096
    ds_read_b64_tr_b16 v[66:67], v13 offset:37888
    v_lshlrev_b32 v19, 16, v32
    v_and_b32 v20, 0xffff0000, v32
    v_add_f32 v15, v15, v19
    v_fmac_f32 v16, v19, v19
    v_add_f32 v17, v17, v20
    v_fmac_f32 v18, v20, v20
    v_lshlrev_b32 v21, 16, v33
    s_waitcnt lgkmcnt(9)
    v_mfma_f32_32x32x16_bf16 v[88:103], v[40:43], v[32:35], v[88:103]
    s_mul_i32 s66, s57, 3072
    s_add_u32 m0, s51, 66560
    s_mov_b64 exec, s[64:65]
    buffer_load_dwordx4 v4, s[12:15], s66 offen lds
    s_add_u32 s66, s66, 6144
    s_add_u32 m0, s51, 67456
    s_nop 0
    buffer_load_dwordx4 v4, s[12:15], s66 offen lds
    s_mov_b64 exec, -1
    s_add_u32 s57, s57, 32
    s_and_b32 s57, s57, 511
    v_and_b32 v22, 0xffff0000, v33
    v_add_f32 v15, v15, v21
    v_fmac_f32 v16, v21, v21
    v_add_f32 v17, v17, v22
    s_waitcnt lgkmcnt(7)
    v_mfma_f32_32x32x16_bf16 v[104:119], v[44:47], v[32:35], v[104:119]
    s_cmp_eq_u32 s3, 1
    s_cbranch_scc0 p1_nozd
    s_lshl_b32 s52, s48, 2
    s_add_u32 s52, s52, s44
    s_lshl_b32 s52, s52, 11
    s_add_u32 s52, s52, 15253504
    v_lshlrev_b32 v165, 7, v1
    s_mov_b64 exec, 0xffff
    buffer_store_dwordx2 v[160:161], v165, s[20:23], s52 offen sc0 sc1
    s_mov_b64 exec, -1
p1_nozd:
    v_fmac_f32 v18, v22, v22
    s_cmp_eq_u32 s45, 0
    s_cbranch_scc0 p1_loopA0_b7
    v_mfma_f32_16x16x32_bf16 v[168:171], v[36:39], v[248:251], v[168:171]
    v_mfma_f32_16x16x32_bf16 v[172:175], v[40:43], v[248:251], v[172:175]
    v_mfma_f32_16x16x32_bf16 v[176:179], v[44:47], v[248:251], v[176:179]
p1_loopA0_b7:
    s_waitcnt lgkmcnt(4)
    v_mfma_f32_32x32x16_bf16 v[72:87], v[56:59], v[52:55], v[72:87]
    ds_read_b128 v[32:35], v7 offset:1024
    ds_read_b64_tr_b16 v[36:37], v13 offset:43008
    ds_read_b64_tr_b16 v[38:39], v13 offset:44800
    ds_read_b64_tr_b16 v[40:41], v13 offset:43136
    ds_read_b64_tr_b16 v[42:43], v13 offset:44928
    ds_read_b64_tr_b16 v[44:45], v13 offset:43264
    ds_read_b64_tr_b16 v[46:47], v13 offset:45056
    v_lshlrev_b32 v19, 16, v52
    v_and_b32 v20, 0xffff0000, v52
    v_add_f32 v15, v15, v19
    s_waitcnt lgkmcnt(9)
    v_mfma_f32_32x32x16_bf16 v[88:103], v[60:63], v[52:55], v[88:103]
    s_mul_i32 s66, s57, 3072
    s_add_u32 m0, s51, 80896
    s_mov_b64 exec, s[64:65]
    buffer_load_dwordx4 v4, s[12:15], s66 offen lds
    s_add_u32 s66, s66, 6144
    s_add_u32 m0, s51, 81792
    s_nop 0
    buffer_load_dwordx4 v4, s[12:15], s66 offen lds
    s_mov_b64 exec, -1
    s_add_u32 s57, s57, 32
    s_and_b32 s57, s57, 511
    s_waitcnt lgkmcnt(7)
    v_mfma_f32_32x32x16_bf16 v[104:119], v[64:67], v[52:55], v[104:119]
    v_fmac_f32 v16, v19, v19
    v_add_f32 v17, v17, v20
    v_fmac_f32 v18, v20, v20
    v_lshlrev_b32 v21, 16, v53
    v_and_b32 v22, 0xffff0000, v53
    v_add_f32 v15, v15, v21
    v_fmac_f32 v16, v21, v21
    v_add_f32 v17, v17, v22
    v_fmac_f32 v18, v22, v22
    s_cmp_eq_u32 s45, 1
    s_cbranch_scc0 p1_loopA0_a8
    v_mfma_f32_16x16x32_bf16 v[168:171], v[56:59], v[248:251], v[168:171]
    v_mfma_f32_16x16x32_bf16 v[172:175], v[60:63], v[248:251], v[172:175]
    v_mfma_f32_16x16x32_bf16 v[176:179], v[64:67], v[248:251], v[176:179]
p1_loopA0_a8:
    s_waitcnt lgkmcnt(4)
    v_mfma_f32_32x32x16_bf16 v[72:87], v[36:39], v[32:35], v[72:87]
    ds_read_b128 v[52:55], v8 offset:1024
    ds_read_b64_tr_b16 v[56:57], v13 offset:50176
    ds_read_b64_tr_b16 v[58:59], v13 offset:51968
    ds_read_b64_tr_b16 v[60:61], v13 offset:50304
    ds_read_b64_tr_b16 v[62:63], v13 offset:52096
    ds_read_b64_tr_b16 v[64:65], v13 offset:50432
    ds_read_b64_tr_b16 v[66:67], v13 offset:52224
    v_lshlrev_b32 v19, 16, v32
    s_waitcnt lgkmcnt(9)
    v_mfma_f32_32x32x16_bf16 v[88:103], v[40:43], v[32:35], v[88:103]
    s_add_u32 s66, s98, 0
    buffer_load_dwordx2 v[10:11], v252, s[28:31], s66 offen
    s_add_u32 s66, s98, 32768
    buffer_load_dwordx2 v[10:11], v252, s[28:31], s66 offen
    v_and_b32 v20, 0xffff0000, v32
    v_add_f32 v15, v15, v19
    v_fmac_f32 v16, v19, v19
    v_add_f32 v17, v17, v20
    s_waitcnt lgkmcnt(7)
    v_mfma_f32_32x32x16_bf16 v[104:119], v[44:47], v[32:35], v[104:119]
    v_fmac_f32 v18, v20, v20
    v_lshlrev_b32 v21, 16, v33
    v_and_b32 v22, 0xffff0000, v33
    v_add_f32 v15, v15, v21
    v_fmac_f32 v16, v21, v21
    v_add_f32 v17, v17, v22
    v_fmac_f32 v18, v22, v22
    s_cmp_eq_u32 s45, 2
    s_cbranch_scc0 p1_loopA0_b8
    v_mfma_f32_16x16x32_bf16 v[168:171], v[36:39], v[248:251], v[168:171]
    v_mfma_f32_16x16x32_bf16 v[172:175], v[40:43], v[248:251], v[172:175]
    v_mfma_f32_16x16x32_bf16 v[176:179], v[44:47], v[248:251], v[176:179]
p1_loopA0_b8:
    s_waitcnt vmcnt(8) lgkmcnt(0)
    s_barrier
    v_mfma_f32_32x32x16_bf16 v[72:87], v[56:59], v[52:55], v[72:87]
    ds_read_b128 v[32:35], v5 offset:17408
    ds_read_b64_tr_b16 v[36:37], v14 offset:0
    ds_read_b64_tr_b16 v[38:39], v14 offset:1792
    ds_read_b64_tr_b16 v[40:41], v14 offset:128
    ds_read_b64_tr_b16 v[42:43], v14 offset:1920
    ds_read_b64_tr_b16 v[44:45], v14 offset:256
    ds_read_b64_tr_b16 v[46:47], v14 offset:2048
    v_mfma_f32_32x32x16_bf16 v[88:103], v[60:63], v[52:55], v[88:103]
    v_lshlrev_b32 v19, 16, v52
    v_and_b32 v20, 0xffff0000, v52
    v_add_f32 v15, v15, v19
    v_fmac_f32 v16, v19, v19
    v_add_f32 v17, v17, v20
    v_fmac_f32 v18, v20, v20
    v_lshlrev_b32 v21, 16, v53
    v_mfma_f32_32x32x16_bf16 v[104:119], v[64:67], v[52:55], v[104:119]
    v_and_b32 v22, 0xffff0000, v53
    v_add_f32 v15, v15, v21
    v_fmac_f32 v16, v21, v21
    v_add_f32 v17, v17, v22
    v_fmac_f32 v18, v22, v22
    s_cmp_eq_u32 s45, 3
    s_cbranch_scc0 p1_loopA0_a9
    v_mfma_f32_16x16x32_bf16 v[168:171], v[56:59], v[248:251], v[168:171]
    v_mfma_f32_16x16x32_bf16 v[172:175], v[60:63], v[248:251], v[172:175]
    v_mfma_f32_16x16x32_bf16 v[176:179], v[64:67], v[248:251], v[176:179]
p1_loopA0_a9:
    s_or_b32 s52, s44, s67
    s_cmp_eq_u32 s52, 0
    s_cbranch_scc0 k_nonon0
    s_cmp_eq_u32 s47, 0
    s_cbranch_scc1 k_nonon0
    s_and_b32 s52, s2, 63
    s_lshl_b32 s52, s52, 7
    s_add_u32 s52, s52, 15319040
    s_mov_b64 exec, 1
    buffer_load_dwordx2 v[160:161], off, s[20:23], s52 sc0 sc1
    s_mov_b64 exec, -1
k_nonon0:
    s_waitcnt lgkmcnt(4)
    v_mfma_f32_32x32x16_bf16 v[72:87], v[36:39], v[32:35], v[72:87]
    ds_read_b128 v[52:55], v6 offset:17408
    ds_read_b64_tr_b16 v[56:57], v14 offset:7168
    ds_read_b64_tr_b16 v[58:59], v14 offset:8960
    ds_read_b64_tr_b16 v[60:61], v14 offset:7296
    ds_read_b64_tr_b16 v[62:63], v14 offset:9088
    ds_read_b64_tr_b16 v[64:65], v14 offset:7424
    ds_read_b64_tr_b16 v[66:67], v14 offset:9216
    v_lshlrev_b32 v19, 16, v32
    v_and_b32 v20, 0xffff0000, v32
    v_add_f32 v15, v15, v19
    v_fmac_f32 v16, v19, v19
    s_waitcnt lgkmcnt(9)
    v_mfma_f32_32x32x16_bf16 v[88:103], v[40:43], v[32:35], v[88:103]
    s_mul_i32 s66, s57, 3072
    s_add_u32 m0, s51, 95232
    s_mov_b64 exec, s[64:65]
    buffer_load_dwordx4 v4, s[12:15], s66 offen lds
    s_add_u32 s66, s66, 6144
    s_add_u32 m0, s51, 96128
    s_nop 0
    buffer_load_dwordx4 v4, s[12:15], s66 offen lds
    s_mov_b64 exec, -1
    s_add_u32 s57, s57, 32
    s_and_b32 s57, s57, 511
    v_add_f32 v17, v17, v20
    s_waitcnt lgkmcnt(7)
    v_mfma_f32_32x32x16_bf16 v[104:119], v[44:47], v[32:35], v[104:119]
    s_add_u32 s66, s98, 65536
    buffer_load_dwordx2 v[10:11], v252, s[28:31], s66 offen
    s_add_u32 s66, s98, 98304
    buffer_load_dwordx2 v[10:11], v252, s[28:31], s66 offen
    v_fmac_f32 v18, v20, v20
    v_lshlrev_b32 v21, 16, v33
    v_and_b32 v22, 0xffff0000, v33
    v_add_f32 v15, v15, v21
    v_fmac_f32 v16, v21, v21
    v_add_f32 v17, v17, v22
    v_fmac_f32 v18, v22, v22
    s_cmp_eq_u32 s45, 0
    s_cbranch_scc0 p1_loopA0_b9
    v_mfma_f32_16x16x32_bf16 v[168:171], v[36:39], v[248:251], v[168:171]
    v_mfma_f32_16x16x32_bf16 v[172:175], v[40:43], v[248:251], v[172:175]
    v_mfma_f32_16x16x32_bf16 v[176:179], v[44:47], v[248:251], v[176:179]
p1_loopA0_b9:
    s_waitcnt lgkmcnt(4)
    v_mfma_f32_32x32x16_bf16 v[72:87], v[56:59], v[52:55], v[72:87]
    ds_read_b128 v[32:35], v7 offset:17408
    ds_read_b64_tr_b16 v[36:37], v14 offset:14336
    ds_read_b64_tr_b16 v[38:39], v14 offset:16128
    ds_read_b64_tr_b16 v[40:41], v14 offset:14464
    ds_read_b64_tr_b16 v[42:43], v14 offset:16256
    ds_read_b64_tr_b16 v[44:45], v14 offset:14592
    ds_read_b64_tr_b16 v[46:47], v14 offset:16384
    v_lshlrev_b32 v19, 16, v52
    v_and_b32 v20, 0xffff0000, v52
    v_add_f32 v15, v15, v19
    s_waitcnt lgkmcnt(9)
    v_mfma_f32_32x32x16_bf16 v[88:103], v[60:63], v[52:55], v[88:103]
    s_mul_i32 s66, s57, 3072
    s_add_u32 m0, s51, 109568
    s_mov_b64 exec, s[64:65]
    buffer_load_dwordx4 v4, s[12:15], s66 offen lds
    s_add_u32 s66, s66, 6144
    s_add_u32 m0, s51, 110464
    s_nop 0
    buffer_load_dwordx4 v4, s[12:15], s66 offen lds
    s_mov_b64 exec, -1
    s_add_u32 s57, s57, 32
    s_and_b32 s57, s57, 511
    s_waitcnt lgkmcnt(7)
    v_mfma_f32_32x32x16_bf16 v[104:119], v[64:67], v[52:55], v[104:119]
    v_fmac_f32 v16, v19, v19
    v_add_f32 v17, v17, v20
    v_fmac_f32 v18, v20, v20
    v_lshlrev_b32 v21, 16, v53
    v_and_b32 v22, 0xffff0000, v53
    v_add_f32 v15, v15, v21
    v_fmac_f32 v16, v21, v21
    v_add_f32 v17, v17, v22
    v_fmac_f32 v18, v22, v22
    s_cmp_eq_u32 s45, 1
    s_cbranch_scc0 p1_loopA0_a10
    v_mfma_f32_16x16x32_bf16 v[168:171], v[56:59], v[248:251], v[168:171]
    v_mfma_f32_16x16x32_bf16 v[172:175], v[60:63], v[248:251], v[172:175]
    v_mfma_f32_16x16x32_bf16 v[176:179], v[64:67], v[248:251], v[176:179]
p1_loopA0_a10:
    s_waitcnt lgkmcnt(4)
    v_mfma_f32_32x32x16_bf16 v[72:87], v[36:39], v[32:35], v[72:87]
    ds_read_b128 v[52:55], v8 offset:17408
    ds_read_b64_tr_b16 v[56:57], v14 offset:21504
    ds_read_b64_tr_b16 v[58:59], v14 offset:23296
    ds_read_b64_tr_b16 v[60:61], v14 offset:21632
    ds_read_b64_tr_b16 v[62:63], v14 offset:23424
    ds_read_b64_tr_b16 v[64:65], v14 offset:21760
    ds_read_b64_tr_b16 v[66:67], v14 offset:23552
    v_lshlrev_b32 v19, 16, v32
    s_waitcnt lgkmcnt(9)
    v_mfma_f32_32x32x16_bf16 v[88:103], v[40:43], v[32:35], v[88:103]
    s_add_u32 s66, s98, 131072
    buffer_load_dwordx2 v[10:11], v252, s[28:31], s66 offen
    s_add_u32 s66, s98, 163840
    buffer_load_dwordx2 v[10:11], v252, s[28:31], s66 offen
    v_and_b32 v20, 0xffff0000, v32
    v_add_f32 v15, v15, v19
    v_fmac_f32 v16, v19, v19
    v_add_f32 v17, v17, v20
    s_waitcnt lgkmcnt(7)
    v_mfma_f32_32x32x16_bf16 v[104:119], v[44:47], v[32:35], v[104:119]
    v_fmac_f32 v18, v20, v20
    v_lshlrev_b32 v21, 16, v33
    v_and_b32 v22, 0xffff0000, v33
    v_add_f32 v15, v15, v21
    v_fmac_f32 v16, v21, v21
    v_add_f32 v17, v17, v22
    v_fmac_f32 v18, v22, v22
    s_cmp_eq_u32 s45, 2
    s_cbranch_scc0 p1_loopA0_b10
    v_mfma_f32_16x16x32_bf16 v[168:171], v[36:39], v[248:251], v[168:171]
    v_mfma_f32_16x16x32_bf16 v[172:175], v[40:43], v[248:251], v[172:175]
    v_mfma_f32_16x16x32_bf16 v[176:179], v[44:47], v[248:251], v[176:179]
p1_loopA0_b10:
    s_waitcnt vmcnt(10) lgkmcnt(0)
    s_barrier
    v_mfma_f32_32x32x16_bf16 v[72:87], v[56:59], v[52:55], v[72:87]
    ds_read_b128 v[32:35], v5 offset:33792
    ds_read_b64_tr_b16 v[36:37], v13 offset:0
    ds_read_b64_tr_b16 v[38:39], v13 offset:1792
    ds_read_b64_tr_b16 v[40:41], v13 offset:128
    ds_read_b64_tr_b16 v[42:43], v13 offset:1920
    ds_read_b64_tr_b16 v[44:45], v13 offset:256
    ds_read_b64_tr_b16 v[46:47], v13 offset:2048
    v_mfma_f32_32x32x16_bf16 v[88:103], v[60:63], v[52:55], v[88:103]
    v_lshlrev_b32 v19, 16, v52
    v_and_b32 v20, 0xffff0000, v52
    v_add_f32 v15, v15, v19
    v_fmac_f32 v16, v19, v19
    v_add_f32 v17, v17, v20
    v_fmac_f32 v18, v20, v20
    v_lshlrev_b32 v21, 16, v53
    v_mfma_f32_32x32x16_bf16 v[104:119], v[64:67], v[52:55], v[104:119]
    v_and_b32 v22, 0xffff0000, v53
    v_add_f32 v15, v15, v21
    v_fmac_f32 v16, v21, v21
    v_add_f32 v17, v17, v22
    v_fmac_f32 v18, v22, v22
    s_cmp_eq_u32 s45, 3
    s_cbranch_scc0 p1_loopA0_a11
    v_mfma_f32_16x16x32_bf16 v[168:171], v[56:59], v[248:251], v[168:171]
    v_mfma_f32_16x16x32_bf16 v[172:175], v[60:63], v[248:251], v[172:175]
    v_mfma_f32_16x16x32_bf16 v[176:179], v[64:67], v[248:251], v[176:179]
p1_loopA0_a11:
    s_waitcnt lgkmcnt(4)
    v_mfma_f32_32x32x16_bf16 v[72:87], v[36:39], v[32:35], v[72:87]
    ds_read_b128 v[52:55], v6 offset:33792
    ds_read_b64_tr_b16 v[56:57], v13 offset:7168
    ds_read_b64_tr_b16 v[58:59], v13 offset:8960
    ds_read_b64_tr_b16 v[60:61], v13 offset:7296
    ds_read_b64_tr_b16 v[62:63], v13 offset:9088
    ds_read_b64_tr_b16 v[64:65], v13 offset:7424
    ds_read_b64_tr_b16 v[66:67], v13 offset:9216
    v_lshlrev_b32 v19, 16, v32
    s_waitcnt lgkmcnt(9)
    v_mfma_f32_32x32x16_bf16 v[88:103], v[40:43], v[32:35], v[88:103]
    s_add_u32 s66, s98, 196608
    buffer_load_dwordx2 v[10:11], v252, s[28:31], s66 offen
    s_add_u32 s66, s99, 0
    buffer_load_dwordx2 v[10:11], v252, s[32:35], s66 offen
    v_and_b32 v20, 0xffff0000, v32
    v_add_f32 v15, v15, v19
    v_fmac_f32 v16, v19, v19
    v_add_f32 v17, v17, v20
    s_waitcnt lgkmcnt(7)
    v_mfma_f32_32x32x16_bf16 v[104:119], v[44:47], v[32:35], v[104:119]
    v_fmac_f32 v18, v20, v20
    v_lshlrev_b32 v21, 16, v33
    v_and_b32 v22, 0xffff0000, v33
    v_add_f32 v15, v15, v21
    v_fmac_f32 v16, v21, v21
    v_add_f32 v17, v17, v22
    v_fmac_f32 v18, v22, v22
    s_cmp_eq_u32 s45, 0
    s_cbranch_scc0 p1_loopA0_b11
    v_mfma_f32_16x16x32_bf16 v[168:171], v[36:39], v[248:251], v[168:171]
    v_mfma_f32_16x16x32_bf16 v[172:175], v[40:43], v[248:251], v[172:175]
    v_mfma_f32_16x16x32_bf16 v[176:179], v[44:47], v[248:251], v[176:179]
p1_loopA0_b11:
    s_waitcnt lgkmcnt(4)
    v_mfma_f32_32x32x16_bf16 v[72:87], v[56:59], v[52:55], v[72:87]
    ds_read_b128 v[32:35], v7 offset:33792
    ds_read_b64_tr_b16 v[36:37], v13 offset:14336
    ds_read_b64_tr_b16 v[38:39], v13 offset:16128
    ds_read_b64_tr_b16 v[40:41], v13 offset:14464
    ds_read_b64_tr_b16 v[42:43], v13 offset:16256
    ds_read_b64_tr_b16 v[44:45], v13 offset:14592
    ds_read_b64_tr_b16 v[46:47], v13 offset:16384
    s_waitcnt lgkmcnt(9)
    v_mfma_f32_32x32x16_bf16 v[88:103], v[60:63], v[52:55], v[88:103]
    v_lshlrev_b32 v19, 16, v52
    v_and_b32 v20, 0xffff0000, v52
    v_add_f32 v15, v15, v19
    v_fmac_f32 v16, v19, v19
    v_add_f32 v17, v17, v20
    v_fmac_f32 v18, v20, v20
    v_lshlrev_b32 v21, 16, v53
    s_waitcnt lgkmcnt(7)
    v_mfma_f32_32x32x16_bf16 v[104:119], v[64:67], v[52:55], v[104:119]
    v_and_b32 v22, 0xffff0000, v53
    v_add_f32 v15, v15, v21
    v_fmac_f32 v16, v21, v21
    v_add_f32 v17, v17, v22
    v_fmac_f32 v18, v22, v22
    s_cmp_eq_u32 s45, 1
    s_cbranch_scc0 p1_loopA0_a12
    v_mfma_f32_16x16x32_bf16 v[168:171], v[56:59], v[248:251], v[168:171]
    v_mfma_f32_16x16x32_bf16 v[172:175], v[60:63], v[248:251], v[172:175]
    v_mfma_f32_16x16x32_bf16 v[176:179], v[64:67], v[248:251], v[176:179]
p1_loopA0_a12:
    s_waitcnt lgkmcnt(4)
    v_mfma_f32_32x32x16_bf16 v[72:87], v[36:39], v[32:35], v[72:87]
    ds_read_b128 v[52:55], v8 offset:33792
    ds_read_b64_tr_b16 v[56:57], v13 offset:21504
    ds_read_b64_tr_b16 v[58:59], v13 offset:23296
    ds_read_b64_tr_b16 v[60:61], v13 offset:21632
    ds_read_b64_tr_b16 v[62:63], v13 offset:23424
    ds_read_b64_tr_b16 v[64:65], v13 offset:21760
    ds_read_b64_tr_b16 v[66:67], v13 offset:23552
    s_waitcnt lgkmcnt(9)
    v_mfma_f32_32x32x16_bf16 v[88:103], v[40:43], v[32:35], v[88:103]
    s_add_u32 s66, s99, 32768
    buffer_load_dwordx2 v[10:11], v252, s[32:35], s66 offen
    v_lshlrev_b32 v19, 16, v32
    v_and_b32 v20, 0xffff0000, v32
    v_add_f32 v15, v15, v19
    v_fmac_f32 v16, v19, v19
    v_add_f32 v17, v17, v20
    s_waitcnt lgkmcnt(7)
    v_mfma_f32_32x32x16_bf16 v[104:119], v[44:47], v[32:35], v[104:119]
    v_fmac_f32 v18, v20, v20
    v_lshlrev_b32 v21, 16, v33
    v_and_b32 v22, 0xffff0000, v33
    v_add_f32 v15, v15, v21
    v_fmac_f32 v16, v21, v21
    v_add_f32 v17, v17, v22
    v_fmac_f32 v18, v22, v22
    s_cmp_eq_u32 s45, 2
    s_cbranch_scc0 p1_loopA0_b12
    v_mfma_f32_16x16x32_bf16 v[168:171], v[36:39], v[248:251], v[168:171]
    v_mfma_f32_16x16x32_bf16 v[172:175], v[40:43], v[248:251], v[172:175]
    v_mfma_f32_16x16x32_bf16 v[176:179], v[44:47], v[248:251], v[176:179]
p1_loopA0_b12:
    s_waitcnt vmcnt(5) lgkmcnt(0)
    s_barrier
    v_mfma_f32_32x32x16_bf16 v[72:87], v[56:59], v[52:55], v[72:87]
    ds_read_b128 v[32:35], v5 offset:50176
    ds_read_b64_tr_b16 v[36:37], v13 offset:28672
    ds_read_b64_tr_b16 v[38:39], v13 offset:30464
    ds_read_b64_tr_b16 v[40:41], v13 offset:28800
    ds_read_b64_tr_b16 v[42:43], v13 offset:30592
    ds_read_b64_tr_b16 v[44:45], v13 offset:28928
    ds_read_b64_tr_b16 v[46:47], v13 offset:30720
    v_mfma_f32_32x32x16_bf16 v[88:103], v[60:63], v[52:55], v[88:103]
    v_lshlrev_b32 v19, 16, v52
    v_and_b32 v20, 0xffff0000, v52
    v_add_f32 v15, v15, v19
    v_fmac_f32 v16, v19, v19
    v_add_f32 v17, v17, v20
    v_fmac_f32 v18, v20, v20
    v_lshlrev_b32 v21, 16, v53
    v_mfma_f32_32x32x16_bf16 v[104:119], v[64:67], v[52:55], v[104:119]
    v_and_b32 v22, 0xffff0000, v53
    v_add_f32 v15, v15, v21
    v_fmac_f32 v16, v21, v21
    v_add_f32 v17, v17, v22
    v_fmac_f32 v18, v22, v22
    s_cmp_eq_u32 s45, 3
    s_cbranch_scc0 p1_loopA0_a13
    v_mfma_f32_16x16x32_bf16 v[168:171], v[56:59], v[248:251], v[168:171]
    v_mfma_f32_16x16x32_bf16 v[172:175], v[60:63], v[248:251], v[172:175]
    v_mfma_f32_16x16x32_bf16 v[176:179], v[64:67], v[248:251], v[176:179]
p1_loopA0_a13:
    s_waitcnt lgkmcnt(4)
    v_mfma_f32_32x32x16_bf16 v[72:87], v[36:39], v[32:35], v[72:87]
    ds_read_b128 v[52:55], v6 offset:50176
    ds_read_b64_tr_b16 v[56:57], v13 offset:35840
    ds_read_b64_tr_b16 v[58:59], v13 offset:37632
    ds_read_b64_tr_b16 v[60:61], v13 offset:35968
    ds_read_b64_tr_b16 v[62:63], v13 offset:37760
    ds_read_b64_tr_b16 v[64:65], v13 offset:36096
    ds_read_b64_tr_b16 v[66:67], v13 offset:37888
    s_waitcnt lgkmcnt(9)
    v_mfma_f32_32x32x16_bf16 v[88:103], v[40:43], v[32:35], v[88:103]
    v_lshlrev_b32 v19, 16, v32
    v_and_b32 v20, 0xffff0000, v32
    v_add_f32 v15, v15, v19
    v_fmac_f32 v16, v19, v19
    v_add_f32 v17, v17, v20
    v_fmac_f32 v18, v20, v20
    v_lshlrev_b32 v21, 16, v33
    s_waitcnt lgkmcnt(7)
    v_mfma_f32_32x32x16_bf16 v[104:119], v[44:47], v[32:35], v[104:119]
    v_and_b32 v22, 0xffff0000, v33
    v_add_f32 v15, v15, v21
    v_fmac_f32 v16, v21, v21
    v_add_f32 v17, v17, v22
    v_fmac_f32 v18, v22, v22
    s_cmp_eq_u32 s45, 0
    s_cbranch_scc0 p1_loopA0_b13
    v_mfma_f32_16x16x32_bf16 v[168:171], v[36:39], v[248:251], v[168:171]
    v_mfma_f32_16x16x32_bf16 v[172:175], v[40:43], v[248:251], v[172:175]
    v_mfma_f32_16x16x32_bf16 v[176:179], v[44:47], v[248:251], v[176:179]
p1_loopA0_b13:
    s_waitcnt lgkmcnt(4)
    v_mfma_f32_32x32x16_bf16 v[72:87], v[56:59], v[52:55], v[72:87]
    ds_read_b128 v[32:35], v7 offset:50176
    ds_read_b64_tr_b16 v[36:37], v13 offset:43008
    ds_read_b64_tr_b16 v[38:39], v13 offset:44800
    ds_read_b64_tr_b16 v[40:41], v13 offset:43136
    ds_read_b64_tr_b16 v[42:43], v13 offset:44928
    ds_read_b64_tr_b16 v[44:45], v13 offset:43264
    ds_read_b64_tr_b16 v[46:47], v13 offset:45056
    s_waitcnt lgkmcnt(9)
    v_mfma_f32_32x32x16_bf16 v[88:103], v[60:63], v[52:55], v[88:103]
    v_lshlrev_b32 v19, 16, v52
    v_and_b32 v20, 0xffff0000, v52
    v_add_f32 v15, v15, v19
    v_fmac_f32 v16, v19, v19
    v_add_f32 v17, v17, v20
    v_fmac_f32 v18, v20, v20
    v_lshlrev_b32 v21, 16, v53
    s_waitcnt lgkmcnt(7)
    v_mfma_f32_32x32x16_bf16 v[104:119], v[64:67], v[52:55], v[104:119]
    v_and_b32 v22, 0xffff0000, v53
    v_add_f32 v15, v15, v21
    v_fmac_f32 v16, v21, v21
    v_add_f32 v17, v17, v22
    v_fmac_f32 v18, v22, v22
    s_cmp_eq_u32 s45, 1
    s_cbranch_scc0 p1_loopA0_a14
    v_mfma_f32_16x16x32_bf16 v[168:171], v[56:59], v[248:251], v[168:171]
    v_mfma_f32_16x16x32_bf16 v[172:175], v[60:63], v[248:251], v[172:175]
    v_mfma_f32_16x16x32_bf16 v[176:179], v[64:67], v[248:251], v[176:179]
p1_loopA0_a14:
    s_waitcnt lgkmcnt(4)
    v_mfma_f32_32x32x16_bf16 v[72:87], v[36:39], v[32:35], v[72:87]
    ds_read_b128 v[52:55], v8 offset:50176
    ds_read_b64_tr_b16 v[56:57], v13 offset:50176
    ds_read_b64_tr_b16 v[58:59], v13 offset:51968
    ds_read_b64_tr_b16 v[60:61], v13 offset:50304
    ds_read_b64_tr_b16 v[62:63], v13 offset:52096
    ds_read_b64_tr_b16 v[64:65], v13 offset:50432
    ds_read_b64_tr_b16 v[66:67], v13 offset:52224
    s_waitcnt lgkmcnt(9)
    v_mfma_f32_32x32x16_bf16 v[88:103], v[40:43], v[32:35], v[88:103]
    v_lshlrev_b32 v19, 16, v32
    v_and_b32 v20, 0xffff0000, v32
    v_add_f32 v15, v15, v19
    v_fmac_f32 v16, v19, v19
    v_add_f32 v17, v17, v20
    v_fmac_f32 v18, v20, v20
    v_lshlrev_b32 v21, 16, v33
    s_waitcnt lgkmcnt(7)
    v_mfma_f32_32x32x16_bf16 v[104:119], v[44:47], v[32:35], v[104:119]
    v_and_b32 v22, 0xffff0000, v33
    v_add_f32 v15, v15, v21
    v_fmac_f32 v16, v21, v21
    v_add_f32 v17, v17, v22
    v_fmac_f32 v18, v22, v22
    s_cmp_eq_u32 s45, 2
    s_cbranch_scc0 p1_loopA0_b14
    v_mfma_f32_16x16x32_bf16 v[168:171], v[36:39], v[248:251], v[168:171]
    v_mfma_f32_16x16x32_bf16 v[172:175], v[40:43], v[248:251], v[172:175]
    v_mfma_f32_16x16x32_bf16 v[176:179], v[44:47], v[248:251], v[176:179]
p1_loopA0_b14:
    s_waitcnt lgkmcnt(4)
    v_mfma_f32_32x32x16_bf16 v[72:87], v[56:59], v[52:55], v[72:87]
    v_lshlrev_b32 v19, 16, v52
    v_and_b32 v20, 0xffff0000, v52
    v_add_f32 v15, v15, v19
    v_fmac_f32 v16, v19, v19
    s_waitcnt lgkmcnt(2)
    v_mfma_f32_32x32x16_bf16 v[88:103], v[60:63], v[52:55], v[88:103]
    v_add_f32 v17, v17, v20
    v_fmac_f32 v18, v20, v20
    v_lshlrev_b32 v21, 16, v53
    v_and_b32 v22, 0xffff0000, v53
    s_waitcnt lgkmcnt(0)
    v_mfma_f32_32x32x16_bf16 v[104:119], v[64:67], v[52:55], v[104:119]
    v_add_f32 v15, v15, v21
    v_fmac_f32 v16, v21, v21
    v_add_f32 v17, v17, v22
    v_fmac_f32 v18, v22, v22
    s_cmp_eq_u32 s45, 3
    s_cbranch_scc0 p1_loopA0_a15
    v_mfma_f32_16x16x32_bf16 v[168:171], v[56:59], v[248:251], v[168:171]
    v_mfma_f32_16x16x32_bf16 v[172:175], v[60:63], v[248:251], v[172:175]
    v_mfma_f32_16x16x32_bf16 v[176:179], v[64:67], v[248:251], v[176:179]
p1_loopA0_a15:
    s_branch p1_epiA
p1_typeA1:
    s_waitcnt vmcnt(7)
    s_barrier
    ds_read_b128 v[32:35], v5 offset:1024
    ds_read_b64_tr_b16 v[36:37], v13 offset:0
    ds_read_b64_tr_b16 v[38:39], v13 offset:1792
    ds_read_b64_tr_b16 v[40:41], v13 offset:128
    ds_read_b64_tr_b16 v[42:43], v13 offset:1920
    ds_read_b64_tr_b16 v[44:45], v13 offset:256
    ds_read_b64_tr_b16 v[46:47], v13 offset:2048
    ds_read_b128 v[52:55], v6 offset:1024
    ds_read_b64_tr_b16 v[56:57], v13 offset:7168
    ds_read_b64_tr_b16 v[58:59], v13 offset:8960
    ds_read_b64_tr_b16 v[60:61], v13 offset:7296
    ds_read_b64_tr_b16 v[62:63], v13 offset:9088
    ds_read_b64_tr_b16 v[64:65], v13 offset:7424
    ds_read_b64_tr_b16 v[66:67], v13 offset:9216
    s_waitcnt lgkmcnt(11)
    v_mfma_f32_32x32x16_bf16 v[72:87], v[36:39], v[32:35], 0
    s_add_u32 m0, s50, 33792
    s_nop 0
    buffer_load_dwordx4 v2, s[8:11], s56 offen lds
    s_add_u32 m0, s50, 34816
    s_nop 0
    buffer_load_dwordx4 v3, s[8:11], s56 offen lds
    s_add_u32 s56, s56, 128
    s_and_b32 s56, s56, 1023
    v_lshlrev_b32 v19, 16, v34
    v_and_b32 v20, 0xffff0000, v34
    v_add_f32 v15, v15, v19
    v_fmac_f32 v16, v19, v19
    s_waitcnt lgkmcnt(9)
    v_mfma_f32_32x32x16_bf16 v[88:103], v[40:43], v[32:35], 0
    s_mul_i32 s66, s57, 3072
    s_add_u32 m0, s51, 123904
    s_mov_b64 exec, s[64:65]
    buffer_load_dwordx4 v4, s[12:15], s66 offen lds
    s_add_u32 s66, s66, 6144
    s_add_u32 m0, s51, 124800
    s_nop 0
    buffer_load_dwordx4 v4, s[12:15], s66 offen lds
    s_mov_b64 exec, -1
    s_add_u32 s57, s57, 32
    s_and_b32 s57, s57, 511
    s_waitcnt lgkmcnt(7)
    v_mfma_f32_32x32x16_bf16 v[104:119], v[44:47], v[32:35], 0
    v_add_f32 v17, v17, v20
    v_fmac_f32 v18, v20, v20
    v_lshlrev_b32 v21, 16, v35
    v_and_b32 v22, 0xffff0000, v35
    v_add_f32 v15, v15, v21
    v_fmac_f32 v16, v21, v21
    v_add_f32 v17, v17, v22
    v_fmac_f32 v18, v22, v22
    s_cmp_eq_u32 s45, 0
    s_cbranch_scc0 p1_loopA1_p
    v_mfma_f32_16x16x32_bf16 v[168:171], v[36:39], v[248:251], v[168:171]
    v_mfma_f32_16x16x32_bf16 v[172:175], v[40:43], v[248:251], v[172:175]
    v_mfma_f32_16x16x32_bf16 v[176:179], v[44:47], v[248:251], v[176:179]
p1_loopA1_p:
    s_waitcnt lgkmcnt(4)
    v_mfma_f32_32x32x16_bf16 v[72:87], v[56:59], v[52:55], v[72:87]
    ds_read_b128 v[32:35], v7 offset:1024
    ds_read_b64_tr_b16 v[36:37], v13 offset:14336
    ds_read_b64_tr_b16 v[38:39], v13 offset:16128
    ds_read_b64_tr_b16 v[40:41], v13 offset:14464
    ds_read_b64_tr_b16 v[42:43], v13 offset:16256
    ds_read_b64_tr_b16 v[44:45], v13 offset:14592
    ds_read_b64_tr_b16 v[46:47], v13 offset:16384
    v_lshlrev_b32 v19, 16, v54
    v_and_b32 v20, 0xffff0000, v54
    v_add_f32 v15, v15, v19
    s_waitcnt lgkmcnt(9)
    v_mfma_f32_32x32x16_bf16 v[88:103], v[60:63], v[52:55], v[88:103]
    s_mul_i32 s66, s57, 3072
    s_add_u32 m0, s51, 138240
    s_mov_b64 exec, s[64:65]
    buffer_load_dwordx4 v4, s[12:15], s66 offen lds
    s_add_u32 s66, s66, 6144
    s_add_u32 m0, s51, 139136
    s_nop 0
    buffer_load_dwordx4 v4, s[12:15], s66 offen lds
    s_mov_b64 exec, -1
    s_add_u32 s57, s57, 32
    s_and_b32 s57, s57, 511
    s_waitcnt lgkmcnt(7)
    v_mfma_f32_32x32x16_bf16 v[104:119], v[64:67], v[52:55], v[104:119]
    v_fmac_f32 v16, v19, v19
    v_add_f32 v17, v17, v20
    v_fmac_f32 v18, v20, v20
    v_lshlrev_b32 v21, 16, v55
    v_and_b32 v22, 0xffff0000, v55
    v_add_f32 v15, v15, v21
    v_fmac_f32 v16, v21, v21
    v_add_f32 v17, v17, v22
    v_fmac_f32 v18, v22, v22
    s_cmp_eq_u32 s45, 1
    s_cbranch_scc0 p1_loopA1_a0
    v_mfma_f32_16x16x32_bf16 v[168:171], v[56:59], v[248:251], v[168:171]
    v_mfma_f32_16x16x32_bf16 v[172:175], v[60:63], v[248:251], v[172:175]
    v_mfma_f32_16x16x32_bf16 v[176:179], v[64:67], v[248:251], v[176:179]
p1_loopA1_a0:
    s_waitcnt lgkmcnt(4)
    v_mfma_f32_32x32x16_bf16 v[72:87], v[36:39], v[32:35], v[72:87]
    ds_read_b128 v[52:55], v8 offset:1024
    ds_read_b64_tr_b16 v[56:57], v13 offset:21504
    ds_read_b64_tr_b16 v[58:59], v13 offset:23296
    ds_read_b64_tr_b16 v[60:61], v13 offset:21632
    ds_read_b64_tr_b16 v[62:63], v13 offset:23424
    ds_read_b64_tr_b16 v[64:65], v13 offset:21760
    ds_read_b64_tr_b16 v[66:67], v13 offset:23552
    s_add_u32 m0, s50, 50176
    s_nop 0
    buffer_load_dwordx4 v2, s[8:11], s56 offen lds
    s_waitcnt lgkmcnt(9)
    v_mfma_f32_32x32x16_bf16 v[88:103], v[40:43], v[32:35], v[88:103]
    s_add_u32 m0, s50, 51200
    s_nop 0
    buffer_load_dwordx4 v3, s[8:11], s56 offen lds
    s_add_u32 s56, s56, 128
    s_and_b32 s56, s56, 1023
    v_lshlrev_b32 v19, 16, v34
    v_and_b32 v20, 0xffff0000, v34
    v_add_f32 v15, v15, v19
    v_fmac_f32 v16, v19, v19
    v_add_f32 v17, v17, v20
    s_waitcnt lgkmcnt(7)
    v_mfma_f32_32x32x16_bf16 v[104:119], v[44:47], v[32:35], v[104:119]
    v_fmac_f32 v18, v20, v20
    v_lshlrev_b32 v21, 16, v35
    v_and_b32 v22, 0xffff0000, v35
    v_add_f32 v15, v15, v21
    v_fmac_f32 v16, v21, v21
    v_add_f32 v17, v17, v22
    v_fmac_f32 v18, v22, v22
    s_cmp_eq_u32 s45, 2
    s_cbranch_scc0 p1_loopA1_b0
    v_mfma_f32_16x16x32_bf16 v[168:171], v[36:39], v[248:251], v[168:171]
    v_mfma_f32_16x16x32_bf16 v[172:175], v[40:43], v[248:251], v[172:175]
    v_mfma_f32_16x16x32_bf16 v[176:179], v[44:47], v[248:251], v[176:179]
p1_loopA1_b0:
    s_waitcnt vmcnt(9) lgkmcnt(0)
    s_barrier
    v_mfma_f32_32x32x16_bf16 v[72:87], v[56:59], v[52:55], v[72:87]
    ds_read_b128 v[32:35], v5 offset:17408
    ds_read_b64_tr_b16 v[36:37], v13 offset:28672
    ds_read_b64_tr_b16 v[38:39], v13 offset:30464
    ds_read_b64_tr_b16 v[40:41], v13 offset:28800
    ds_read_b64_tr_b16 v[42:43], v13 offset:30592
    ds_read_b64_tr_b16 v[44:45], v13 offset:28928
    ds_read_b64_tr_b16 v[46:47], v13 offset:30720
    s_add_u32 m0, s50, 1024
    s_nop 0
    buffer_load_dwordx4 v2, s[8:11], s56 offen lds
    v_mfma_f32_32x32x16_bf16 v[88:103], v[60:63], v[52:55], v[88:103]
    s_add_u32 m0, s50, 2048
    s_nop 0
    buffer_load_dwordx4 v3, s[8:11], s56 offen lds
    s_add_u32 s56, s56, 128
    s_and_b32 s56, s56, 1023
    v_lshlrev_b32 v19, 16, v54
    v_and_b32 v20, 0xffff0000, v54
    v_add_f32 v15, v15, v19
    v_fmac_f32 v16, v19, v19
    v_add_f32 v17, v17, v20
    v_mfma_f32_32x32x16_bf16 v[104:119], v[64:67], v[52:55], v[104:119]
    v_fmac_f32 v18, v20, v20
    v_lshlrev_b32 v21, 16, v55
    v_and_b32 v22, 0xffff0000, v55
    v_add_f32 v15, v15, v21
    v_fmac_f32 v16, v21, v21
    v_add_f32 v17, v17, v22
    v_fmac_f32 v18, v22, v22
    s_cmp_eq_u32 s45, 3
    s_cbranch_scc0 p1_loopA1_a1
    v_mfma_f32_16x16x32_bf16 v[168:171], v[56:59], v[248:251], v[168:171]
    v_mfma_f32_16x16x32_bf16 v[172:175], v[60:63], v[248:251], v[172:175]
    v_mfma_f32_16x16x32_bf16 v[176:179], v[64:67], v[248:251], v[176:179]
p1_loopA1_a1:
    s_waitcnt lgkmcnt(4)
    v_mfma_f32_32x32x16_bf16 v[72:87], v[36:39], v[32:35], v[72:87]
    ds_read_b128 v[52:55], v6 offset:17408
    ds_read_b64_tr_b16 v[56:57], v13 offset:35840
    ds_read_b64_tr_b16 v[58:59], v13 offset:37632
    ds_read_b64_tr_b16 v[60:61], v13 offset:35968
    ds_read_b64_tr_b16 v[62:63], v13 offset:37760
    ds_read_b64_tr_b16 v[64:65], v13 offset:36096
    ds_read_b64_tr_b16 v[66:67], v13 offset:37888
    v_lshlrev_b32 v19, 16, v34
    v_and_b32 v20, 0xffff0000, v34
    v_add_f32 v15, v15, v19
    s_waitcnt lgkmcnt(9)
    v_mfma_f32_32x32x16_bf16 v[88:103], v[40:43], v[32:35], v[88:103]
    s_mul_i32 s66, s57, 3072
    s_add_u32 m0, s51, 66560
    s_mov_b64 exec, s[64:65]
    buffer_load_dwordx4 v4, s[12:15], s66 offen lds
    s_add_u32 s66, s66, 6144
    s_add_u32 m0, s51, 67456
    s_nop 0
    buffer_load_dwordx4 v4, s[12:15], s66 offen lds
    s_mov_b64 exec, -1
    s_add_u32 s57, s57, 32
    s_and_b32 s57, s57, 511
    s_waitcnt lgkmcnt(7)
    v_mfma_f32_32x32x16_bf16 v[104:119], v[44:47], v[32:35], v[104:119]
    v_fmac_f32 v16, v19, v19
    v_add_f32 v17, v17, v20
    v_fmac_f32 v18, v20, v20
    v_lshlrev_b32 v21, 16, v35
    v_and_b32 v22, 0xffff0000, v35
    v_add_f32 v15, v15, v21
    v_fmac_f32 v16, v21, v21
    v_add_f32 v17, v17, v22
    v_fmac_f32 v18, v22, v22
    s_cmp_eq_u32 s45, 0
    s_cbranch_scc0 p1_loopA1_b1
    v_mfma_f32_16x16x32_bf16 v[168:171], v[36:39], v[248:251], v[168:171]
    v_mfma_f32_16x16x32_bf16 v[172:175], v[40:43], v[248:251], v[172:175]
    v_mfma_f32_16x16x32_bf16 v[176:179], v[44:47], v[248:251], v[176:179]
p1_loopA1_b1:
    s_waitcnt lgkmcnt(4)
    v_mfma_f32_32x32x16_bf16 v[72:87], v[56:59], v[52:55], v[72:87]
    ds_read_b128 v[32:35], v7 offset:17408
    ds_read_b64_tr_b16 v[36:37], v13 offset:43008
    ds_read_b64_tr_b16 v[38:39], v13 offset:44800
    ds_read_b64_tr_b16 v[40:41], v13 offset:43136
    ds_read_b64_tr_b16 v[42:43], v13 offset:44928
    ds_read_b64_tr_b16 v[44:45], v13 offset:43264
    ds_read_b64_tr_b16 v[46:47], v13 offset:45056
    v_lshlrev_b32 v19, 16, v54
    v_and_b32 v20, 0xffff0000, v54
    v_add_f32 v15, v15, v19
    s_waitcnt lgkmcnt(9)
    v_mfma_f32_32x32x16_bf16 v[88:103], v[60:63], v[52:55], v[88:103]
    s_mul_i32 s66, s57, 3072
    s_add_u32 m0, s51, 80896
    s_mov_b64 exec, s[64:65]
    buffer_load_dwordx4 v4, s[12:15], s66 offen lds
    s_add_u32 s66, s66, 6144
    s_add_u32 m0, s51, 81792
    s_nop 0
    buffer_load_dwordx4 v4, s[12:15], s66 offen lds
    s_mov_b64 exec, -1
    s_add_u32 s57, s57, 32
    s_and_b32 s57, s57, 511
    s_waitcnt lgkmcnt(7)
    v_mfma_f32_32x32x16_bf16 v[104:119], v[64:67], v[52:55], v[104:119]
    v_fmac_f32 v16, v19, v19
    v_add_f32 v17, v17, v20
    v_fmac_f32 v18, v20, v20
    v_lshlrev_b32 v21, 16, v55
    v_and_b32 v22, 0xffff0000, v55
    v_add_f32 v15, v15, v21
    v_fmac_f32 v16, v21, v21
    v_add_f32 v17, v17, v22
    v_fmac_f32 v18, v22, v22
    s_cmp_eq_u32 s45, 1
    s_cbranch_scc0 p1_loopA1_a2
    v_mfma_f32_16x16x32_bf16 v[168:171], v[56:59], v[248:251], v[168:171]
    v_mfma_f32_16x16x32_bf16 v[172:175], v[60:63], v[248:251], v[172:175]
    v_mfma_f32_16x16x32_bf16 v[176:179], v[64:67], v[248:251], v[176:179]
p1_loopA1_a2:
    s_waitcnt lgkmcnt(4)
    v_mfma_f32_32x32x16_bf16 v[72:87], v[36:39], v[32:35], v[72:87]
    ds_read_b128 v[52:55], v8 offset:17408
    ds_read_b64_tr_b16 v[56:57], v13 offset:50176
    ds_read_b64_tr_b16 v[58:59], v13 offset:51968
    ds_read_b64_tr_b16 v[60:61], v13 offset:50304
    ds_read_b64_tr_b16 v[62:63], v13 offset:52096
    ds_read_b64_tr_b16 v[64:65], v13 offset:50432
    ds_read_b64_tr_b16 v[66:67], v13 offset:52224
    s_waitcnt lgkmcnt(9)
    v_mfma_f32_32x32x16_bf16 v[88:103], v[40:43], v[32:35], v[88:103]
    v_lshlrev_b32 v19, 16, v34
    v_and_b32 v20, 0xffff0000, v34
    v_add_f32 v15, v15, v19
    v_fmac_f32 v16, v19, v19
    v_add_f32 v17, v17, v20
    v_fmac_f32 v18, v20, v20
    v_lshlrev_b32 v21, 16, v35
    s_waitcnt lgkmcnt(7)
    v_mfma_f32_32x32x16_bf16 v[104:119], v[44:47], v[32:35], v[104:119]
    v_and_b32 v22, 0xffff0000, v35
    v_add_f32 v15, v15, v21
    v_fmac_f32 v16, v21, v21
    v_add_f32 v17, v17, v22
    v_fmac_f32 v18, v22, v22
    s_cmp_eq_u32 s45, 2
    s_cbranch_scc0 p1_loopA1_b2
    v_mfma_f32_16x16x32_bf16 v[168:171], v[36:39], v[248:251], v[168:171]
    v_mfma_f32_16x16x32_bf16 v[172:175], v[40:43], v[248:251], v[172:175]
    v_mfma_f32_16x16x32_bf16 v[176:179], v[44:47], v[248:251], v[176:179]
p1_loopA1_b2:
    s_waitcnt vmcnt(8) lgkmcnt(0)
    s_barrier
    v_mfma_f32_32x32x16_bf16 v[72:87], v[56:59], v[52:55], v[72:87]
    ds_read_b128 v[32:35], v5 offset:33792
    ds_read_b64_tr_b16 v[36:37], v14 offset:0
    ds_read_b64_tr_b16 v[38:39], v14 offset:1792
    ds_read_b64_tr_b16 v[40:41], v14 offset:128
    ds_read_b64_tr_b16 v[42:43], v14 offset:1920
    ds_read_b64_tr_b16 v[44:45], v14 offset:256
    ds_read_b64_tr_b16 v[46:47], v14 offset:2048
    s_add_u32 m0, s50, 17408
    s_nop 0
    buffer_load_dwordx4 v2, s[8:11], s56 offen lds
    v_mfma_f32_32x32x16_bf16 v[88:103], v[60:63], v[52:55], v[88:103]
    s_add_u32 m0, s50, 18432
    s_nop 0
    buffer_load_dwordx4 v3, s[8:11], s56 offen lds
    s_add_u32 s56, s56, 128
    s_and_b32 s56, s56, 1023
    v_lshlrev_b32 v19, 16, v54
    v_and_b32 v20, 0xffff0000, v54
    v_add_f32 v15, v15, v19
    v_fmac_f32 v16, v19, v19
    v_add_f32 v17, v17, v20
    v_mfma_f32_32x32x16_bf16 v[104:119], v[64:67], v[52:55], v[104:119]
    v_fmac_f32 v18, v20, v20
    v_lshlrev_b32 v21, 16, v55
    v_and_b32 v22, 0xffff0000, v55
    v_add_f32 v15, v15, v21
    v_fmac_f32 v16, v21, v21
    v_add_f32 v17, v17, v22
    v_fmac_f32 v18, v22, v22
    s_cmp_eq_u32 s45, 3
    s_cbranch_scc0 p1_loopA1_a3
    v_mfma_f32_16x16x32_bf16 v[168:171], v[56:59], v[248:251], v[168:171]
    v_mfma_f32_16x16x32_bf16 v[172:175], v[60:63], v[248:251], v[172:175]
    v_mfma_f32_16x16x32_bf16 v[176:179], v[64:67], v[248:251], v[176:179]
p1_loopA1_a3:
    s_waitcnt lgkmcnt(4)
    v_mfma_f32_32x32x16_bf16 v[72:87], v[36:39], v[32:35], v[72:87]
    ds_read_b128 v[52:55], v6 offset:33792
    ds_read_b64_tr_b16 v[56:57], v14 offset:7168
    ds_read_b64_tr_b16 v[58:59], v14 offset:8960
    ds_read_b64_tr_b16 v[60:61], v14 offset:7296
    ds_read_b64_tr_b16 v[62:63], v14 offset:9088
    ds_read_b64_tr_b16 v[64:65], v14 offset:7424
    ds_read_b64_tr_b16 v[66:67], v14 offset:9216
    v_lshlrev_b32 v19, 16, v34
    v_and_b32 v20, 0xffff0000, v34
    v_add_f32 v15, v15, v19
    s_waitcnt lgkmcnt(9)
    v_mfma_f32_32x32x16_bf16 v[88:103], v[40:43], v[32:35], v[88:103]
    s_mul_i32 s66, s57, 3072
    s_add_u32 m0, s51, 95232
    s_mov_b64 exec, s[64:65]
    buffer_load_dwordx4 v4, s[12:15], s66 offen lds
    s_add_u32 s66, s66, 6144
    s_add_u32 m0, s51, 96128
    s_nop 0
    buffer_load_dwordx4 v4, s[12:15], s66 offen lds
    s_mov_b64 exec, -1
    s_add_u32 s57, s57, 32
    s_and_b32 s57, s57, 511
    s_waitcnt lgkmcnt(7)
    v_mfma_f32_32x32x16_bf16 v[104:119], v[44:47], v[32:35], v[104:119]
    v_fmac_f32 v16, v19, v19
    v_add_f32 v17, v17, v20
    v_fmac_f32 v18, v20, v20
    v_lshlrev_b32 v21, 16, v35
    v_and_b32 v22, 0xffff0000, v35
    v_add_f32 v15, v15, v21
    v_fmac_f32 v16, v21, v21
    v_add_f32 v17, v17, v22
    v_fmac_f32 v18, v22, v22
    s_cmp_eq_u32 s45, 0
    s_cbranch_scc0 p1_loopA1_b3
    v_mfma_f32_16x16x32_bf16 v[168:171], v[36:39], v[248:251], v[168:171]
    v_mfma_f32_16x16x32_bf16 v[172:175], v[40:43], v[248:251], v[172:175]
    v_mfma_f32_16x16x32_bf16 v[176:179], v[44:47], v[248:251], v[176:179]
p1_loopA1_b3:
    s_waitcnt lgkmcnt(4)
    v_mfma_f32_32x32x16_bf16 v[72:87], v[56:59], v[52:55], v[72:87]
    ds_read_b128 v[32:35], v7 offset:33792
    ds_read_b64_tr_b16 v[36:37], v14 offset:14336
    ds_read_b64_tr_b16 v[38:39], v14 offset:16128
    ds_read_b64_tr_b16 v[40:41], v14 offset:14464
    ds_read_b64_tr_b16 v[42:43], v14 offset:16256
    ds_read_b64_tr_b16 v[44:45], v14 offset:14592
    ds_read_b64_tr_b16 v[46:47], v14 offset:16384
    v_lshlrev_b32 v19, 16, v54
    v_and_b32 v20, 0xffff0000, v54
    v_add_f32 v15, v15, v19
    s_waitcnt lgkmcnt(9)
    v_mfma_f32_32x32x16_bf16 v[88:103], v[60:63], v[52:55], v[88:103]
    s_mul_i32 s66, s57, 3072
    s_add_u32 m0, s51, 109568
    s_mov_b64 exec, s[64:65]
    buffer_load_dwordx4 v4, s[12:15], s66 offen lds
    s_add_u32 s66, s66, 6144
    s_add_u32 m0, s51, 110464
    s_nop 0
    buffer_load_dwordx4 v4, s[12:15], s66 offen lds
    s_mov_b64 exec, -1
    s_add_u32 s57, s57, 32
    s_and_b32 s57, s57, 511
    s_waitcnt lgkmcnt(7)
    v_mfma_f32_32x32x16_bf16 v[104:119], v[64:67], v[52:55], v[104:119]
    v_fmac_f32 v16, v19, v19
    v_add_f32 v17, v17, v20
    v_fmac_f32 v18, v20, v20
    v_lshlrev_b32 v21, 16, v55
    v_and_b32 v22, 0xffff0000, v55
    v_add_f32 v15, v15, v21
    v_fmac_f32 v16, v21, v21
    v_add_f32 v17, v17, v22
    v_fmac_f32 v18, v22, v22
    s_cmp_eq_u32 s45, 1
    s_cbranch_scc0 p1_loopA1_a4
    v_mfma_f32_16x16x32_bf16 v[168:171], v[56:59], v[248:251], v[168:171]
    v_mfma_f32_16x16x32_bf16 v[172:175], v[60:63], v[248:251], v[172:175]
    v_mfma_f32_16x16x32_bf16 v[176:179], v[64:67], v[248:251], v[176:179]
p1_loopA1_a4:
    s_waitcnt lgkmcnt(4)
    v_mfma_f32_32x32x16_bf16 v[72:87], v[36:39], v[32:35], v[72:87]
    ds_read_b128 v[52:55], v8 offset:33792
    ds_read_b64_tr_b16 v[56:57], v14 offset:21504
    ds_read_b64_tr_b16 v[58:59], v14 offset:23296
    ds_read_b64_tr_b16 v[60:61], v14 offset:21632
    ds_read_b64_tr_b16 v[62:63], v14 offset:23424
    ds_read_b64_tr_b16 v[64:65], v14 offset:21760
    ds_read_b64_tr_b16 v[66:67], v14 offset:23552
    s_waitcnt lgkmcnt(9)
    v_mfma_f32_32x32x16_bf16 v[88:103], v[40:43], v[32:35], v[88:103]
    v_lshlrev_b32 v19, 16, v34
    v_and_b32 v20, 0xffff0000, v34
    v_add_f32 v15, v15, v19
    v_fmac_f32 v16, v19, v19
    v_add_f32 v17, v17, v20
    v_fmac_f32 v18, v20, v20
    v_lshlrev_b32 v21, 16, v35
    s_waitcnt lgkmcnt(7)
    v_mfma_f32_32x32x16_bf16 v[104:119], v[44:47], v[32:35], v[104:119]
    v_and_b32 v22, 0xffff0000, v35
    v_add_f32 v15, v15, v21
    v_fmac_f32 v16, v21, v21
    v_add_f32 v17, v17, v22
    v_fmac_f32 v18, v22, v22
    s_cmp_eq_u32 s45, 2
    s_cbranch_scc0 p1_loopA1_b4
    v_mfma_f32_16x16x32_bf16 v[168:171], v[36:39], v[248:251], v[168:171]
    v_mfma_f32_16x16x32_bf16 v[172:175], v[40:43], v[248:251], v[172:175]
    v_mfma_f32_16x16x32_bf16 v[176:179], v[44:47], v[248:251], v[176:179]
p1_loopA1_b4:
    s_waitcnt vmcnt(6) lgkmcnt(0)
    s_barrier
    v_mfma_f32_32x32x16_bf16 v[72:87], v[56:59], v[52:55], v[72:87]
    ds_read_b128 v[32:35], v5 offset:50176
    ds_read_b64_tr_b16 v[36:37], v13 offset:0
    ds_read_b64_tr_b16 v[38:39], v13 offset:1792
    ds_read_b64_tr_b16 v[40:41], v13 offset:128
    ds_read_b64_tr_b16 v[42:43], v13 offset:1920
    ds_read_b64_tr_b16 v[44:45], v13 offset:256
    ds_read_b64_tr_b16 v[46:47], v13 offset:2048
    s_add_u32 m0, s50, 33792
    s_nop 0
    buffer_load_dwordx4 v2, s[8:11], s56 offen lds
    v_mfma_f32_32x32x16_bf16 v[88:103], v[60:63], v[52:55], v[88:103]
    s_add_u32 m0, s50, 34816
    s_nop 0
    buffer_load_dwordx4 v3, s[8:11], s56 offen lds
    s_add_u32 s56, s56, 128
    s_and_b32 s56, s56, 1023
    v_lshlrev_b32 v19, 16, v54
    v_and_b32 v20, 0xffff0000, v54
    v_add_f32 v15, v15, v19
    v_fmac_f32 v16, v19, v19
    v_add_f32 v17, v17, v20
    v_mfma_f32_32x32x16_bf16 v[104:119], v[64:67], v[52:55], v[104:119]
    v_fmac_f32 v18, v20, v20
    v_lshlrev_b32 v21, 16, v55
    v_and_b32 v22, 0xffff0000, v55
    v_add_f32 v15, v15, v21
    v_fmac_f32 v16, v21, v21
    v_add_f32 v17, v17, v22
    v_fmac_f32 v18, v22, v22
    s_cmp_eq_u32 s45, 3
    s_cbranch_scc0 p1_loopA1_a5
    v_mfma_f32_16x16x32_bf16 v[168:171], v[56:59], v[248:251], v[168:171]
    v_mfma_f32_16x16x32_bf16 v[172:175], v[60:63], v[248:251], v[172:175]
    v_mfma_f32_16x16x32_bf16 v[176:179], v[64:67], v[248:251], v[176:179]
p1_loopA1_a5:
    s_waitcnt lgkmcnt(4)
    v_mfma_f32_32x32x16_bf16 v[72:87], v[36:39], v[32:35], v[72:87]
    ds_read_b128 v[52:55], v6 offset:50176
    ds_read_b64_tr_b16 v[56:57], v13 offset:7168
    ds_read_b64_tr_b16 v[58:59], v13 offset:8960
    ds_read_b64_tr_b16 v[60:61], v13 offset:7296
    ds_read_b64_tr_b16 v[62:63], v13 offset:9088
    ds_read_b64_tr_b16 v[64:65], v13 offset:7424
    ds_read_b64_tr_b16 v[66:67], v13 offset:9216
    v_lshlrev_b32 v19, 16, v34
    v_and_b32 v20, 0xffff0000, v34
    v_add_f32 v15, v15, v19
    s_waitcnt lgkmcnt(9)
    v_mfma_f32_32x32x16_bf16 v[88:103], v[40:43], v[32:35], v[88:103]
    s_mul_i32 s66, s57, 3072
    s_add_u32 m0, s51, 123904
    s_mov_b64 exec, s[64:65]
    buffer_load_dwordx4 v4, s[12:15], s66 offen lds
    s_add_u32 s66, s66, 6144
    s_add_u32 m0, s51, 124800
    s_nop 0
    buffer_load_dwordx4 v4, s[12:15], s66 offen lds
    s_mov_b64 exec, -1
    s_add_u32 s57, s57, 32
    s_and_b32 s57, s57, 511
    s_waitcnt lgkmcnt(7)
    v_mfma_f32_32x32x16_bf16 v[104:119], v[44:47], v[32:35], v[104:119]
    v_fmac_f32 v16, v19, v19
    v_add_f32 v17, v17, v20
    v_fmac_f32 v18, v20, v20
    v_lshlrev_b32 v21, 16, v35
    v_and_b32 v22, 0xffff0000, v35
    v_add_f32 v15, v15, v21
    v_fmac_f32 v16, v21, v21
    v_add_f32 v17, v17, v22
    v_fmac_f32 v18, v22, v22
    s_cmp_eq_u32 s45, 0
    s_cbranch_scc0 p1_loopA1_b5
    v_mfma_f32_16x16x32_bf16 v[168:171], v[36:39], v[248:251], v[168:171]
    v_mfma_f32_16x16x32_bf16 v[172:175], v[40:43], v[248:251], v[172:175]
    v_mfma_f32_16x16x32_bf16 v[176:179], v[44:47], v[248:251], v[176:179]
p1_loopA1_b5:
    s_waitcnt lgkmcnt(4)
    v_mfma_f32_32x32x16_bf16 v[72:87], v[56:59], v[52:55], v[72:87]
    ds_read_b128 v[32:35], v7 offset:50176
    ds_read_b64_tr_b16 v[36:37], v13 offset:14336
    ds_read_b64_tr_b16 v[38:39], v13 offset:16128
    ds_read_b64_tr_b16 v[40:41], v13 offset:14464
    ds_read_b64_tr_b16 v[42:43], v13 offset:16256
    ds_read_b64_tr_b16 v[44:45], v13 offset:14592
    ds_read_b64_tr_b16 v[46:47], v13 offset:16384
    v_lshlrev_b32 v19, 16, v54
    v_and_b32 v20, 0xffff0000, v54
    v_add_f32 v15, v15, v19
    s_waitcnt lgkmcnt(9)
    v_mfma_f32_32x32x16_bf16 v[88:103], v[60:63], v[52:55], v[88:103]
    s_mul_i32 s66, s57, 3072
    s_add_u32 m0, s51, 138240
    s_mov_b64 exec, s[64:65]
    buffer_load_dwordx4 v4, s[12:15], s66 offen lds
    s_add_u32 s66, s66, 6144
    s_add_u32 m0, s51, 139136
    s_nop 0
    buffer_load_dwordx4 v4, s[12:15], s66 offen lds
    s_mov_b64 exec, -1
    s_add_u32 s57, s57, 32
    s_and_b32 s57, s57, 511
    s_waitcnt lgkmcnt(7)
    v_mfma_f32_32x32x16_bf16 v[104:119], v[64:67], v[52:55], v[104:119]
    v_fmac_f32 v16, v19, v19
    v_add_f32 v17, v17, v20
    v_fmac_f32 v18, v20, v20
    v_lshlrev_b32 v21, 16, v55
    v_and_b32 v22, 0xffff0000, v55
    v_add_f32 v15, v15, v21
    v_fmac_f32 v16, v21, v21
    v_add_f32 v17, v17, v22
    v_fmac_f32 v18, v22, v22
    s_cmp_eq_u32 s45, 1
    s_cbranch_scc0 p1_loopA1_a6
    v_mfma_f32_16x16x32_bf16 v[168:171], v[56:59], v[248:251], v[168:171]
    v_mfma_f32_16x16x32_bf16 v[172:175], v[60:63], v[248:251], v[172:175]
    v_mfma_f32_16x16x32_bf16 v[176:179], v[64:67], v[248:251], v[176:179]
p1_loopA1_a6:
    s_waitcnt lgkmcnt(4)
    v_mfma_f32_32x32x16_bf16 v[72:87], v[36:39], v[32:35], v[72:87]
    ds_read_b128 v[52:55], v8 offset:50176
    ds_read_b64_tr_b16 v[56:57], v13 offset:21504
    ds_read_b64_tr_b16 v[58:59], v13 offset:23296
    ds_read_b64_tr_b16 v[60:61], v13 offset:21632
    ds_read_b64_tr_b16 v[62:63], v13 offset:23424
    ds_read_b64_tr_b16 v[64:65], v13 offset:21760
    ds_read_b64_tr_b16 v[66:67], v13 offset:23552
    s_waitcnt lgkmcnt(9)
    v_mfma_f32_32x32x16_bf16 v[88:103], v[40:43], v[32:35], v[88:103]
    v_lshlrev_b32 v19, 16, v34
    v_and_b32 v20, 0xffff0000, v34
    v_add_f32 v15, v15, v19
    v_fmac_f32 v16, v19, v19
    v_add_f32 v17, v17, v20
    v_fmac_f32 v18, v20, v20
    v_lshlrev_b32 v21, 16, v35
    s_waitcnt lgkmcnt(7)
    v_mfma_f32_32x32x16_bf16 v[104:119], v[44:47], v[32:35], v[104:119]
    v_and_b32 v22, 0xffff0000, v35
    v_add_f32 v15, v15, v21
    v_fmac_f32 v16, v21, v21
    v_add_f32 v17, v17, v22
    v_fmac_f32 v18, v22, v22
    s_cmp_eq_u32 s45, 2
    s_cbranch_scc0 p1_loopA1_b6
    v_mfma_f32_16x16x32_bf16 v[168:171], v[36:39], v[248:251], v[168:171]
    v_mfma_f32_16x16x32_bf16 v[172:175], v[40:43], v[248:251], v[172:175]
    v_mfma_f32_16x16x32_bf16 v[176:179], v[44:47], v[248:251], v[176:179]
p1_loopA1_b6:
    s_waitcnt vmcnt(6) lgkmcnt(0)
    s_barrier
    v_mfma_f32_32x32x16_bf16 v[72:87], v[56:59], v[52:55], v[72:87]
    ds_read_b128 v[32:35], v5 offset:1024
    ds_read_b64_tr_b16 v[36:37], v13 offset:28672
    ds_read_b64_tr_b16 v[38:39], v13 offset:30464
    ds_read_b64_tr_b16 v[40:41], v13 offset:28800
    ds_read_b64_tr_b16 v[42:43], v13 offset:30592
    ds_read_b64_tr_b16 v[44:45], v13 offset:28928
    ds_read_b64_tr_b16 v[46:47], v13 offset:30720
    s_add_u32 m0, s50, 50176
    s_nop 0
    buffer_load_dwordx4 v2, s[8:11], s56 offen lds
    v_mfma_f32_32x32x16_bf16 v[88:103], v[60:63], v[52:55], v[88:103]
    s_add_u32 m0, s50, 51200
    s_nop 0
    buffer_load_dwordx4 v3, s[8:11], s56 offen lds
    s_add_u32 s56, s56, 128
    s_and_b32 s56, s56, 1023
    v_lshlrev_b32 v19, 16, v54
    v_and_b32 v20, 0xffff0000, v54
    v_add_f32 v15, v15, v19
    v_fmac_f32 v16, v19, v19
    v_add_f32 v17, v17, v20
    v_mfma_f32_32x32x16_bf16 v[104:119], v[64:67], v[52:55], v[104:119]
    v_fmac_f32 v18, v20, v20
    v_lshlrev_b32 v21, 16, v55
    v_and_b32 v22, 0xffff0000, v55
    v_add_f32 v15, v15, v21
    v_fmac_f32 v16, v21, v21
    v_add_f32 v17, v17, v22
    v_fmac_f32 v18, v22, v22
    s_cmp_eq_u32 s45, 3
    s_cbranch_scc0 p1_loopA1_a7
    v_mfma_f32_16x16x32_bf16 v[168:171], v[56:59], v[248:251], v[168:171]
    v_mfma_f32_16x16x32_bf16 v[172:175], v[60:63], v[248:251], v[172:175]
    v_mfma_f32_16x16x32_bf16 v[176:179], v[64:67], v[248:251], v[176:179]
p1_loopA1_a7:
    s_waitcnt lgkmcnt(4)
    v_mfma_f32_32x32x16_bf16 v[72:87], v[36:39], v[32:35], v[72:87]
    ds_read_b128 v[52:55], v6 offset:1024
    ds_read_b64_tr_b16 v[56:57], v13 offset:35840
    ds_read_b64_tr_b16 v[58:59], v13 offset:37632
    ds_read_b64_tr_b16 v[60:61], v13 offset:35968
    ds_read_b64_tr_b16 v[62:63], v13 offset:37760
    ds_read_b64_tr_b16 v[64:65], v13 offset:36096
    ds_read_b64_tr_b16 v[66:67], v13 offset:37888
    v_lshlrev_b32 v19, 16, v34
    v_and_b32 v20, 0xffff0000, v34
    v_add_f32 v15, v15, v19
    s_waitcnt lgkmcnt(9)
    v_mfma_f32_32x32x16_bf16 v[88:103], v[40:43], v[32:35], v[88:103]
    s_mul_i32 s66, s57, 3072
    s_add_u32 m0, s51, 66560
    s_mov_b64 exec, s[64:65]
    buffer_load_dwordx4 v4, s[12:15], s66 offen lds
    s_add_u32 s66, s66, 6144
    s_add_u32 m0, s51, 67456
    s_nop 0
    buffer_load_dwordx4 v4, s[12:15], s66 offen lds
    s_mov_b64 exec, -1
    s_add_u32 s57, s57, 32
    s_and_b32 s57, s57, 511
    s_waitcnt lgkmcnt(7)
    v_mfma_f32_32x32x16_bf16 v[104:119], v[44:47], v[32:35], v[104:119]
    v_fmac_f32 v16, v19, v19
    v_add_f32 v17, v17, v20
    v_fmac_f32 v18, v20, v20
    v_lshlrev_b32 v21, 16, v35
    v_and_b32 v22, 0xffff0000, v35
    v_add_f32 v15, v15, v21
    v_fmac_f32 v16, v21, v21
    v_add_f32 v17, v17, v22
    v_fmac_f32 v18, v22, v22
    s_cmp_eq_u32 s45, 0
    s_cbranch_scc0 p1_loopA1_b7
    v_mfma_f32_16x16x32_bf16 v[168:171], v[36:39], v[248:251], v[168:171]
    v_mfma_f32_16x16x32_bf16 v[172:175], v[40:43], v[248:251], v[172:175]
    v_mfma_f32_16x16x32_bf16 v[176:179], v[44:47], v[248:251], v[176:179]
p1_loopA1_b7:
    s_waitcnt lgkmcnt(4)
    v_mfma_f32_32x32x16_bf16 v[72:87], v[56:59], v[52:55], v[72:87]
    ds_read_b128 v[32:35], v7 offset:1024
    ds_read_b64_tr_b16 v[36:37], v13 offset:43008
    ds_read_b64_tr_b16 v[38:39], v13 offset:44800
    ds_read_b64_tr_b16 v[40:41], v13 offset:43136
    ds_read_b64_tr_b16 v[42:43], v13 offset:44928
    ds_read_b64_tr_b16 v[44:45], v13 offset:43264
    ds_read_b64_tr_b16 v[46:47], v13 offset:45056
    v_lshlrev_b32 v19, 16, v54
    v_and_b32 v20, 0xffff0000, v54
    v_add_f32 v15, v15, v19
    s_waitcnt lgkmcnt(9)
    v_mfma_f32_32x32x16_bf16 v[88:103], v[60:63], v[52:55], v[88:103]
    s_mul_i32 s66, s57, 3072
    s_add_u32 m0, s51, 80896
    s_mov_b64 exec, s[64:65]
    buffer_load_dwordx4 v4, s[12:15], s66 offen lds
    s_add_u32 s66, s66, 6144
    s_add_u32 m0, s51, 81792
    s_nop 0
    buffer_load_dwordx4 v4, s[12:15], s66 offen lds
    s_mov_b64 exec, -1
    s_add_u32 s57, s57, 32
    s_and_b32 s57, s57, 511
    s_waitcnt lgkmcnt(7)
    v_mfma_f32_32x32x16_bf16 v[104:119], v[64:67], v[52:55], v[104:119]
    v_fmac_f32 v16, v19, v19
    v_add_f32 v17, v17, v20
    v_fmac_f32 v18, v20, v20
    v_lshlrev_b32 v21, 16, v55
    v_and_b32 v22, 0xffff0000, v55
    v_add_f32 v15, v15, v21
    v_fmac_f32 v16, v21, v21
    v_add_f32 v17, v17, v22
    v_fmac_f32 v18, v22, v22
    s_cmp_eq_u32 s45, 1
    s_cbranch_scc0 p1_loopA1_a8
    v_mfma_f32_16x16x32_bf16 v[168:171], v[56:59], v[248:251], v[168:171]
    v_mfma_f32_16x16x32_bf16 v[172:175], v[60:63], v[248:251], v[172:175]
    v_mfma_f32_16x16x32_bf16 v[176:179], v[64:67], v[248:251], v[176:179]
p1_loopA1_a8:
    s_waitcnt lgkmcnt(4)
    v_mfma_f32_32x32x16_bf16 v[72:87], v[36:39], v[32:35], v[72:87]
    ds_read_b128 v[52:55], v8 offset:1024
    ds_read_b64_tr_b16 v[56:57], v13 offset:50176
    ds_read_b64_tr_b16 v[58:59], v13 offset:51968
    ds_read_b64_tr_b16 v[60:61], v13 offset:50304
    ds_read_b64_tr_b16 v[62:63], v13 offset:52096
    ds_read_b64_tr_b16 v[64:65], v13 offset:50432
    ds_read_b64_tr_b16 v[66:67], v13 offset:52224
    v_lshlrev_b32 v19, 16, v34
    s_waitcnt lgkmcnt(9)
    v_mfma_f32_32x32x16_bf16 v[88:103], v[40:43], v[32:35], v[88:103]
    s_add_u32 s66, s98, 0
    buffer_load_dwordx2 v[10:11], v252, s[28:31], s66 offen
    s_add_u32 s66, s98, 32768
    buffer_load_dwordx2 v[10:11], v252, s[28:31], s66 offen
    v_and_b32 v20, 0xffff0000, v34
    v_add_f32 v15, v15, v19
    v_fmac_f32 v16, v19, v19
    v_add_f32 v17, v17, v20
    s_waitcnt lgkmcnt(7)
    v_mfma_f32_32x32x16_bf16 v[104:119], v[44:47], v[32:35], v[104:119]
    v_fmac_f32 v18, v20, v20
    v_lshlrev_b32 v21, 16, v35
    v_and_b32 v22, 0xffff0000, v35
    v_add_f32 v15, v15, v21
    v_fmac_f32 v16, v21, v21
    v_add_f32 v17, v17, v22
    v_fmac_f32 v18, v22, v22
    s_cmp_eq_u32 s45, 2
    s_cbranch_scc0 p1_loopA1_b8
    v_mfma_f32_16x16x32_bf16 v[168:171], v[36:39], v[248:251], v[168:171]
    v_mfma_f32_16x16x32_bf16 v[172:175], v[40:43], v[248:251], v[172:175]
    v_mfma_f32_16x16x32_bf16 v[176:179], v[44:47], v[248:251], v[176:179]
p1_loopA1_b8:
    s_waitcnt vmcnt(8) lgkmcnt(0)
    s_barrier
    v_mfma_f32_32x32x16_bf16 v[72:87], v[56:59], v[52:55], v[72:87]
    ds_read_b128 v[32:35], v5 offset:17408
    ds_read_b64_tr_b16 v[36:37], v14 offset:0
    ds_read_b64_tr_b16 v[38:39], v14 offset:1792
    ds_read_b64_tr_b16 v[40:41], v14 offset:128
    ds_read_b64_tr_b16 v[42:43], v14 offset:1920
    ds_read_b64_tr_b16 v[44:45], v14 offset:256
    ds_read_b64_tr_b16 v[46:47], v14 offset:2048
    v_mfma_f32_32x32x16_bf16 v[88:103], v[60:63], v[52:55], v[88:103]
    v_lshlrev_b32 v19, 16, v54
    v_and_b32 v20, 0xffff0000, v54
    v_add_f32 v15, v15, v19
    v_fmac_f32 v16, v19, v19
    v_add_f32 v17, v17, v20
    v_fmac_f32 v18, v20, v20
    v_lshlrev_b32 v21, 16, v55
    v_mfma_f32_32x32x16_bf16 v[104:119], v[64:67], v[52:55], v[104:119]
    v_and_b32 v22, 0xffff0000, v55
    v_add_f32 v15, v15, v21
    v_fmac_f32 v16, v21, v21
    v_add_f32 v17, v17, v22
    v_fmac_f32 v18, v22, v22
    s_cmp_eq_u32 s45, 3
    s_cbranch_scc0 p1_loopA1_a9
    v_mfma_f32_16x16x32_bf16 v[168:171], v[56:59], v[248:251], v[168:171]
    v_mfma_f32_16x16x32_bf16 v[172:175], v[60:63], v[248:251], v[172:175]
    v_mfma_f32_16x16x32_bf16 v[176:179], v[64:67], v[248:251], v[176:179]
p1_loopA1_a9:
    s_waitcnt lgkmcnt(4)
    v_mfma_f32_32x32x16_bf16 v[72:87], v[36:39], v[32:35], v[72:87]
    ds_read_b128 v[52:55], v6 offset:17408
    ds_read_b64_tr_b16 v[56:57], v14 offset:7168
    ds_read_b64_tr_b16 v[58:59], v14 offset:8960
    ds_read_b64_tr_b16 v[60:61], v14 offset:7296
    ds_read_b64_tr_b16 v[62:63], v14 offset:9088
    ds_read_b64_tr_b16 v[64:65], v14 offset:7424
    ds_read_b64_tr_b16 v[66:67], v14 offset:9216
    v_lshlrev_b32 v19, 16, v34
    v_and_b32 v20, 0xffff0000, v34
    v_add_f32 v15, v15, v19
    v_fmac_f32 v16, v19, v19
    s_waitcnt lgkmcnt(9)
    v_mfma_f32_32x32x16_bf16 v[88:103], v[40:43], v[32:35], v[88:103]
    s_mul_i32 s66, s57, 3072
    s_add_u32 m0, s51, 95232
    s_mov_b64 exec, s[64:65]
    buffer_load_dwordx4 v4, s[12:15], s66 offen lds
    s_add_u32 s66, s66, 6144
    s_add_u32 m0, s51, 96128
    s_nop 0
    buffer_load_dwordx4 v4, s[12:15], s66 offen lds
    s_mov_b64 exec, -1
    s_add_u32 s57, s57, 32
    s_and_b32 s57, s57, 511
    v_add_f32 v17, v17, v20
    s_waitcnt lgkmcnt(7)
    v_mfma_f32_32x32x16_bf16 v[104:119], v[44:47], v[32:35], v[104:119]
    s_add_u32 s66, s98, 65536
    buffer_load_dwordx2 v[10:11], v252, s[28:31], s66 offen
    s_add_u32 s66, s98, 98304
    buffer_load_dwordx2 v[10:11], v252, s[28:31], s66 offen
    v_fmac_f32 v18, v20, v20
    v_lshlrev_b32 v21, 16, v35
    v_and_b32 v22, 0xffff0000, v35
    v_add_f32 v15, v15, v21
    v_fmac_f32 v16, v21, v21
    v_add_f32 v17, v17, v22
    v_fmac_f32 v18, v22, v22
    s_cmp_eq_u32 s45, 0
    s_cbranch_scc0 p1_loopA1_b9
    v_mfma_f32_16x16x32_bf16 v[168:171], v[36:39], v[248:251], v[168:171]
    v_mfma_f32_16x16x32_bf16 v[172:175], v[40:43], v[248:251], v[172:175]
    v_mfma_f32_16x16x32_bf16 v[176:179], v[44:47], v[248:251], v[176:179]
p1_loopA1_b9:
    s_waitcnt lgkmcnt(4)
    v_mfma_f32_32x32x16_bf16 v[72:87], v[56:59], v[52:55], v[72:87]
    ds_read_b128 v[32:35], v7 offset:17408
    ds_read_b64_tr_b16 v[36:37], v14 offset:14336
    ds_read_b64_tr_b16 v[38:39], v14 offset:16128
    ds_read_b64_tr_b16 v[40:41], v14 offset:14464
    ds_read_b64_tr_b16 v[42:43], v14 offset:16256
    ds_read_b64_tr_b16 v[44:45], v14 offset:14592
    ds_read_b64_tr_b16 v[46:47], v14 offset:16384
    v_lshlrev_b32 v19, 16, v54
    v_and_b32 v20, 0xffff0000, v54
    v_add_f32 v15, v15, v19
    s_waitcnt lgkmcnt(9)
    v_mfma_f32_32x32x16_bf16 v[88:103], v[60:63], v[52:55], v[88:103]
    s_mul_i32 s66, s57, 3072
    s_add_u32 m0, s51, 109568
    s_mov_b64 exec, s[64:65]
    buffer_load_dwordx4 v4, s[12:15], s66 offen lds
    s_add_u32 s66, s66, 6144
    s_add_u32 m0, s51, 110464
    s_nop 0
    buffer_load_dwordx4 v4, s[12:15], s66 offen lds
    s_mov_b64 exec, -1
    s_add_u32 s57, s57, 32
    s_and_b32 s57, s57, 511
    s_waitcnt lgkmcnt(7)
    v_mfma_f32_32x32x16_bf16 v[104:119], v[64:67], v[52:55], v[104:119]
    v_fmac_f32 v16, v19, v19
    v_add_f32 v17, v17, v20
    v_fmac_f32 v18, v20, v20
    v_lshlrev_b32 v21, 16, v55
    v_and_b32 v22, 0xffff0000, v55
    v_add_f32 v15, v15, v21
    v_fmac_f32 v16, v21, v21
    v_add_f32 v17, v17, v22
    v_fmac_f32 v18, v22, v22
    s_cmp_eq_u32 s45, 1
    s_cbranch_scc0 p1_loopA1_a10
    v_mfma_f32_16x16x32_bf16 v[168:171], v[56:59], v[248:251], v[168:171]
    v_mfma_f32_16x16x32_bf16 v[172:175], v[60:63], v[248:251], v[172:175]
    v_mfma_f32_16x16x32_bf16 v[176:179], v[64:67], v[248:251], v[176:179]
p1_loopA1_a10:
    s_waitcnt lgkmcnt(4)
    v_mfma_f32_32x32x16_bf16 v[72:87], v[36:39], v[32:35], v[72:87]
    ds_read_b128 v[52:55], v8 offset:17408
    ds_read_b64_tr_b16 v[56:57], v14 offset:21504
    ds_read_b64_tr_b16 v[58:59], v14 offset:23296
    ds_read_b64_tr_b16 v[60:61], v14 offset:21632
    ds_read_b64_tr_b16 v[62:63], v14 offset:23424
    ds_read_b64_tr_b16 v[64:65], v14 offset:21760
    ds_read_b64_tr_b16 v[66:67], v14 offset:23552
    v_lshlrev_b32 v19, 16, v34
    s_waitcnt lgkmcnt(9)
    v_mfma_f32_32x32x16_bf16 v[88:103], v[40:43], v[32:35], v[88:103]
    s_add_u32 s66, s98, 131072
    buffer_load_dwordx2 v[10:11], v252, s[28:31], s66 offen
    s_add_u32 s66, s98, 163840
    buffer_load_dwordx2 v[10:11], v252, s[28:31], s66 offen
    v_and_b32 v20, 0xffff0000, v34
    v_add_f32 v15, v15, v19
    v_fmac_f32 v16, v19, v19
    v_add_f32 v17, v17, v20
    s_waitcnt lgkmcnt(7)
    v_mfma_f32_32x32x16_bf16 v[104:119], v[44:47], v[32:35], v[104:119]
    v_fmac_f32 v18, v20, v20
    v_lshlrev_b32 v21, 16, v35
    v_and_b32 v22, 0xffff0000, v35
    v_add_f32 v15, v15, v21
    v_fmac_f32 v16, v21, v21
    v_add_f32 v17, v17, v22
    v_fmac_f32 v18, v22, v22
    s_cmp_eq_u32 s45, 2
    s_cbranch_scc0 p1_loopA1_b10
    v_mfma_f32_16x16x32_bf16 v[168:171], v[36:39], v[248:251], v[168:171]
    v_mfma_f32_16x16x32_bf16 v[172:175], v[40:43], v[248:251], v[172:175]
    v_mfma_f32_16x16x32_bf16 v[176:179], v[44:47], v[248:251], v[176:179]
p1_loopA1_b10:
    s_waitcnt vmcnt(10) lgkmcnt(0)
    s_barrier
    v_mfma_f32_32x32x16_bf16 v[72:87], v[56:59], v[52:55], v[72:87]
    ds_read_b128 v[32:35], v5 offset:33792
    ds_read_b64_tr_b16 v[36:37], v13 offset:0
    ds_read_b64_tr_b16 v[38:39], v13 offset:1792
    ds_read_b64_tr_b16 v[40:41], v13 offset:128
    ds_read_b64_tr_b16 v[42:43], v13 offset:1920
    ds_read_b64_tr_b16 v[44:45], v13 offset:256
    ds_read_b64_tr_b16 v[46:47], v13 offset:2048
    v_mfma_f32_32x32x16_bf16 v[88:103], v[60:63], v[52:55], v[88:103]
    v_lshlrev_b32 v19, 16, v54
    v_and_b32 v20, 0xffff0000, v54
    v_add_f32 v15, v15, v19
    v_fmac_f32 v16, v19, v19
    v_add_f32 v17, v17, v20
    v_fmac_f32 v18, v20, v20
    v_lshlrev_b32 v21, 16, v55
    v_mfma_f32_32x32x16_bf16 v[104:119], v[64:67], v[52:55], v[104:119]
    v_and_b32 v22, 0xffff0000, v55
    v_add_f32 v15, v15, v21
    v_fmac_f32 v16, v21, v21
    v_add_f32 v17, v17, v22
    v_fmac_f32 v18, v22, v22
    s_cmp_eq_u32 s45, 3
    s_cbranch_scc0 p1_loopA1_a11
    v_mfma_f32_16x16x32_bf16 v[168:171], v[56:59], v[248:251], v[168:171]
    v_mfma_f32_16x16x32_bf16 v[172:175], v[60:63], v[248:251], v[172:175]
    v_mfma_f32_16x16x32_bf16 v[176:179], v[64:67], v[248:251], v[176:179]
p1_loopA1_a11:
    s_waitcnt lgkmcnt(4)
    v_mfma_f32_32x32x16_bf16 v[72:87], v[36:39], v[32:35], v[72:87]
    ds_read_b128 v[52:55], v6 offset:33792
    ds_read_b64_tr_b16 v[56:57], v13 offset:7168
    ds_read_b64_tr_b16 v[58:59], v13 offset:8960
    ds_read_b64_tr_b16 v[60:61], v13 offset:7296
    ds_read_b64_tr_b16 v[62:63], v13 offset:9088
    ds_read_b64_tr_b16 v[64:65], v13 offset:7424
    ds_read_b64_tr_b16 v[66:67], v13 offset:9216
    v_lshlrev_b32 v19, 16, v34
    s_waitcnt lgkmcnt(9)
    v_mfma_f32_32x32x16_bf16 v[88:103], v[40:43], v[32:35], v[88:103]
    s_add_u32 s66, s98, 196608
    buffer_load_dwordx2 v[10:11], v252, s[28:31], s66 offen
    s_add_u32 s66, s99, 0
    buffer_load_dwordx2 v[10:11], v252, s[32:35], s66 offen
    v_and_b32 v20, 0xffff0000, v34
    v_add_f32 v15, v15, v19
    v_fmac_f32 v16, v19, v19
    v_add_f32 v17, v17, v20
    s_waitcnt lgkmcnt(7)
    v_mfma_f32_32x32x16_bf16 v[104:119], v[44:47], v[32:35], v[104:119]
    v_fmac_f32 v18, v20, v20
    v_lshlrev_b32 v21, 16, v35
    v_and_b32 v22, 0xffff0000, v35
    v_add_f32 v15, v15, v21
    v_fmac_f32 v16, v21, v21
    v_add_f32 v17, v17, v22
    v_fmac_f32 v18, v22, v22
    s_cmp_eq_u32 s45, 0
    s_cbranch_scc0 p1_loopA1_b11
    v_mfma_f32_16x16x32_bf16 v[168:171], v[36:39], v[248:251], v[168:171]
    v_mfma_f32_16x16x32_bf16 v[172:175], v[40:43], v[248:251], v[172:175]
    v_mfma_f32_16x16x32_bf16 v[176:179], v[44:47], v[248:251], v[176:179]
p1_loopA1_b11:
    s_waitcnt lgkmcnt(4)
    v_mfma_f32_32x32x16_bf16 v[72:87], v[56:59], v[52:55], v[72:87]
    ds_read_b128 v[32:35], v7 offset:33792
    ds_read_b64_tr_b16 v[36:37], v13 offset:14336
    ds_read_b64_tr_b16 v[38:39], v13 offset:16128
    ds_read_b64_tr_b16 v[40:41], v13 offset:14464
    ds_read_b64_tr_b16 v[42:43], v13 offset:16256
    ds_read_b64_tr_b16 v[44:45], v13 offset:14592
    ds_read_b64_tr_b16 v[46:47], v13 offset:16384
    s_waitcnt lgkmcnt(9)
    v_mfma_f32_32x32x16_bf16 v[88:103], v[60:63], v[52:55], v[88:103]
    v_lshlrev_b32 v19, 16, v54
    v_and_b32 v20, 0xffff0000, v54
    v_add_f32 v15, v15, v19
    v_fmac_f32 v16, v19, v19
    v_add_f32 v17, v17, v20
    v_fmac_f32 v18, v20, v20
    v_lshlrev_b32 v21, 16, v55
    s_waitcnt lgkmcnt(7)
    v_mfma_f32_32x32x16_bf16 v[104:119], v[64:67], v[52:55], v[104:119]
    v_and_b32 v22, 0xffff0000, v55
    v_add_f32 v15, v15, v21
    v_fmac_f32 v16, v21, v21
    v_add_f32 v17, v17, v22
    v_fmac_f32 v18, v22, v22
    s_cmp_eq_u32 s45, 1
    s_cbranch_scc0 p1_loopA1_a12
    v_mfma_f32_16x16x32_bf16 v[168:171], v[56:59], v[248:251], v[168:171]
    v_mfma_f32_16x16x32_bf16 v[172:175], v[60:63], v[248:251], v[172:175]
    v_mfma_f32_16x16x32_bf16 v[176:179], v[64:67], v[248:251], v[176:179]
p1_loopA1_a12:
    s_waitcnt lgkmcnt(4)
    v_mfma_f32_32x32x16_bf16 v[72:87], v[36:39], v[32:35], v[72:87]
    ds_read_b128 v[52:55], v8 offset:33792
    ds_read_b64_tr_b16 v[56:57], v13 offset:21504
    ds_read_b64_tr_b16 v[58:59], v13 offset:23296
    ds_read_b64_tr_b16 v[60:61], v13 offset:21632
    ds_read_b64_tr_b16 v[62:63], v13 offset:23424
    ds_read_b64_tr_b16 v[64:65], v13 offset:21760
    ds_read_b64_tr_b16 v[66:67], v13 offset:23552
    s_waitcnt lgkmcnt(9)
    v_mfma_f32_32x32x16_bf16 v[88:103], v[40:43], v[32:35], v[88:103]
    s_add_u32 s66, s99, 32768
    buffer_load_dwordx2 v[10:11], v252, s[32:35], s66 offen
    v_lshlrev_b32 v19, 16, v34
    v_and_b32 v20, 0xffff0000, v34
    v_add_f32 v15, v15, v19
    v_fmac_f32 v16, v19, v19
    v_add_f32 v17, v17, v20
    s_waitcnt lgkmcnt(7)
    v_mfma_f32_32x32x16_bf16 v[104:119], v[44:47], v[32:35], v[104:119]
    v_fmac_f32 v18, v20, v20
    v_lshlrev_b32 v21, 16, v35
    v_and_b32 v22, 0xffff0000, v35
    v_add_f32 v15, v15, v21
    v_fmac_f32 v16, v21, v21
    v_add_f32 v17, v17, v22
    v_fmac_f32 v18, v22, v22
    s_cmp_eq_u32 s45, 2
    s_cbranch_scc0 p1_loopA1_b12
    v_mfma_f32_16x16x32_bf16 v[168:171], v[36:39], v[248:251], v[168:171]
    v_mfma_f32_16x16x32_bf16 v[172:175], v[40:43], v[248:251], v[172:175]
    v_mfma_f32_16x16x32_bf16 v[176:179], v[44:47], v[248:251], v[176:179]
p1_loopA1_b12:
    s_waitcnt vmcnt(5) lgkmcnt(0)
    s_barrier
    v_mfma_f32_32x32x16_bf16 v[72:87], v[56:59], v[52:55], v[72:87]
    ds_read_b128 v[32:35], v5 offset:50176
    ds_read_b64_tr_b16 v[36:37], v13 offset:28672
    ds_read_b64_tr_b16 v[38:39], v13 offset:30464
    ds_read_b64_tr_b16 v[40:41], v13 offset:28800
    ds_read_b64_tr_b16 v[42:43], v13 offset:30592
    ds_read_b64_tr_b16 v[44:45], v13 offset:28928
    ds_read_b64_tr_b16 v[46:47], v13 offset:30720
    v_mfma_f32_32x32x16_bf16 v[88:103], v[60:63], v[52:55], v[88:103]
    v_lshlrev_b32 v19, 16, v54
    v_and_b32 v20, 0xffff0000, v54
    v_add_f32 v15, v15, v19
    v_fmac_f32 v16, v19, v19
    v_add_f32 v17, v17, v20
    v_fmac_f32 v18, v20, v20
    v_lshlrev_b32 v21, 16, v55
    v_mfma_f32_32x32x16_bf16 v[104:119], v[64:67], v[52:55], v[104:119]
    v_and_b32 v22, 0xffff0000, v55
    v_add_f32 v15, v15, v21
    v_fmac_f32 v16, v21, v21
    v_add_f32 v17, v17, v22
    v_fmac_f32 v18, v22, v22
    s_cmp_eq_u32 s45, 3
    s_cbranch_scc0 p1_loopA1_a13
    v_mfma_f32_16x16x32_bf16 v[168:171], v[56:59], v[248:251], v[168:171]
    v_mfma_f32_16x16x32_bf16 v[172:175], v[60:63], v[248:251], v[172:175]
    v_mfma_f32_16x16x32_bf16 v[176:179], v[64:67], v[248:251], v[176:179]
p1_loopA1_a13:
    s_waitcnt lgkmcnt(4)
    v_mfma_f32_32x32x16_bf16 v[72:87], v[36:39], v[32:35], v[72:87]
    ds_read_b128 v[52:55], v6 offset:50176
    ds_read_b64_tr_b16 v[56:57], v13 offset:35840
    ds_read_b64_tr_b16 v[58:59], v13 offset:37632
    ds_read_b64_tr_b16 v[60:61], v13 offset:35968
    ds_read_b64_tr_b16 v[62:63], v13 offset:37760
    ds_read_b64_tr_b16 v[64:65], v13 offset:36096
    ds_read_b64_tr_b16 v[66:67], v13 offset:37888
    s_waitcnt lgkmcnt(9)
    v_mfma_f32_32x32x16_bf16 v[88:103], v[40:43], v[32:35], v[88:103]
    v_lshlrev_b32 v19, 16, v34
    v_and_b32 v20, 0xffff0000, v34
    v_add_f32 v15, v15, v19
    v_fmac_f32 v16, v19, v19
    v_add_f32 v17, v17, v20
    v_fmac_f32 v18, v20, v20
    v_lshlrev_b32 v21, 16, v35
    s_waitcnt lgkmcnt(7)
    v_mfma_f32_32x32x16_bf16 v[104:119], v[44:47], v[32:35], v[104:119]
    v_and_b32 v22, 0xffff0000, v35
    v_add_f32 v15, v15, v21
    v_fmac_f32 v16, v21, v21
    v_add_f32 v17, v17, v22
    v_fmac_f32 v18, v22, v22
    s_cmp_eq_u32 s45, 0
    s_cbranch_scc0 p1_loopA1_b13
    v_mfma_f32_16x16x32_bf16 v[168:171], v[36:39], v[248:251], v[168:171]
    v_mfma_f32_16x16x32_bf16 v[172:175], v[40:43], v[248:251], v[172:175]
    v_mfma_f32_16x16x32_bf16 v[176:179], v[44:47], v[248:251], v[176:179]
p1_loopA1_b13:
    s_waitcnt lgkmcnt(4)
    v_mfma_f32_32x32x16_bf16 v[72:87], v[56:59], v[52:55], v[72:87]
    ds_read_b128 v[32:35], v7 offset:50176
    ds_read_b64_tr_b16 v[36:37], v13 offset:43008
    ds_read_b64_tr_b16 v[38:39], v13 offset:44800
    ds_read_b64_tr_b16 v[40:41], v13 offset:43136
    ds_read_b64_tr_b16 v[42:43], v13 offset:44928
    ds_read_b64_tr_b16 v[44:45], v13 offset:43264
    ds_read_b64_tr_b16 v[46:47], v13 offset:45056
    s_waitcnt lgkmcnt(9)
    v_mfma_f32_32x32x16_bf16 v[88:103], v[60:63], v[52:55], v[88:103]
    v_lshlrev_b32 v19, 16, v54
    v_and_b32 v20, 0xffff0000, v54
    v_add_f32 v15, v15, v19
    v_fmac_f32 v16, v19, v19
    v_add_f32 v17, v17, v20
    v_fmac_f32 v18, v20, v20
    v_lshlrev_b32 v21, 16, v55
    s_waitcnt lgkmcnt(7)
    v_mfma_f32_32x32x16_bf16 v[104:119], v[64:67], v[52:55], v[104:119]
    v_and_b32 v22, 0xffff0000, v55
    v_add_f32 v15, v15, v21
    v_fmac_f32 v16, v21, v21
    v_add_f32 v17, v17, v22
    v_fmac_f32 v18, v22, v22
    s_cmp_eq_u32 s45, 1
    s_cbranch_scc0 p1_loopA1_a14
    v_mfma_f32_16x16x32_bf16 v[168:171], v[56:59], v[248:251], v[168:171]
    v_mfma_f32_16x16x32_bf16 v[172:175], v[60:63], v[248:251], v[172:175]
    v_mfma_f32_16x16x32_bf16 v[176:179], v[64:67], v[248:251], v[176:179]
p1_loopA1_a14:
    s_waitcnt lgkmcnt(4)
    v_mfma_f32_32x32x16_bf16 v[72:87], v[36:39], v[32:35], v[72:87]
    ds_read_b128 v[52:55], v8 offset:50176
    ds_read_b64_tr_b16 v[56:57], v13 offset:50176
    ds_read_b64_tr_b16 v[58:59], v13 offset:51968
    ds_read_b64_tr_b16 v[60:61], v13 offset:50304
    ds_read_b64_tr_b16 v[62:63], v13 offset:52096
    ds_read_b64_tr_b16 v[64:65], v13 offset:50432
    ds_read_b64_tr_b16 v[66:67], v13 offset:52224
    s_waitcnt lgkmcnt(9)
    v_mfma_f32_32x32x16_bf16 v[88:103], v[40:43], v[32:35], v[88:103]
    v_lshlrev_b32 v19, 16, v34
    v_and_b32 v20, 0xffff0000, v34
    v_add_f32 v15, v15, v19
    v_fmac_f32 v16, v19, v19
    v_add_f32 v17, v17, v20
    v_fmac_f32 v18, v20, v20
    v_lshlrev_b32 v21, 16, v35
    s_waitcnt lgkmcnt(7)
    v_mfma_f32_32x32x16_bf16 v[104:119], v[44:47], v[32:35], v[104:119]
    v_and_b32 v22, 0xffff0000, v35
    v_add_f32 v15, v15, v21
    v_fmac_f32 v16, v21, v21
    v_add_f32 v17, v17, v22
    v_fmac_f32 v18, v22, v22
    s_cmp_eq_u32 s45, 2
    s_cbranch_scc0 p1_loopA1_b14
    v_mfma_f32_16x16x32_bf16 v[168:171], v[36:39], v[248:251], v[168:171]
    v_mfma_f32_16x16x32_bf16 v[172:175], v[40:43], v[248:251], v[172:175]
    v_mfma_f32_16x16x32_bf16 v[176:179], v[44:47], v[248:251], v[176:179]
p1_loopA1_b14:
    s_waitcnt lgkmcnt(4)
    v_mfma_f32_32x32x16_bf16 v[72:87], v[56:59], v[52:55], v[72:87]
    v_lshlrev_b32 v19, 16, v54
    v_and_b32 v20, 0xffff0000, v54
    v_add_f32 v15, v15, v19
    v_fmac_f32 v16, v19, v19
    s_waitcnt lgkmcnt(2)
    v_mfma_f32_32x32x16_bf16 v[88:103], v[60:63], v[52:55], v[88:103]
    v_add_f32 v17, v17, v20
    v_fmac_f32 v18, v20, v20
    v_lshlrev_b32 v21, 16, v55
    v_and_b32 v22, 0xffff0000, v55
    s_waitcnt lgkmcnt(0)
    v_mfma_f32_32x32x16_bf16 v[104:119], v[64:67], v[52:55], v[104:119]
    v_add_f32 v15, v15, v21
    v_fmac_f32 v16, v21, v21
    v_add_f32 v17, v17, v22
    v_fmac_f32 v18, v22, v22
    s_cmp_eq_u32 s45, 3
    s_cbranch_scc0 p1_loopA1_a15
    v_mfma_f32_16x16x32_bf16 v[168:171], v[56:59], v[248:251], v[168:171]
    v_mfma_f32_16x16x32_bf16 v[172:175], v[60:63], v[248:251], v[172:175]
    v_mfma_f32_16x16x32_bf16 v[176:179], v[64:67], v[248:251], v[176:179]
p1_loopA1_a15:
p1_epiA:
    s_waitcnt lgkmcnt(0)
    v_lshrrev_b32 v136, 5, v1
    v_bfe_u32 v137, v1, 2, 2
    v_lshl_add_u32 v136, v136, 2, v137
    v_lshlrev_b32 v136, 5, v136
    v_and_b32 v137, 3, v1
    v_lshl_add_u32 v136, v137, 3, v136
    s_lshl_b32 s52, s46, 10
    s_add_u32 s52, s52, 152576
    v_add_u32 v136, s52, v136
    ds_read_b64_tr_b16 v[24:25], v136 offset:0
    ds_read_b64_tr_b16 v[26:27], v136 offset:256
    ds_read_b64_tr_b16 v[28:29], v136 offset:512
    ds_read_b64_tr_b16 v[30:31], v136 offset:768
    s_or_b32 s52, s44, s67
    s_cbranch_scc1 p1_np0
    s_cmp_eq_u32 s47, 0
    s_cbranch_scc1 p1_np0
    v_readfirstlane_b32 s52, v160
    v_readfirstlane_b32 s53, v161
    s_or_b32 s5, s101, 0x80000000
    s_sub_u32 s4, s52, s100
    s_subb_u32 s5, s53, s5
    s_lshr_b32 s4, s4, 20
    s_or_b32 s4, s4, s5
    s_cbranch_scc0 p1_np0_h
    s_add_u32 s100, s100, 600
    s_addc_u32 s101, s101, 0
    s_bitset1_b32 s101, 31
    v_mov_b32 v160, s100
    v_mov_b32 v161, s101
    v_mov_b32 v162, 0
    v_mov_b32 v163, 0
    s_mov_b64 exec, 1
    buffer_atomic_cmpswap_x2 v[160:163], off, s[40:43], 0 offset:32 sc0 sc1
    s_mov_b64 exec, -1
    s_waitcnt vmcnt(0)
    v_readfirstlane_b32 s52, v160
    v_readfirstlane_b32 s53, v161
    s_nop 0
    s_cmp_eq_u32 s53, 0
    s_cselect_b32 s52, s100, s52
    s_cselect_b32 s53, s101, s53
p1_np0_h:
    v_mov_b32 v160, s52
    v_mov_b32 v161, s53
    v_mov_b32 v148, 161792
    ds_write_b64 v148, v[160:161] offset:16
p1_np0:
    v_add_f32 v15, v15, v17
    v_add_f32 v16, v16, v18
    v_mov_b32 v148, v15
    v_mov_b32 v149, v16
    s_nop 0
    v_permlane32_swap_b32 v15, v148
    v_permlane32_swap_b32 v16, v149
    v_add_f32 v150, v15, v148
    v_add_f32 v151, v16, v149
    s_lshl_b32 s52, s45, 8
    s_add_u32 s52, s52, 141312
    s_lshl_b32 s53, s46, 10
    s_add_u32 s53, s53, s52
    v_and_b32 v152, 31, v1
    v_lshlrev_b32 v153, 3, v152
    v_add_u32 v154, s53, v153
    v_add_u32 v153, s52, v153
    ds_write_b64 v154, v[150:151]
    v_and_b32 v154, 1, v1
    v_lshlrev_b32 v154, 6, v154
    v_lshrrev_b32 v155, 4, v1
    v_lshl_add_u32 v154, v155, 4, v154
    s_lshr_b32 s52, s45, 1
    s_mul_i32 s52, s52, 20480
    s_and_b32 s53, s45, 1
    s_lshl_b32 s53, s53, 10
    s_add_u32 s52, s52, s53
    s_add_u32 s53, s55, 18432
    s_add_u32 s52, s52, s53
    v_add_u32 v154, s52, v154
    v_lshlrev_b32 v152, 2, v152
    v_add_u32 v152, s53, v152
    s_mov_b32 exec_lo, 0x00030003
    s_mov_b32 exec_hi, 0x00030003
    ds_write_b128 v154, v[168:171] offset:0
    ds_write_b128 v154, v[172:175] offset:128
    ds_write_b128 v154, v[176:179] offset:256
    s_mov_b64 exec, -1
    v_mov_b32 v155, 161792
    s_waitcnt lgkmcnt(0)
    s_barrier
    ds_read_b64 v[160:161], v155 offset:16
    ds_read_b64 v[148:149], v153
    ds_read_b64 v[150:151], v153 offset:1024
    ds_read_b32 v168, v152 offset:0
    ds_read_b32 v169, v152 offset:1024
    ds_read_b32 v170, v152 offset:20480
    ds_read_b32 v171, v152 offset:21504
    ds_read_b32 v172, v152 offset:128
    ds_read_b32 v173, v152 offset:1152
    ds_read_b32 v174, v152 offset:20608
    ds_read_b32 v175, v152 offset:21632
    ds_read_b32 v176, v152 offset:256
    ds_read_b32 v177, v152 offset:1280
    ds_read_b32 v178, v152 offset:20736
    ds_read_b32 v179, v152 offset:21760
    s_waitcnt lgkmcnt(12)
    v_readfirstlane_b32 s100, v160
    v_readfirstlane_b32 s101, v161
    v_add_f32 v15, v148, v150
    v_add_f32 v16, v149, v151
    v_mul_f32 v15, 0xbb000000, v15
    v_mul_f32 v16, 0x3b000000, v16
    v_fma_f32 v16, -v15, v15, v16
    v_add_f32 v16, 0x3727c5ac, v16
    v_rsq_f32 v136, v16
    v_cvt_pk_bf16_f32 v148, v15, v15
    v_and_b32 v148, 0xffff0000, v148
    v_sub_f32 v148, v15, v148
    v_cvt_pk_bf16_f32 v140, v15, v148
    v_mov_b32 v141, 0
    v_mov_b32 v142, 0
    v_mov_b32 v143, 0
    v_mul_f32 v138, 0xbfb8aa3b, v136
    v_mov_b32 v145, 0
    v_mov_b32 v146, 0
    v_mov_b32 v147, 0
    v_mov_b32 v153, 0
    v_mov_b32 v154, 0
    v_mov_b32 v155, 0
    s_mov_b32 s62, 0
    s_mov_b32 s63, -1
    s_waitcnt lgkmcnt(8)
    v_add_f32 v168, v168, v169
    v_add_f32 v170, v170, v171
    v_add_f32 v168, v168, v170
    v_cvt_pk_bf16_f32 v169, v168, v168
    v_and_b32 v170, 0xffff0000, v169
    v_sub_f32 v170, v168, v170
    v_cvt_pk_bf16_f32 v170, v170, v170
    v_cndmask_b32 v144, v169, v170, s[62:63]
    s_nop 1
    v_mfma_f32_32x32x16_bf16 v[72:87], v[144:147], v[140:143], v[72:87]
    s_waitcnt lgkmcnt(4)
    v_add_f32 v172, v172, v173
    v_add_f32 v174, v174, v175
    v_add_f32 v172, v172, v174
    v_cvt_pk_bf16_f32 v173, v172, v172
    v_and_b32 v174, 0xffff0000, v173
    v_sub_f32 v174, v172, v174
    v_cvt_pk_bf16_f32 v174, v174, v174
    v_cndmask_b32 v152, v173, v174, s[62:63]
    s_nop 1
    v_mfma_f32_32x32x16_bf16 v[88:103], v[152:155], v[140:143], v[88:103]
    s_waitcnt lgkmcnt(0)
    v_add_f32 v176, v176, v177
    v_add_f32 v178, v178, v179
    v_add_f32 v176, v176, v178
    v_cvt_pk_bf16_f32 v177, v176, v176
    v_and_b32 v178, 0xffff0000, v177
    v_sub_f32 v178, v176, v178
    v_cvt_pk_bf16_f32 v178, v178, v178
    v_cndmask_b32 v144, v177, v178, s[62:63]
    s_nop 1
    v_mfma_f32_32x32x16_bf16 v[104:119], v[144:147], v[140:143], v[104:119]
    v_mov_b32 v148, 0
    v_mov_b32 v149, 0x80008000
    v_cndmask_b32 v148, v148, v149, s[60:61]
    v_xor_b32 v24, v24, v148
    v_xor_b32 v25, v25, v148
    v_xor_b32 v26, v26, v148
    v_xor_b32 v27, v27, v148
    v_xor_b32 v28, v28, v148
    v_xor_b32 v29, v29, v148
    v_xor_b32 v30, v30, v148
    v_xor_b32 v31, v31, v148
    s_and_b32 s52, s45, 1
    s_lshl_b32 s52, s52, 5
    v_and_b32 v148, 31, v1
    v_add_u32 v148, s52, v148
    v_bfe_u32 v149, v148, 1, 2
    v_lshrrev_b32 v150, 5, v1
    v_lshlrev_b32 v153, 5, v148
    v_lshl_add_u32 v153, v150, 4, v153
    v_xor_b32 v149, v149, v150
    v_lshlrev_b32 v148, 6, v148
    v_lshl_add_u32 v150, v149, 4, v148
    v_xor_b32 v149, 2, v149
    v_lshl_add_u32 v151, v149, 4, v148
    v_lshlrev_b32 v152, 4, v1
    s_and_b32 s53, s45, 2
    s_add_u32 s53, s53, s46
    s_mul_i32 s53, s53, 40960
    s_add_u32 s52, s53, 16384
    v_add_u32 v153, s52, v153
    s_add_u32 s53, s53, 12288
    v_add_u32 v150, s53, v150
    v_add_u32 v151, s53, v151
    s_cmp_eq_u32 s46, 0
    s_cbranch_scc0 p1_nocl
    s_lshl_b32 s55, s48, 2
    s_add_u32 s55, s55, s44
    s_lshl_b32 s55, s55, 4
    s_add_u32 s55, s55, s47
    s_lshl_b32 s55, s55, 7
    s_add_u32 s55, s55, 15253504
    s_xor_b32 s5, s101, 0x40000000
    v_mov_b32 v164, s100
    v_mov_b32 v165, s5
    v_mov_b32 v166, s100
    v_mov_b32 v167, s101
    s_mov_b64 exec, 1
    buffer_atomic_cmpswap_x2 v[164:167], off, s[20:23], s55 sc0 sc1
    s_mov_b64 exec, -1
p1_nocl:
    v_pk_mul_f32 v[88:89], v[88:89], v[136:137] op_sel_hi:[1,0]
    v_pk_mul_f32 v[90:91], v[90:91], v[136:137] op_sel_hi:[1,0]
    v_pk_mul_f32 v[92:93], v[92:93], v[136:137] op_sel_hi:[1,0]
    v_pk_mul_f32 v[94:95], v[94:95], v[136:137] op_sel_hi:[1,0]
    v_pk_mul_f32 v[96:97], v[96:97], v[136:137] op_sel_hi:[1,0]
    v_pk_mul_f32 v[98:99], v[98:99], v[136:137] op_sel_hi:[1,0]
    v_pk_mul_f32 v[100:101], v[100:101], v[136:137] op_sel_hi:[1,0]
    v_pk_mul_f32 v[102:103], v[102:103], v[136:137] op_sel_hi:[1,0]
    v_cvt_pk_bf16_f32 v40, v88, v89
    v_cvt_pk_bf16_f32 v41, v90, v91
    v_cvt_pk_bf16_f32 v42, v92, v93
    v_cvt_pk_bf16_f32 v43, v94, v95
    v_cvt_pk_bf16_f32 v44, v96, v97
    v_cvt_pk_bf16_f32 v45, v98, v99
    v_cvt_pk_bf16_f32 v46, v100, v101
    v_cvt_pk_bf16_f32 v47, v102, v103
    v_pk_mul_f32 v[104:105], v[104:105], v[136:137] op_sel_hi:[1,0]
    v_pk_mul_f32 v[106:107], v[106:107], v[136:137] op_sel_hi:[1,0]
    v_pk_mul_f32 v[108:109], v[108:109], v[136:137] op_sel_hi:[1,0]
    v_pk_mul_f32 v[110:111], v[110:111], v[136:137] op_sel_hi:[1,0]
    v_pk_mul_f32 v[112:113], v[112:113], v[136:137] op_sel_hi:[1,0]
    v_pk_mul_f32 v[114:115], v[114:115], v[136:137] op_sel_hi:[1,0]
    v_pk_mul_f32 v[116:117], v[116:117], v[136:137] op_sel_hi:[1,0]
    v_pk_mul_f32 v[118:119], v[118:119], v[136:137] op_sel_hi:[1,0]
    v_cvt_pk_bf16_f32 v48, v104, v105
    v_cvt_pk_bf16_f32 v49, v106, v107
    v_cvt_pk_bf16_f32 v50, v108, v109
    v_cvt_pk_bf16_f32 v51, v110, v111
    v_cvt_pk_bf16_f32 v52, v112, v113
    v_cvt_pk_bf16_f32 v53, v114, v115
    v_cvt_pk_bf16_f32 v54, v116, v117
    v_cvt_pk_bf16_f32 v55, v118, v119
    v_pk_mul_f32 v[72:73], v[72:73], v[136:137] op_sel_hi:[1,0]
    v_pk_mul_f32 v[74:75], v[74:75], v[136:137] op_sel_hi:[1,0]
    v_pk_mul_f32 v[76:77], v[76:77], v[136:137] op_sel_hi:[1,0]
    v_pk_mul_f32 v[78:79], v[78:79], v[136:137] op_sel_hi:[1,0]
    v_pk_mul_f32 v[80:81], v[80:81], v[136:137] op_sel_hi:[1,0]
    v_pk_mul_f32 v[82:83], v[82:83], v[136:137] op_sel_hi:[1,0]
    v_pk_mul_f32 v[84:85], v[84:85], v[136:137] op_sel_hi:[1,0]
    v_pk_mul_f32 v[86:87], v[86:87], v[136:137] op_sel_hi:[1,0]
    v_cvt_pk_bf16_f32 v32, v72, v73
    v_cvt_pk_bf16_f32 v33, v74, v75
    v_cvt_pk_bf16_f32 v34, v76, v77
    v_cvt_pk_bf16_f32 v35, v78, v79
    v_cvt_pk_bf16_f32 v36, v80, v81
    v_cvt_pk_bf16_f32 v37, v82, v83
    v_cvt_pk_bf16_f32 v38, v84, v85
    v_cvt_pk_bf16_f32 v39, v86, v87
    ds_write_b128 v153, v[48:51]
    ds_write_b128 v153, v[52:55] offset:20480
    v_mfma_f32_32x32x16_bf16 v[104:119], v[24:27], v[40:43], 0
    v_mfma_f32_32x32x16_bf16 v[120:135], v[28:31], v[44:47], 0
    v_mfma_f32_32x32x16_bf16 v[72:87], v[24:27], v[32:35], 0
    v_mfma_f32_32x32x16_bf16 v[88:103], v[28:31], v[36:39], 0
    s_nop 8
    v_max3_f32 v154, v104, v105, v106
    v_max3_f32 v156, v112, v113, v114
    v_max3_f32 v154, v154, v107, v108
    v_max3_f32 v156, v156, v115, v116
    v_max3_f32 v154, v154, v109, v110
    v_max3_f32 v156, v156, v117, v118
    v_max_f32 v154, v154, v111
    v_max_f32 v156, v156, v119
    s_nop 1
    v_permlane32_swap_b32 v154, v156
    v_max_f32 v154, v154, v156
    v_mul_f32 v154, 0xbfb8aa3b, v154
    v_mov_b32 v156, v154
    s_nop 1
    v_permlane32_swap_b32 v154, v156
    v_pk_fma_f32 v[104:105], v[104:105], s[58:59], v[154:155] op_sel_hi:[1,0,0]
    v_pk_fma_f32 v[106:107], v[106:107], s[58:59], v[154:155] op_sel_hi:[1,0,0]
    v_pk_fma_f32 v[108:109], v[108:109], s[58:59], v[154:155] op_sel_hi:[1,0,0]
    v_pk_fma_f32 v[110:111], v[110:111], s[58:59], v[154:155] op_sel_hi:[1,0,0]
    v_pk_fma_f32 v[112:113], v[112:113], s[58:59], v[156:157] op_sel_hi:[1,0,0]
    v_pk_fma_f32 v[114:115], v[114:115], s[58:59], v[156:157] op_sel_hi:[1,0,0]
    v_pk_fma_f32 v[116:117], v[116:117], s[58:59], v[156:157] op_sel_hi:[1,0,0]
    v_pk_fma_f32 v[118:119], v[118:119], s[58:59], v[156:157] op_sel_hi:[1,0,0]
    v_exp_f32 v104, v104
    v_exp_f32 v105, v105
    v_exp_f32 v106, v106
    v_exp_f32 v107, v107
    v_exp_f32 v108, v108
    v_exp_f32 v109, v109
    v_exp_f32 v110, v110
    v_exp_f32 v111, v111
    v_exp_f32 v112, v112
    v_exp_f32 v113, v113
    v_exp_f32 v114, v114
    v_exp_f32 v115, v115
    v_exp_f32 v116, v116
    v_exp_f32 v117, v117
    v_exp_f32 v118, v118
    v_exp_f32 v119, v119
    v_pk_add_f32 v[154:155], v[104:105], v[106:107]
    v_pk_add_f32 v[156:157], v[112:113], v[114:115]
    v_pk_add_f32 v[158:159], v[108:109], v[110:111]
    v_pk_add_f32 v[160:161], v[116:117], v[118:119]
    v_pk_add_f32 v[154:155], v[154:155], v[158:159]
    v_pk_add_f32 v[156:157], v[156:157], v[160:161]
    v_add_f32 v154, v154, v155
    v_add_f32 v156, v156, v157
    s_nop 1
    v_permlane32_swap_b32 v154, v156
    v_add_f32 v154, v154, v156
    v_rcp_f32 v154, v154
    s_nop 0
    v_mov_b32 v156, v154
    s_nop 1
    v_permlane32_swap_b32 v154, v156
    v_pk_mul_f32 v[104:105], v[104:105], v[154:155] op_sel_hi:[1,0]
    v_pk_mul_f32 v[106:107], v[106:107], v[154:155] op_sel_hi:[1,0]
    v_pk_mul_f32 v[108:109], v[108:109], v[154:155] op_sel_hi:[1,0]
    v_pk_mul_f32 v[110:111], v[110:111], v[154:155] op_sel_hi:[1,0]
    v_pk_mul_f32 v[112:113], v[112:113], v[156:157] op_sel_hi:[1,0]
    v_pk_mul_f32 v[114:115], v[114:115], v[156:157] op_sel_hi:[1,0]
    v_pk_mul_f32 v[116:117], v[116:117], v[156:157] op_sel_hi:[1,0]
    v_pk_mul_f32 v[118:119], v[118:119], v[156:157] op_sel_hi:[1,0]
    v_cvt_pk_bf16_f32 v56, v104, v105
    v_cvt_pk_bf16_f32 v57, v106, v107
    v_cvt_pk_bf16_f32 v58, v108, v109
    v_cvt_pk_bf16_f32 v59, v110, v111
    v_cvt_pk_bf16_f32 v60, v112, v113
    v_cvt_pk_bf16_f32 v61, v114, v115
    v_cvt_pk_bf16_f32 v62, v116, v117
    v_cvt_pk_bf16_f32 v63, v118, v119
    ds_write_b128 v150, v[56:59] offset:0
    ds_write_b128 v151, v[60:63] offset:0
    v_max3_f32 v154, v120, v121, v122
    v_max3_f32 v156, v128, v129, v130
    v_max3_f32 v154, v154, v123, v124
    v_max3_f32 v156, v156, v131, v132
    v_max3_f32 v154, v154, v125, v126
    v_max3_f32 v156, v156, v133, v134
    v_max_f32 v154, v154, v127
    v_max_f32 v156, v156, v135
    s_nop 1
    v_permlane32_swap_b32 v154, v156
    v_max_f32 v154, v154, v156
    v_mul_f32 v154, 0xbfb8aa3b, v154
    v_mov_b32 v156, v154
    s_nop 1
    v_permlane32_swap_b32 v154, v156
    v_pk_fma_f32 v[120:121], v[120:121], s[58:59], v[154:155] op_sel_hi:[1,0,0]
    v_pk_fma_f32 v[122:123], v[122:123], s[58:59], v[154:155] op_sel_hi:[1,0,0]
    v_pk_fma_f32 v[124:125], v[124:125], s[58:59], v[154:155] op_sel_hi:[1,0,0]
    v_pk_fma_f32 v[126:127], v[126:127], s[58:59], v[154:155] op_sel_hi:[1,0,0]
    v_pk_fma_f32 v[128:129], v[128:129], s[58:59], v[156:157] op_sel_hi:[1,0,0]
    v_pk_fma_f32 v[130:131], v[130:131], s[58:59], v[156:157] op_sel_hi:[1,0,0]
    v_pk_fma_f32 v[132:133], v[132:133], s[58:59], v[156:157] op_sel_hi:[1,0,0]
    v_pk_fma_f32 v[134:135], v[134:135], s[58:59], v[156:157] op_sel_hi:[1,0,0]
    v_exp_f32 v120, v120
    v_exp_f32 v121, v121
    v_exp_f32 v122, v122
    v_exp_f32 v123, v123
    v_exp_f32 v124, v124
    v_exp_f32 v125, v125
    v_exp_f32 v126, v126
    v_exp_f32 v127, v127
    v_exp_f32 v128, v128
    v_exp_f32 v129, v129
    v_exp_f32 v130, v130
    v_exp_f32 v131, v131
    v_exp_f32 v132, v132
    v_exp_f32 v133, v133
    v_exp_f32 v134, v134
    v_exp_f32 v135, v135
    v_pk_add_f32 v[154:155], v[120:121], v[122:123]
    v_pk_add_f32 v[156:157], v[128:129], v[130:131]
    v_pk_add_f32 v[158:159], v[124:125], v[126:127]
    v_pk_add_f32 v[160:161], v[132:133], v[134:135]
    v_pk_add_f32 v[154:155], v[154:155], v[158:159]
    v_pk_add_f32 v[156:157], v[156:157], v[160:161]
    v_add_f32 v154, v154, v155
    v_add_f32 v156, v156, v157
    s_nop 1
    v_permlane32_swap_b32 v154, v156
    v_add_f32 v154, v154, v156
    v_rcp_f32 v154, v154
    s_nop 0
    v_mov_b32 v156, v154
    s_nop 1
    v_permlane32_swap_b32 v154, v156
    v_pk_mul_f32 v[120:121], v[120:121], v[154:155] op_sel_hi:[1,0]
    v_pk_mul_f32 v[122:123], v[122:123], v[154:155] op_sel_hi:[1,0]
    v_pk_mul_f32 v[124:125], v[124:125], v[154:155] op_sel_hi:[1,0]
    v_pk_mul_f32 v[126:127], v[126:127], v[154:155] op_sel_hi:[1,0]
    v_pk_mul_f32 v[128:129], v[128:129], v[156:157] op_sel_hi:[1,0]
    v_pk_mul_f32 v[130:131], v[130:131], v[156:157] op_sel_hi:[1,0]
    v_pk_mul_f32 v[132:133], v[132:133], v[156:157] op_sel_hi:[1,0]
    v_pk_mul_f32 v[134:135], v[134:135], v[156:157] op_sel_hi:[1,0]
    v_cvt_pk_bf16_f32 v64, v120, v121
    v_cvt_pk_bf16_f32 v65, v122, v123
    v_cvt_pk_bf16_f32 v66, v124, v125
    v_cvt_pk_bf16_f32 v67, v126, v127
    v_cvt_pk_bf16_f32 v68, v128, v129
    v_cvt_pk_bf16_f32 v69, v130, v131
    v_cvt_pk_bf16_f32 v70, v132, v133
    v_cvt_pk_bf16_f32 v71, v134, v135
    ds_write_b128 v150, v[64:67] offset:20480
    ds_write_b128 v151, v[68:71] offset:20480
    s_waitcnt lgkmcnt(0)
    s_barrier
    s_cmp_ge_u32 s44, 4
    s_cbranch_scc1 p1_q
    v_lshrrev_b32 v154, 5, v1
    v_lshlrev_b32 v154, 3, v154
    v_bfe_u32 v155, v1, 2, 2
    v_add_u32 v154, v154, v155
    v_and_b32 v156, 3, v1
    v_lshlrev_b32 v150, 5, v154
    v_lshl_add_u32 v150, v156, 3, v150
    s_add_u32 s52, s72, 16384
    v_add_u32 v150, s52, v150
    v_lshlrev_b32 v154, 6, v154
    v_and_b32 v156, 1, v1
    v_lshl_add_u32 v154, v156, 3, v154
    v_bfe_u32 v155, v1, 3, 1
    v_bfe_u32 v156, v1, 1, 1
    v_xor_b32 v155, v155, v156
    v_bfe_u32 v156, v1, 4, 1
    v_lshl_add_u32 v157, v156, 1, v155
    s_add_u32 s52, s72, 12288
    v_lshl_add_u32 v148, v157, 4, v154
    v_add_u32 v148, s52, v148
    v_xor_b32 v157, 2, v157
    v_lshl_add_u32 v149, v157, 4, v154
    v_add_u32 v149, s52, v149
    v_mov_b32 v154, 0x3f803f80
    ds_read_b64_tr_b16 v[104:105], v150 offset:0
    ds_read_b64_tr_b16 v[106:107], v150 offset:128
    ds_read_b64_tr_b16 v[108:109], v148 offset:0
    ds_read_b64_tr_b16 v[110:111], v149 offset:256
    ds_read_b64_tr_b16 v[112:113], v150 offset:512
    ds_read_b64_tr_b16 v[114:115], v150 offset:640
    ds_read_b64_tr_b16 v[116:117], v148 offset:1024
    ds_read_b64_tr_b16 v[118:119], v149 offset:1280
    ds_read_b64_tr_b16 v[120:121], v150 offset:1024
    ds_read_b64_tr_b16 v[122:123], v150 offset:1152
    ds_read_b64_tr_b16 v[124:125], v148 offset:2048
    ds_read_b64_tr_b16 v[126:127], v149 offset:2304
    ds_read_b64_tr_b16 v[128:129], v150 offset:1536
    ds_read_b64_tr_b16 v[130:131], v150 offset:1664
    ds_read_b64_tr_b16 v[132:133], v148 offset:3072
    ds_read_b64_tr_b16 v[134:135], v149 offset:3328
    v_add_u32 v155, 81920, v150
    v_add_u32 v156, 81920, v148
    v_add_u32 v157, 81920, v149
    ds_read_b64_tr_b16 v[32:33], v155 offset:0
    ds_read_b64_tr_b16 v[34:35], v155 offset:128
    ds_read_b64_tr_b16 v[36:37], v156 offset:0
    ds_read_b64_tr_b16 v[38:39], v157 offset:256
    ds_read_b64_tr_b16 v[40:41], v155 offset:512
    ds_read_b64_tr_b16 v[42:43], v155 offset:640
    ds_read_b64_tr_b16 v[44:45], v156 offset:1024
    ds_read_b64_tr_b16 v[46:47], v157 offset:1280
    ds_read_b64_tr_b16 v[48:49], v155 offset:1024
    ds_read_b64_tr_b16 v[50:51], v155 offset:1152
    ds_read_b64_tr_b16 v[52:53], v156 offset:2048
    ds_read_b64_tr_b16 v[54:55], v157 offset:2304
    ds_read_b64_tr_b16 v[56:57], v155 offset:1536
    ds_read_b64_tr_b16 v[58:59], v155 offset:1664
    ds_read_b64_tr_b16 v[60:61], v156 offset:3072
    ds_read_b64_tr_b16 v[62:63], v157 offset:3328
    s_lshl_b32 s52, s48, 2
    s_add_u32 s52, s52, s44
    s_mul_i32 s52, s52, 2176
    s_add_u32 s52, s52, 14680064
    v_and_b32 v158, 31, v1
    v_lshlrev_b32 v158, 2, v158
    v_lshrrev_b32 v159, 5, v1
    v_lshl_add_u32 v158, v159, 9, v158
    s_waitcnt lgkmcnt(15)
    v_cndmask_b32 v104, v104, v154, s[60:61]
    v_cndmask_b32 v105, v105, v154, s[60:61]
    v_cndmask_b32 v106, v106, v154, s[60:61]
    v_cndmask_b32 v107, v107, v154, s[60:61]
    s_nop 1
    v_mfma_f32_32x32x16_bf16 v[168:183], v[104:107], v[108:111], 0
    s_waitcnt lgkmcnt(15)
    v_cndmask_b32 v112, v112, v154, s[60:61]
    v_cndmask_b32 v113, v113, v154, s[60:61]
    v_cndmask_b32 v114, v114, v154, s[60:61]
    v_cndmask_b32 v115, v115, v154, s[60:61]
    s_nop 1
    v_mfma_f32_32x32x16_bf16 v[168:183], v[112:115], v[116:119], v[168:183]
    s_waitcnt lgkmcnt(15)
    v_cndmask_b32 v120, v120, v154, s[60:61]
    v_cndmask_b32 v121, v121, v154, s[60:61]
    v_cndmask_b32 v122, v122, v154, s[60:61]
    v_cndmask_b32 v123, v123, v154, s[60:61]
    s_nop 1
    v_mfma_f32_32x32x16_bf16 v[168:183], v[120:123], v[124:127], v[168:183]
    s_waitcnt lgkmcnt(15)
    v_cndmask_b32 v128, v128, v154, s[60:61]
    v_cndmask_b32 v129, v129, v154, s[60:61]
    v_cndmask_b32 v130, v130, v154, s[60:61]
    v_cndmask_b32 v131, v131, v154, s[60:61]
    s_nop 1
    v_mfma_f32_32x32x16_bf16 v[168:183], v[128:131], v[132:135], v[168:183]
    s_waitcnt lgkmcnt(12)
    v_cndmask_b32 v32, v32, v154, s[60:61]
    v_cndmask_b32 v33, v33, v154, s[60:61]
    v_cndmask_b32 v34, v34, v154, s[60:61]
    v_cndmask_b32 v35, v35, v154, s[60:61]
    s_nop 1
    v_mfma_f32_32x32x16_bf16 v[168:183], v[32:35], v[36:39], v[168:183]
    s_waitcnt lgkmcnt(8)
    v_cndmask_b32 v40, v40, v154, s[60:61]
    v_cndmask_b32 v41, v41, v154, s[60:61]
    v_cndmask_b32 v42, v42, v154, s[60:61]
    v_cndmask_b32 v43, v43, v154, s[60:61]
    s_nop 1
    v_mfma_f32_32x32x16_bf16 v[168:183], v[40:43], v[44:47], v[168:183]
    s_waitcnt lgkmcnt(4)
    v_cndmask_b32 v48, v48, v154, s[60:61]
    v_cndmask_b32 v49, v49, v154, s[60:61]
    v_cndmask_b32 v50, v50, v154, s[60:61]
    v_cndmask_b32 v51, v51, v154, s[60:61]
    s_nop 1
    v_mfma_f32_32x32x16_bf16 v[168:183], v[48:51], v[52:55], v[168:183]
    s_waitcnt lgkmcnt(0)
    v_cndmask_b32 v56, v56, v154, s[60:61]
    v_cndmask_b32 v57, v57, v154, s[60:61]
    v_cndmask_b32 v58, v58, v154, s[60:61]
    v_cndmask_b32 v59, v59, v154, s[60:61]
    s_nop 1
    v_mfma_f32_32x32x16_bf16 v[168:183], v[56:59], v[60:63], v[168:183]
    s_mov_b32 s6, s52
    s_waitcnt vmcnt(0)
p1_kvz:
    v_readfirstlane_b32 s4, v164
    v_readfirstlane_b32 s7, v165
    s_cmp_eq_u32 s4, s100
    s_cbranch_scc0 p1_kvzc
    s_cmp_eq_u32 s7, s101
    s_nop 3
    s_cbranch_scc1 p1_kvadd
    s_cmp_eq_u32 s7, s5
    s_cbranch_scc1 p1_kvskip
p1_kvzc:
    s_cmp_eq_u32 s3, 0
    s_cbranch_scc0 p1_kvre
    s_mov_b32 s3, 2
    s_lshl_b32 s66, s48, 2
    s_lshl_b32 s52, 0x10000, s44
    v_mov_b32 v164, s52
    s_mov_b64 exec, 1
    buffer_atomic_or v164, off, s[40:43], s66 sc0 sc1
    s_mov_b64 exec, -1
    s_add_u32 s53, s44, 16
    s_waitcnt vmcnt(0)
    v_readfirstlane_b32 s4, v164
    s_nop 0
    s_bitcmp1_b32 s4, s53
    s_cbranch_scc1 p1_kvre
    s_lshl_b32 s52, s48, 2
    s_add_u32 s52, s52, s44
    s_mul_i32 s52, s52, 2176
    s_add_u32 s52, s52, 14680064
    v_lshlrev_b32 v165, 3, v1
    v_mov_b32 v32, 0
    v_mov_b32 v33, 0
    v_mov_b32 v34, 0
    v_mov_b32 v35, 0
    v_mov_b32 v36, 0
    v_mov_b32 v37, 0
    v_mov_b32 v38, 0
    v_mov_b32 v39, 0
    v_mov_b32 v40, 0
    v_mov_b32 v41, 0
    buffer_atomic_swap_x2 v[32:33], v165, s[20:23], s52 offen offset:0 sc0 sc1
    buffer_atomic_swap_x2 v[34:35], v165, s[20:23], s52 offen offset:512 sc0 sc1
    buffer_atomic_swap_x2 v[36:37], v165, s[20:23], s52 offen offset:1024 sc0 sc1
    buffer_atomic_swap_x2 v[38:39], v165, s[20:23], s52 offen offset:1536 sc0 sc1
    s_mov_b64 exec, 0xffff
    buffer_atomic_swap_x2 v[40:41], v165, s[20:23], s52 offen offset:2048 sc0 sc1
    s_mov_b64 exec, -1
    v_mov_b32 v160, s100
    v_mov_b32 v161, s101
    s_waitcnt vmcnt(0)
    s_lshl_b32 s52, s48, 2
    s_add_u32 s52, s52, s44
    s_lshl_b32 s52, s52, 11
    s_add_u32 s52, s52, 15253504
    v_lshlrev_b32 v165, 7, v1
    s_mov_b64 exec, 0xffff
    buffer_store_dwordx2 v[160:161], v165, s[20:23], s52 offen sc0 sc1
    s_mov_b64 exec, -1
p1_kvre:
    s_sleep 2
    v_mov_b32 v164, s100
    v_mov_b32 v165, s5
    v_mov_b32 v166, s100
    v_mov_b32 v167, s101
    s_mov_b64 exec, 1
    buffer_atomic_cmpswap_x2 v[164:167], off, s[20:23], s55 sc0 sc1
    s_mov_b64 exec, -1
    s_mov_b32 s52, s6
    s_waitcnt vmcnt(0)
    s_branch p1_kvz
p1_kvskip:
    s_mov_b32 s3, 0
    s_branch p1_q
p1_kvadd:
    buffer_atomic_add_f32 v168, v158, s[20:23], s52 offen offset:0 sc1
    buffer_atomic_add_f32 v169, v158, s[20:23], s52 offen offset:128 sc1
    buffer_atomic_add_f32 v170, v158, s[20:23], s52 offen offset:256 sc1
    buffer_atomic_add_f32 v171, v158, s[20:23], s52 offen offset:384 sc1
    buffer_atomic_add_f32 v172, v158, s[20:23], s52 offen offset:1024 sc1
    buffer_atomic_add_f32 v173, v158, s[20:23], s52 offen offset:1152 sc1
    buffer_atomic_add_f32 v174, v158, s[20:23], s52 offen offset:1280 sc1
    buffer_atomic_add_f32 v175, v158, s[20:23], s52 offen offset:1408 sc1
    s_mov_b32 exec_hi, 0
    buffer_atomic_add_f32 v176, v158, s[20:23], s52 offen offset:2048 sc1
    s_mov_b64 exec, -1
    s_mov_b32 s3, 1
p1_q:
    v_max3_f32 v154, v72, v73, v74
    v_max3_f32 v156, v80, v81, v82
    v_max3_f32 v154, v154, v75, v76
    v_max3_f32 v156, v156, v83, v84
    v_max3_f32 v154, v154, v77, v78
    v_max3_f32 v156, v156, v85, v86
    v_max_f32 v154, v154, v79
    v_max_f32 v156, v156, v87
    s_nop 1
    v_permlane32_swap_b32 v154, v156
    v_max_f32 v154, v154, v156
    v_mul_f32 v154, 0xbfb8aa3b, v154
    v_mov_b32 v156, v154
    s_nop 1
    v_permlane32_swap_b32 v154, v156
    v_pk_fma_f32 v[72:73], v[72:73], s[58:59], v[154:155] op_sel_hi:[1,0,0]
    s_add_u32 s66, s73, 98304
    buffer_load_dwordx4 v[184:187], v252, s[28:31], s66 offen
    v_pk_fma_f32 v[74:75], v[74:75], s[58:59], v[154:155] op_sel_hi:[1,0,0]
    v_pk_fma_f32 v[76:77], v[76:77], s[58:59], v[154:155] op_sel_hi:[1,0,0]
    v_pk_fma_f32 v[78:79], v[78:79], s[58:59], v[154:155] op_sel_hi:[1,0,0]
    v_pk_fma_f32 v[80:81], v[80:81], s[58:59], v[156:157] op_sel_hi:[1,0,0]
    v_pk_fma_f32 v[82:83], v[82:83], s[58:59], v[156:157] op_sel_hi:[1,0,0]
    v_pk_fma_f32 v[84:85], v[84:85], s[58:59], v[156:157] op_sel_hi:[1,0,0]
    s_add_u32 s66, s73, 106496
    buffer_load_dwordx4 v[188:191], v252, s[28:31], s66 offen
    v_pk_fma_f32 v[86:87], v[86:87], s[58:59], v[156:157] op_sel_hi:[1,0,0]
    v_exp_f32 v72, v72
    v_exp_f32 v73, v73
    s_add_u32 s66, s73, 114688
    buffer_load_dwordx4 v[192:195], v252, s[28:31], s66 offen
    v_exp_f32 v74, v74
    v_exp_f32 v75, v75
    s_add_u32 s66, s73, 122880
    buffer_load_dwordx4 v[196:199], v252, s[28:31], s66 offen
    v_exp_f32 v76, v76
    v_exp_f32 v77, v77
    s_add_u32 s66, s73, 131072
    buffer_load_dwordx4 v[200:203], v252, s[28:31], s66 offen
    v_exp_f32 v78, v78
    v_exp_f32 v79, v79
    s_add_u32 s66, s73, 139264
    buffer_load_dwordx4 v[204:207], v252, s[28:31], s66 offen
    v_exp_f32 v80, v80
    v_exp_f32 v81, v81
    s_add_u32 s66, s73, 147456
    buffer_load_dwordx4 v[208:211], v252, s[28:31], s66 offen
    v_exp_f32 v82, v82
    v_exp_f32 v83, v83
    s_add_u32 s66, s73, 155648
    buffer_load_dwordx4 v[212:215], v252, s[28:31], s66 offen
    v_exp_f32 v84, v84
    v_exp_f32 v85, v85
    s_add_u32 s66, s73, 163840
    buffer_load_dwordx4 v[216:219], v252, s[28:31], s66 offen
    v_exp_f32 v86, v86
    v_exp_f32 v87, v87
    s_add_u32 s66, s73, 172032
    buffer_load_dwordx4 v[220:223], v252, s[28:31], s66 offen
    v_pk_add_f32 v[154:155], v[72:73], v[74:75]
    v_pk_add_f32 v[156:157], v[80:81], v[82:83]
    v_pk_add_f32 v[158:159], v[76:77], v[78:79]
    v_pk_add_f32 v[160:161], v[84:85], v[86:87]
    v_pk_add_f32 v[154:155], v[154:155], v[158:159]
    v_pk_add_f32 v[156:157], v[156:157], v[160:161]
    v_add_f32 v154, v154, v155
    v_add_f32 v156, v156, v157
    s_nop 1
    v_permlane32_swap_b32 v154, v156
    v_add_f32 v154, v154, v156
    v_rcp_f32 v154, v154
    s_nop 0
    v_mov_b32 v156, v154
    s_nop 1
    v_permlane32_swap_b32 v154, v156
    v_pk_mul_f32 v[72:73], v[72:73], v[154:155] op_sel_hi:[1,0]
    v_pk_mul_f32 v[74:75], v[74:75], v[154:155] op_sel_hi:[1,0]
    v_pk_mul_f32 v[76:77], v[76:77], v[154:155] op_sel_hi:[1,0]
    v_pk_mul_f32 v[78:79], v[78:79], v[154:155] op_sel_hi:[1,0]
    v_pk_mul_f32 v[80:81], v[80:81], v[156:157] op_sel_hi:[1,0]
    v_pk_mul_f32 v[82:83], v[82:83], v[156:157] op_sel_hi:[1,0]
    s_add_u32 s66, s73, 180224
    buffer_load_dwordx4 v[224:227], v252, s[28:31], s66 offen
    v_pk_mul_f32 v[84:85], v[84:85], v[156:157] op_sel_hi:[1,0]
    v_pk_mul_f32 v[86:87], v[86:87], v[156:157] op_sel_hi:[1,0]
    v_cvt_pk_bf16_f32 v56, v72, v73
    v_cvt_pk_bf16_f32 v57, v74, v75
    v_cvt_pk_bf16_f32 v58, v76, v77
    v_cvt_pk_bf16_f32 v59, v78, v79
    s_add_u32 s66, s73, 188416
    buffer_load_dwordx4 v[228:231], v252, s[28:31], s66 offen
    v_cvt_pk_bf16_f32 v60, v80, v81
    v_cvt_pk_bf16_f32 v61, v82, v83
    v_cvt_pk_bf16_f32 v62, v84, v85
    v_cvt_pk_bf16_f32 v63, v86, v87
    s_cmp_eq_u32 s3, 0
    s_cbranch_scc1 p1_nokf
    s_lshl_b32 s52, s48, 9
    s_lshl_b32 s53, s47, 2
    s_add_u32 s52, s52, s53
    s_add_u32 s52, s52, s44
    s_lshl_b32 s52, s52, 3
    s_add_u32 s52, s52, 15220736
    v_lshlrev_b32 v150, 9, v1
    v_mov_b32 v148, s100
    v_mov_b32 v149, s101
    s_mov_b64 exec, 0xff
    s_waitcnt vmcnt(12)
    buffer_store_dwordx2 v[148:149], v150, s[20:23], s52 offen sc0 sc1
    s_mov_b64 exec, -1
p1_nokf:
    v_max3_f32 v154, v88, v89, v90
    v_max3_f32 v156, v96, v97, v98
    v_max3_f32 v154, v154, v91, v92
    v_max3_f32 v156, v156, v99, v100
    v_max3_f32 v154, v154, v93, v94
    v_max3_f32 v156, v156, v101, v102
    v_max_f32 v154, v154, v95
    v_max_f32 v156, v156, v103
    s_nop 1
    v_permlane32_swap_b32 v154, v156
    v_max_f32 v154, v154, v156
    v_mul_f32 v154, 0xbfb8aa3b, v154
    v_mov_b32 v156, v154
    s_nop 1
    v_permlane32_swap_b32 v154, v156
    v_pk_fma_f32 v[88:89], v[88:89], s[58:59], v[154:155] op_sel_hi:[1,0,0]
    v_pk_fma_f32 v[90:91], v[90:91], s[58:59], v[154:155] op_sel_hi:[1,0,0]
    s_add_u32 s66, s73, 196608
    buffer_load_dwordx4 v[232:235], v252, s[28:31], s66 offen
    v_pk_fma_f32 v[92:93], v[92:93], s[58:59], v[154:155] op_sel_hi:[1,0,0]
    v_pk_fma_f32 v[94:95], v[94:95], s[58:59], v[154:155] op_sel_hi:[1,0,0]
    v_pk_fma_f32 v[96:97], v[96:97], s[58:59], v[156:157] op_sel_hi:[1,0,0]
    v_pk_fma_f32 v[98:99], v[98:99], s[58:59], v[156:157] op_sel_hi:[1,0,0]
    v_pk_fma_f32 v[100:101], v[100:101], s[58:59], v[156:157] op_sel_hi:[1,0,0]
    v_pk_fma_f32 v[102:103], v[102:103], s[58:59], v[156:157] op_sel_hi:[1,0,0]
    s_add_u32 s66, s73, 204800
    buffer_load_dwordx4 v[236:239], v252, s[28:31], s66 offen
    v_exp_f32 v88, v88
    v_exp_f32 v89, v89
    s_add_u32 s66, s73, 212992
    buffer_load_dwordx4 v[240:243], v252, s[28:31], s66 offen
    v_exp_f32 v90, v90
    v_exp_f32 v91, v91
    s_add_u32 s66, s73, 221184
    buffer_load_dwordx4 v[244:247], v252, s[28:31], s66 offen
    v_exp_f32 v92, v92
    v_exp_f32 v93, v93
    s_add_u32 m0, s72, 0
    s_add_u32 s66, s73, 0
    buffer_load_dwordx4 v252, s[28:31], s66 offen lds
    v_exp_f32 v94, v94
    v_exp_f32 v95, v95
    s_add_u32 m0, s72, 1024
    s_add_u32 s66, s73, 8192
    buffer_load_dwordx4 v252, s[28:31], s66 offen lds
    v_exp_f32 v96, v96
    v_exp_f32 v97, v97
    s_add_u32 m0, s72, 2048
    s_add_u32 s66, s73, 16384
    buffer_load_dwordx4 v252, s[28:31], s66 offen lds
    v_exp_f32 v98, v98
    v_exp_f32 v99, v99
    s_add_u32 m0, s72, 3072
    s_add_u32 s66, s73, 24576
    buffer_load_dwordx4 v252, s[28:31], s66 offen lds
    v_exp_f32 v100, v100
    v_exp_f32 v101, v101
    s_add_u32 m0, s72, 4096
    s_add_u32 s66, s73, 32768
    buffer_load_dwordx4 v252, s[28:31], s66 offen lds
    v_exp_f32 v102, v102
    v_exp_f32 v103, v103
    s_add_u32 m0, s72, 5120
    s_add_u32 s66, s73, 40960
    buffer_load_dwordx4 v252, s[28:31], s66 offen lds
    v_pk_add_f32 v[154:155], v[88:89], v[90:91]
    v_pk_add_f32 v[156:157], v[96:97], v[98:99]
    v_pk_add_f32 v[158:159], v[92:93], v[94:95]
    v_pk_add_f32 v[160:161], v[100:101], v[102:103]
    v_pk_add_f32 v[154:155], v[154:155], v[158:159]
    v_pk_add_f32 v[156:157], v[156:157], v[160:161]
    v_add_f32 v154, v154, v155
    v_add_f32 v156, v156, v157
    s_nop 1
    v_permlane32_swap_b32 v154, v156
    v_add_f32 v154, v154, v156
    v_rcp_f32 v154, v154
    s_nop 0
    v_mov_b32 v156, v154
    s_nop 1
    v_permlane32_swap_b32 v154, v156
    v_pk_mul_f32 v[88:89], v[88:89], v[154:155] op_sel_hi:[1,0]
    v_pk_mul_f32 v[90:91], v[90:91], v[154:155] op_sel_hi:[1,0]
    v_pk_mul_f32 v[92:93], v[92:93], v[154:155] op_sel_hi:[1,0]
    v_pk_mul_f32 v[94:95], v[94:95], v[154:155] op_sel_hi:[1,0]
    v_pk_mul_f32 v[96:97], v[96:97], v[156:157] op_sel_hi:[1,0]
    v_pk_mul_f32 v[98:99], v[98:99], v[156:157] op_sel_hi:[1,0]
    s_add_u32 m0, s72, 6144
    s_add_u32 s66, s73, 49152
    buffer_load_dwordx4 v252, s[28:31], s66 offen lds
    v_pk_mul_f32 v[100:101], v[100:101], v[156:157] op_sel_hi:[1,0]
    v_pk_mul_f32 v[102:103], v[102:103], v[156:157] op_sel_hi:[1,0]
    v_cvt_pk_bf16_f32 v64, v88, v89
    v_cvt_pk_bf16_f32 v65, v90, v91
    v_cvt_pk_bf16_f32 v66, v92, v93
    v_cvt_pk_bf16_f32 v67, v94, v95
    s_add_u32 m0, s72, 7168
    s_add_u32 s66, s73, 57344
    buffer_load_dwordx4 v252, s[28:31], s66 offen lds
    v_cvt_pk_bf16_f32 v68, v96, v97
    v_cvt_pk_bf16_f32 v69, v98, v99
    v_cvt_pk_bf16_f32 v70, v100, v101
    v_cvt_pk_bf16_f32 v71, v102, v103
    s_add_u32 m0, s72, 8192
    s_add_u32 s66, s73, 65536
    buffer_load_dwordx4 v252, s[28:31], s66 offen lds
    s_add_u32 m0, s72, 9216
    s_add_u32 s66, s73, 73728
    buffer_load_dwordx4 v252, s[28:31], s66 offen lds
    s_add_u32 m0, s72, 10240
    s_add_u32 s66, s73, 81920
    buffer_load_dwordx4 v252, s[28:31], s66 offen lds
    s_add_u32 m0, s72, 11264
    s_add_u32 s66, s73, 90112
    buffer_load_dwordx4 v252, s[28:31], s66 offen lds
    v_and_b32 v17, 31, v1
    v_min_u32 v17, 16, v17
    v_lshlrev_b32 v17, 7, v17
    v_lshrrev_b32 v18, 5, v1
    v_lshl_add_u32 v17, v18, 5, v17
    v_lshlrev_b32 v18, 4, v1
    s_mul_i32 s76, s54, 2176
    s_add_u32 s76, s76, 14680064
    s_lshl_b32 s62, s47, 2
    s_add_u32 s62, s62, s45
    s_lshl_b32 s62, s62, 5
    s_add_u32 s62, s62, s54
    s_lshl_b32 s62, s62, 10
    s_add_u32 s62, s62, 8388608
    s_lshl_b32 s54, s47, 3
    s_add_u32 s54, s54, s48
    s_lshl_b32 s54, s54, 7
    s_add_u32 s54, s54, 15204352
    s_lshl_b32 s52, s44, 3
    s_add_u32 s54, s54, s52
    s_lshl_b32 s79, s48, 3
    s_and_b32 s52, s47, 7
    s_add_u32 s79, s79, s52
    s_lshl_b32 s79, s79, 9
    s_add_u32 s79, s79, 15220736
    s_barrier
    s_cmp_eq_u32 s67, 0
    s_cbranch_scc1 p1_doneA
    v_lshlrev_b32 v253, 3, v1
    s_waitcnt vmcnt(0)
    s_barrier
    buffer_load_dwordx2 v[20:21], v253, s[20:23], s79 offen sc0 sc1
    s_waitcnt vmcnt(0)
    v_cmp_eq_u64 vcc, s[100:101], v[20:21]
    s_nop 0
    s_cmp_eq_u64 vcc, -1
    s_cbranch_scc0 safe
    s_mov_b32 exec_lo, 0x0011ffff
    s_mov_b32 exec_hi, 0x0011ffff
    buffer_load_dwordx4 v[72:75], v17, s[20:23], s76 offen offset:0
    buffer_load_dwordx4 v[76:79], v17, s[20:23], s76 offen offset:16
    buffer_load_dwordx4 v[80:83], v17, s[20:23], s76 offen offset:64
    buffer_load_dwordx4 v[84:87], v17, s[20:23], s76 offen offset:80
    buffer_load_dwordx4 v[32:35], v17, s[20:23], s76 offen offset:2176
    buffer_load_dwordx4 v[36:39], v17, s[20:23], s76 offen offset:2192
    buffer_load_dwordx4 v[40:43], v17, s[20:23], s76 offen offset:2240
    buffer_load_dwordx4 v[44:47], v17, s[20:23], s76 offen offset:2256
    s_mov_b64 exec, -1
    s_waitcnt vmcnt(4)
    v_cvt_pk_bf16_f32 v88, v72, v73
    v_cvt_pk_bf16_f32 v89, v74, v75
    v_cvt_pk_bf16_f32 v90, v76, v77
    v_cvt_pk_bf16_f32 v91, v78, v79
    v_cvt_pk_bf16_f32 v92, v80, v81
    v_cvt_pk_bf16_f32 v93, v82, v83
    v_cvt_pk_bf16_f32 v94, v84, v85
    v_cvt_pk_bf16_f32 v95, v86, v87
    v_mfma_f32_32x32x16_bf16 v[72:87], v[88:91], v[56:59], 0
    s_nop 0
    v_mfma_f32_32x32x16_bf16 v[72:87], v[92:95], v[60:63], v[72:87]
    s_waitcnt vmcnt(0)
    v_cvt_pk_bf16_f32 v48, v32, v33
    v_cvt_pk_bf16_f32 v49, v34, v35
    v_cvt_pk_bf16_f32 v50, v36, v37
    v_cvt_pk_bf16_f32 v51, v38, v39
    v_cvt_pk_bf16_f32 v52, v40, v41
    v_cvt_pk_bf16_f32 v53, v42, v43
    v_cvt_pk_bf16_f32 v54, v44, v45
    v_cvt_pk_bf16_f32 v55, v46, v47
    v_mfma_f32_32x32x16_bf16 v[32:47], v[48:51], v[64:67], 0
    s_nop 0
    v_mfma_f32_32x32x16_bf16 v[32:47], v[52:55], v[68:71], v[32:47]
    v_add_f32 v80, s77, v80
    v_rcp_f32 v80, v80
    s_nop 0
    v_pk_mul_f32 v[72:73], v[72:73], v[80:81] op_sel_hi:[1,0]
    v_pk_mul_f32 v[74:75], v[74:75], v[80:81] op_sel_hi:[1,0]
    v_pk_mul_f32 v[76:77], v[76:77], v[80:81] op_sel_hi:[1,0]
    v_pk_mul_f32 v[78:79], v[78:79], v[80:81] op_sel_hi:[1,0]
    v_cvt_pk_bf16_f32 v88, v72, v73
    v_cvt_pk_bf16_f32 v89, v74, v75
    v_cvt_pk_bf16_f32 v90, v76, v77
    v_cvt_pk_bf16_f32 v91, v78, v79
    buffer_store_dwordx4 v[88:91], v18, s[20:23], s62 offen offset:0 sc1
    v_add_f32 v40, s77, v40
    v_rcp_f32 v40, v40
    s_nop 0
    v_pk_mul_f32 v[32:33], v[32:33], v[40:41] op_sel_hi:[1,0]
    v_pk_mul_f32 v[34:35], v[34:35], v[40:41] op_sel_hi:[1,0]
    v_pk_mul_f32 v[36:37], v[36:37], v[40:41] op_sel_hi:[1,0]
    v_pk_mul_f32 v[38:39], v[38:39], v[40:41] op_sel_hi:[1,0]
    v_cvt_pk_bf16_f32 v48, v32, v33
    v_cvt_pk_bf16_f32 v49, v34, v35
    v_cvt_pk_bf16_f32 v50, v36, v37
    v_cvt_pk_bf16_f32 v51, v38, v39
    buffer_store_dwordx4 v[48:51], v18, s[20:23], s62 offen offset:1024 sc1
    s_waitcnt vmcnt(0)
    v_mov_b32 v22, s100
    v_mov_b32 v23, s101
    s_mov_b64 exec, 1
    buffer_store_dwordx2 v[22:23], off, s[20:23], s54 offset:0 sc0 sc1
    s_mov_b64 exec, -1
    s_branch safe
p1_typeB:
    v_mul_u32_u24 v4, 3584, v136
    v_lshl_add_u32 v4, v137, 4, v4
    s_mul_i32 s52, s48, 448
    v_add_u32 v4, s52, v4
    s_waitcnt lgkmcnt(0)
    s_add_u32 m0, s50, 1024
    s_nop 0
    buffer_load_dwordx4 v2, s[8:11], s56 offen lds
    s_add_u32 m0, s50, 2048
    s_nop 0
    buffer_load_dwordx4 v3, s[8:11], s56 offen lds
    s_add_u32 s56, s56, 128
    s_and_b32 s56, s56, 1023
    s_mul_i32 s66, s57, 3584
    s_add_u32 m0, s51, 66560
    s_mov_b64 exec, s[64:65]
    buffer_load_dwordx4 v4, s[16:19], s66 offen lds
    s_add_u32 s66, s66, 7168
    s_add_u32 m0, s51, 67456
    s_nop 0
    buffer_load_dwordx4 v4, s[16:19], s66 offen lds
    s_mov_b64 exec, -1
    s_add_u32 s57, s57, 32
    s_and_b32 s57, s57, 511
    s_mul_i32 s66, s57, 3584
    s_add_u32 m0, s51, 80896
    s_mov_b64 exec, s[64:65]
    buffer_load_dwordx4 v4, s[16:19], s66 offen lds
    s_add_u32 s66, s66, 7168
    s_add_u32 m0, s51, 81792
    s_nop 0
    buffer_load_dwordx4 v4, s[16:19], s66 offen lds
    s_mov_b64 exec, -1
    s_add_u32 s57, s57, 32
    s_and_b32 s57, s57, 511
    s_setprio 2
    s_lshl_b32 s52, s45, 5
    v_and_b32 v19, 31, v1
    v_add_u32 v19, s52, v19
    v_bfe_u32 v20, v19, 1, 3
    v_lshrrev_b32 v21, 5, v1
    v_xor_b32 v20, v20, v21
    v_lshlrev_b32 v19, 7, v19
    v_xor_b32 v22, 0, v20
    v_lshl_add_u32 v5, v22, 4, v19
    v_xor_b32 v22, 2, v20
    v_lshl_add_u32 v6, v22, 4, v19
    v_xor_b32 v22, 4, v20
    v_lshl_add_u32 v7, v22, 4, v19
    v_xor_b32 v22, 6, v20
    v_lshl_add_u32 v8, v22, 4, v19
    v_lshrrev_b32 v19, 5, v1
    s_add_u32 m0, s50, 17408
    s_nop 0
    buffer_load_dwordx4 v2, s[8:11], s56 offen lds
    s_add_u32 m0, s50, 18432
    s_nop 0
    buffer_load_dwordx4 v3, s[8:11], s56 offen lds
    s_add_u32 s56, s56, 128
    s_and_b32 s56, s56, 1023
    v_lshlrev_b32 v19, 3, v19
    v_bfe_u32 v20, v1, 2, 2
    v_add_u32 v19, v19, v20
    v_mul_u32_u24 v19, 448, v19
    v_bfe_u32 v20, v1, 4, 1
    v_lshl_add_u32 v19, v20, 5, v19
    v_and_b32 v20, 3, v1
    v_lshl_add_u32 v13, v20, 3, v19
    v_and_b32 v253, 7, v1
    v_bfe_u32 v254, v1, 4, 1
    v_lshlrev_b32 v254, 2, v254
    v_xor_b32 v253, v253, v254
    v_lshlrev_b32 v253, 4, v253
    s_lshl_b32 s52, s69, 7
    v_add_u32 v253, s52, v253
    v_lshrrev_b32 v254, 3, v1
    s_mul_i32 s66, s57, 3584
    s_add_u32 m0, s51, 95232
    s_mov_b64 exec, s[64:65]
    buffer_load_dwordx4 v4, s[16:19], s66 offen lds
    s_add_u32 s66, s66, 7168
    s_add_u32 m0, s51, 96128
    s_nop 0
    buffer_load_dwordx4 v4, s[16:19], s66 offen lds
    s_mov_b64 exec, -1
    s_add_u32 s57, s57, 32
    s_and_b32 s57, s57, 511
    v_lshl_add_u32 v252, v254, 10, v253
    v_mov_b32 v15, 0
    v_mov_b32 v16, 0
    v_mov_b32 v17, 0
    v_mov_b32 v18, 0
    v_mov_b32 v168, 0
    v_mov_b32 v169, 0
    v_mov_b32 v170, 0
    v_mov_b32 v171, 0
    v_mov_b32 v172, 0
    v_mov_b32 v173, 0
    v_mov_b32 v174, 0
    v_mov_b32 v175, 0
    v_mov_b32 v176, 0
    v_mov_b32 v177, 0
    v_mov_b32 v178, 0
    s_mul_i32 s66, s57, 3584
    s_add_u32 m0, s51, 109568
    s_mov_b64 exec, s[64:65]
    buffer_load_dwordx4 v4, s[16:19], s66 offen lds
    s_add_u32 s66, s66, 7168
    s_add_u32 m0, s51, 110464
    s_nop 0
    buffer_load_dwordx4 v4, s[16:19], s66 offen lds
    s_mov_b64 exec, -1
    s_add_u32 s57, s57, 32
    s_and_b32 s57, s57, 511
    s_setprio 1
    v_mov_b32 v179, 0
    v_mov_b32 v180, 0
    v_mov_b32 v181, 0
    v_mov_b32 v182, 0
    v_mov_b32 v183, 0
    v_lshrrev_b32 v19, 4, v1
    v_xor_b32 v19, v19, v1
    v_and_b32 v19, 1, v19
    v_cmp_eq_u32 vcc, 0, v19
    v_mov_b32 v20, 0x3f803f80
    s_nop 0
    v_cndmask_b32 v248, 0, v20, vcc
    v_mov_b32 v249, v248
    v_mov_b32 v250, v248
    v_mov_b32 v251, v248
    v_add_u32 v13, 66560, v13
    v_add_u32 v14, 57344, v13
    s_setprio 0
    s_lshl_b32 s55, s46, 9
    s_cmp_eq_u32 s46, 0
    s_cbranch_scc0 p1_typeB1
    s_waitcnt vmcnt(6)
    s_barrier
    ds_read_b128 v[32:35], v5 offset:1024
    ds_read_b64_tr_b16 v[36:37], v13 offset:0
    ds_read_b64_tr_b16 v[38:39], v13 offset:1792
    ds_read_b64_tr_b16 v[40:41], v13 offset:64
    ds_read_b64_tr_b16 v[42:43], v13 offset:1856
    ds_read_b64_tr_b16 v[44:45], v13 offset:128
    ds_read_b64_tr_b16 v[46:47], v13 offset:1920
    ds_read_b64_tr_b16 v[48:49], v13 offset:192
    ds_read_b64_tr_b16 v[50:51], v13 offset:1984
    ds_read_b128 v[52:55], v6 offset:1024
    ds_read_b64_tr_b16 v[56:57], v13 offset:7168
    ds_read_b64_tr_b16 v[58:59], v13 offset:8960
    ds_read_b64_tr_b16 v[60:61], v13 offset:7232
    ds_read_b64_tr_b16 v[62:63], v13 offset:9024
    ds_read_b64_tr_b16 v[64:65], v13 offset:7296
    ds_read_b64_tr_b16 v[66:67], v13 offset:9088
    ds_read_b64_tr_b16 v[68:69], v13 offset:7360
    ds_read_b64_tr_b16 v[70:71], v13 offset:9152
    s_waitcnt lgkmcnt(15)
    v_mfma_f32_32x32x16_bf16 v[72:87], v[36:39], v[32:35], 0
    s_add_u32 m0, s50, 33792
    s_nop 0
    buffer_load_dwordx4 v2, s[8:11], s56 offen lds
    s_add_u32 m0, s50, 34816
    s_nop 0
    buffer_load_dwordx4 v3, s[8:11], s56 offen lds
    s_add_u32 s56, s56, 128
    s_and_b32 s56, s56, 1023
    v_lshlrev_b32 v19, 16, v32
    s_waitcnt lgkmcnt(13)
    v_mfma_f32_32x32x16_bf16 v[88:103], v[40:43], v[32:35], 0
    s_mul_i32 s66, s57, 3584
    s_add_u32 m0, s51, 123904
    s_mov_b64 exec, s[64:65]
    buffer_load_dwordx4 v4, s[16:19], s66 offen lds
    s_add_u32 s66, s66, 7168
    s_add_u32 m0, s51, 124800
    s_nop 0
    buffer_load_dwordx4 v4, s[16:19], s66 offen lds
    s_mov_b64 exec, -1
    s_add_u32 s57, s57, 32
    s_and_b32 s57, s57, 511
    s_waitcnt lgkmcnt(11)
    v_mfma_f32_32x32x16_bf16 v[104:119], v[44:47], v[32:35], 0
    v_and_b32 v20, 0xffff0000, v32
    v_add_f32 v15, v15, v19
    v_fmac_f32 v16, v19, v19
    v_add_f32 v17, v17, v20
    v_fmac_f32 v18, v20, v20
    v_lshlrev_b32 v21, 16, v33
    v_and_b32 v22, 0xffff0000, v33
    s_waitcnt lgkmcnt(9)
    v_mfma_f32_32x32x16_bf16 v[120:135], v[48:51], v[32:35], 0
    v_add_f32 v15, v15, v21
    v_fmac_f32 v16, v21, v21
    v_add_f32 v17, v17, v22
    v_fmac_f32 v18, v22, v22
    s_cmp_eq_u32 s45, 0
    s_cbranch_scc0 p1_loopB0_p
    v_mfma_f32_16x16x32_bf16 v[168:171], v[36:39], v[248:251], v[168:171]
    v_mfma_f32_16x16x32_bf16 v[172:175], v[40:43], v[248:251], v[172:175]
    v_mfma_f32_16x16x32_bf16 v[176:179], v[44:47], v[248:251], v[176:179]
    v_mfma_f32_16x16x32_bf16 v[180:183], v[48:51], v[248:251], v[180:183]
p1_loopB0_p:
    s_waitcnt lgkmcnt(6)
    v_mfma_f32_32x32x16_bf16 v[72:87], v[56:59], v[52:55], v[72:87]
    ds_read_b128 v[32:35], v7 offset:1024
    ds_read_b64_tr_b16 v[36:37], v13 offset:14336
    ds_read_b64_tr_b16 v[38:39], v13 offset:16128
    ds_read_b64_tr_b16 v[40:41], v13 offset:14400
    ds_read_b64_tr_b16 v[42:43], v13 offset:16192
    ds_read_b64_tr_b16 v[44:45], v13 offset:14464
    ds_read_b64_tr_b16 v[46:47], v13 offset:16256
    ds_read_b64_tr_b16 v[48:49], v13 offset:14528
    s_waitcnt lgkmcnt(12)
    v_mfma_f32_32x32x16_bf16 v[88:103], v[60:63], v[52:55], v[88:103]
    ds_read_b64_tr_b16 v[50:51], v13 offset:16320
    v_lshlrev_b32 v19, 16, v52
    v_and_b32 v20, 0xffff0000, v52
    v_add_f32 v15, v15, v19
    v_fmac_f32 v16, v19, v19
    v_add_f32 v17, v17, v20
    v_fmac_f32 v18, v20, v20
    v_lshlrev_b32 v21, 16, v53
    s_waitcnt lgkmcnt(11)
    v_mfma_f32_32x32x16_bf16 v[104:119], v[64:67], v[52:55], v[104:119]
    s_mul_i32 s66, s57, 3584
    s_add_u32 m0, s51, 138240
    s_mov_b64 exec, s[64:65]
    buffer_load_dwordx4 v4, s[16:19], s66 offen lds
    s_add_u32 s66, s66, 7168
    s_add_u32 m0, s51, 139136
    s_nop 0
    buffer_load_dwordx4 v4, s[16:19], s66 offen lds
    s_mov_b64 exec, -1
    s_add_u32 s57, s57, 32
    s_and_b32 s57, s57, 511
    s_waitcnt lgkmcnt(9)
    v_mfma_f32_32x32x16_bf16 v[120:135], v[68:71], v[52:55], v[120:135]
    v_and_b32 v22, 0xffff0000, v53
    v_add_f32 v15, v15, v21
    v_fmac_f32 v16, v21, v21
    v_add_f32 v17, v17, v22
    v_fmac_f32 v18, v22, v22
    s_cmp_eq_u32 s45, 1
    s_cbranch_scc0 p1_loopB0_a0
    v_mfma_f32_16x16x32_bf16 v[168:171], v[56:59], v[248:251], v[168:171]
    v_mfma_f32_16x16x32_bf16 v[172:175], v[60:63], v[248:251], v[172:175]
    v_mfma_f32_16x16x32_bf16 v[176:179], v[64:67], v[248:251], v[176:179]
    v_mfma_f32_16x16x32_bf16 v[180:183], v[68:71], v[248:251], v[180:183]
p1_loopB0_a0:
    s_waitcnt lgkmcnt(6)
    v_mfma_f32_32x32x16_bf16 v[72:87], v[36:39], v[32:35], v[72:87]
    ds_read_b128 v[52:55], v8 offset:1024
    ds_read_b64_tr_b16 v[56:57], v13 offset:21504
    ds_read_b64_tr_b16 v[58:59], v13 offset:23296
    ds_read_b64_tr_b16 v[60:61], v13 offset:21568
    ds_read_b64_tr_b16 v[62:63], v13 offset:23360
    ds_read_b64_tr_b16 v[64:65], v13 offset:21632
    ds_read_b64_tr_b16 v[66:67], v13 offset:23424
    s_waitcnt lgkmcnt(11)
    v_mfma_f32_32x32x16_bf16 v[88:103], v[40:43], v[32:35], v[88:103]
    ds_read_b64_tr_b16 v[68:69], v13 offset:21696
    ds_read_b64_tr_b16 v[70:71], v13 offset:23488
    s_add_u32 m0, s50, 50176
    s_nop 0
    buffer_load_dwordx4 v2, s[8:11], s56 offen lds
    v_lshlrev_b32 v19, 16, v32
    v_and_b32 v20, 0xffff0000, v32
    v_add_f32 v15, v15, v19
    s_waitcnt lgkmcnt(11)
    v_mfma_f32_32x32x16_bf16 v[104:119], v[44:47], v[32:35], v[104:119]
    s_add_u32 m0, s50, 51200
    s_nop 0
    buffer_load_dwordx4 v3, s[8:11], s56 offen lds
    s_add_u32 s56, s56, 128
    s_and_b32 s56, s56, 1023
    v_fmac_f32 v16, v19, v19
    v_add_f32 v17, v17, v20
    v_fmac_f32 v18, v20, v20
    s_waitcnt lgkmcnt(9)
    v_mfma_f32_32x32x16_bf16 v[120:135], v[48:51], v[32:35], v[120:135]
    v_lshlrev_b32 v21, 16, v33
    v_and_b32 v22, 0xffff0000, v33
    v_add_f32 v15, v15, v21
    v_fmac_f32 v16, v21, v21
    v_add_f32 v17, v17, v22
    v_fmac_f32 v18, v22, v22
    s_cmp_eq_u32 s45, 2
    s_cbranch_scc0 p1_loopB0_b0
    v_mfma_f32_16x16x32_bf16 v[168:171], v[36:39], v[248:251], v[168:171]
    v_mfma_f32_16x16x32_bf16 v[172:175], v[40:43], v[248:251], v[172:175]
    v_mfma_f32_16x16x32_bf16 v[176:179], v[44:47], v[248:251], v[176:179]
    v_mfma_f32_16x16x32_bf16 v[180:183], v[48:51], v[248:251], v[180:183]
p1_loopB0_b0:
    s_waitcnt vmcnt(8) lgkmcnt(0)
    s_barrier
    v_mfma_f32_32x32x16_bf16 v[72:87], v[56:59], v[52:55], v[72:87]
    ds_read_b128 v[32:35], v5 offset:17408
    ds_read_b64_tr_b16 v[36:37], v13 offset:28672
    ds_read_b64_tr_b16 v[38:39], v13 offset:30464
    ds_read_b64_tr_b16 v[40:41], v13 offset:28736
    ds_read_b64_tr_b16 v[42:43], v13 offset:30528
    ds_read_b64_tr_b16 v[44:45], v13 offset:28800
    ds_read_b64_tr_b16 v[46:47], v13 offset:30592
    v_mfma_f32_32x32x16_bf16 v[88:103], v[60:63], v[52:55], v[88:103]
    ds_read_b64_tr_b16 v[48:49], v13 offset:28864
    ds_read_b64_tr_b16 v[50:51], v13 offset:30656
    s_add_u32 m0, s50, 1024
    s_nop 0
    buffer_load_dwordx4 v2, s[8:11], s56 offen lds
    v_lshlrev_b32 v19, 16, v52
    v_and_b32 v20, 0xffff0000, v52
    v_add_f32 v15, v15, v19
    v_mfma_f32_32x32x16_bf16 v[104:119], v[64:67], v[52:55], v[104:119]
    s_add_u32 m0, s50, 2048
    s_nop 0
    buffer_load_dwordx4 v3, s[8:11], s56 offen lds
    s_add_u32 s56, s56, 128
    s_and_b32 s56, s56, 1023
    v_fmac_f32 v16, v19, v19
    v_add_f32 v17, v17, v20
    v_fmac_f32 v18, v20, v20
    v_mfma_f32_32x32x16_bf16 v[120:135], v[68:71], v[52:55], v[120:135]
    v_lshlrev_b32 v21, 16, v53
    v_and_b32 v22, 0xffff0000, v53
    v_add_f32 v15, v15, v21
    v_fmac_f32 v16, v21, v21
    v_add_f32 v17, v17, v22
    v_fmac_f32 v18, v22, v22
    s_cmp_eq_u32 s45, 3
    s_cbranch_scc0 p1_loopB0_a1
    v_mfma_f32_16x16x32_bf16 v[168:171], v[56:59], v[248:251], v[168:171]
    v_mfma_f32_16x16x32_bf16 v[172:175], v[60:63], v[248:251], v[172:175]
    v_mfma_f32_16x16x32_bf16 v[176:179], v[64:67], v[248:251], v[176:179]
    v_mfma_f32_16x16x32_bf16 v[180:183], v[68:71], v[248:251], v[180:183]
p1_loopB0_a1:
    s_waitcnt lgkmcnt(6)
    v_mfma_f32_32x32x16_bf16 v[72:87], v[36:39], v[32:35], v[72:87]
    ds_read_b128 v[52:55], v6 offset:17408
    ds_read_b64_tr_b16 v[56:57], v13 offset:35840
    ds_read_b64_tr_b16 v[58:59], v13 offset:37632
    ds_read_b64_tr_b16 v[60:61], v13 offset:35904
    ds_read_b64_tr_b16 v[62:63], v13 offset:37696
    ds_read_b64_tr_b16 v[64:65], v13 offset:35968
    ds_read_b64_tr_b16 v[66:67], v13 offset:37760
    ds_read_b64_tr_b16 v[68:69], v13 offset:36032
    s_waitcnt lgkmcnt(12)
    v_mfma_f32_32x32x16_bf16 v[88:103], v[40:43], v[32:35], v[88:103]
    ds_read_b64_tr_b16 v[70:71], v13 offset:37824
    v_lshlrev_b32 v19, 16, v32
    v_and_b32 v20, 0xffff0000, v32
    v_add_f32 v15, v15, v19
    v_fmac_f32 v16, v19, v19
    v_add_f32 v17, v17, v20
    v_fmac_f32 v18, v20, v20
    v_lshlrev_b32 v21, 16, v33
    s_waitcnt lgkmcnt(11)
    v_mfma_f32_32x32x16_bf16 v[104:119], v[44:47], v[32:35], v[104:119]
    s_mul_i32 s66, s57, 3584
    s_add_u32 m0, s51, 66560
    s_mov_b64 exec, s[64:65]
    buffer_load_dwordx4 v4, s[16:19], s66 offen lds
    s_add_u32 s66, s66, 7168
    s_add_u32 m0, s51, 67456
    s_nop 0
    buffer_load_dwordx4 v4, s[16:19], s66 offen lds
    s_mov_b64 exec, -1
    s_add_u32 s57, s57, 32
    s_and_b32 s57, s57, 511
    s_waitcnt lgkmcnt(9)
    v_mfma_f32_32x32x16_bf16 v[120:135], v[48:51], v[32:35], v[120:135]
    v_and_b32 v22, 0xffff0000, v33
    v_add_f32 v15, v15, v21
    v_fmac_f32 v16, v21, v21
    v_add_f32 v17, v17, v22
    v_fmac_f32 v18, v22, v22
    s_cmp_eq_u32 s45, 0
    s_cbranch_scc0 p1_loopB0_b1
    v_mfma_f32_16x16x32_bf16 v[168:171], v[36:39], v[248:251], v[168:171]
    v_mfma_f32_16x16x32_bf16 v[172:175], v[40:43], v[248:251], v[172:175]
    v_mfma_f32_16x16x32_bf16 v[176:179], v[44:47], v[248:251], v[176:179]
    v_mfma_f32_16x16x32_bf16 v[180:183], v[48:51], v[248:251], v[180:183]
p1_loopB0_b1:
    s_waitcnt lgkmcnt(6)
    v_mfma_f32_32x32x16_bf16 v[72:87], v[56:59], v[52:55], v[72:87]
    ds_read_b128 v[32:35], v7 offset:17408
    ds_read_b64_tr_b16 v[36:37], v13 offset:43008
    ds_read_b64_tr_b16 v[38:39], v13 offset:44800
    ds_read_b64_tr_b16 v[40:41], v13 offset:43072
    ds_read_b64_tr_b16 v[42:43], v13 offset:44864
    ds_read_b64_tr_b16 v[44:45], v13 offset:43136
    ds_read_b64_tr_b16 v[46:47], v13 offset:44928
    ds_read_b64_tr_b16 v[48:49], v13 offset:43200
    s_waitcnt lgkmcnt(12)
    v_mfma_f32_32x32x16_bf16 v[88:103], v[60:63], v[52:55], v[88:103]
    ds_read_b64_tr_b16 v[50:51], v13 offset:44992
    v_lshlrev_b32 v19, 16, v52
    v_and_b32 v20, 0xffff0000, v52
    v_add_f32 v15, v15, v19
    v_fmac_f32 v16, v19, v19
    v_add_f32 v17, v17, v20
    v_fmac_f32 v18, v20, v20
    v_lshlrev_b32 v21, 16, v53
    s_waitcnt lgkmcnt(11)
    v_mfma_f32_32x32x16_bf16 v[104:119], v[64:67], v[52:55], v[104:119]
    s_mul_i32 s66, s57, 3584
    s_add_u32 m0, s51, 80896
    s_mov_b64 exec, s[64:65]
    buffer_load_dwordx4 v4, s[16:19], s66 offen lds
    s_add_u32 s66, s66, 7168
    s_add_u32 m0, s51, 81792
    s_nop 0
    buffer_load_dwordx4 v4, s[16:19], s66 offen lds
    s_mov_b64 exec, -1
    s_add_u32 s57, s57, 32
    s_and_b32 s57, s57, 511
    s_waitcnt lgkmcnt(9)
    v_mfma_f32_32x32x16_bf16 v[120:135], v[68:71], v[52:55], v[120:135]
    v_and_b32 v22, 0xffff0000, v53
    v_add_f32 v15, v15, v21
    v_fmac_f32 v16, v21, v21
    v_add_f32 v17, v17, v22
    v_fmac_f32 v18, v22, v22
    s_cmp_eq_u32 s45, 1
    s_cbranch_scc0 p1_loopB0_a2
    v_mfma_f32_16x16x32_bf16 v[168:171], v[56:59], v[248:251], v[168:171]
    v_mfma_f32_16x16x32_bf16 v[172:175], v[60:63], v[248:251], v[172:175]
    v_mfma_f32_16x16x32_bf16 v[176:179], v[64:67], v[248:251], v[176:179]
    v_mfma_f32_16x16x32_bf16 v[180:183], v[68:71], v[248:251], v[180:183]
p1_loopB0_a2:
    s_waitcnt lgkmcnt(6)
    v_mfma_f32_32x32x16_bf16 v[72:87], v[36:39], v[32:35], v[72:87]
    ds_read_b128 v[52:55], v8 offset:17408
    ds_read_b64_tr_b16 v[56:57], v13 offset:50176
    ds_read_b64_tr_b16 v[58:59], v13 offset:51968
    ds_read_b64_tr_b16 v[60:61], v13 offset:50240
    ds_read_b64_tr_b16 v[62:63], v13 offset:52032
    ds_read_b64_tr_b16 v[64:65], v13 offset:50304
    s_waitcnt lgkmcnt(10)
    v_mfma_f32_32x32x16_bf16 v[88:103], v[40:43], v[32:35], v[88:103]
    ds_read_b64_tr_b16 v[66:67], v13 offset:52096
    ds_read_b64_tr_b16 v[68:69], v13 offset:50368
    ds_read_b64_tr_b16 v[70:71], v13 offset:52160
    v_lshlrev_b32 v19, 16, v32
    v_and_b32 v20, 0xffff0000, v32
    v_add_f32 v15, v15, v19
    s_waitcnt lgkmcnt(11)
    v_mfma_f32_32x32x16_bf16 v[104:119], v[44:47], v[32:35], v[104:119]
    v_fmac_f32 v16, v19, v19
    v_add_f32 v17, v17, v20
    v_fmac_f32 v18, v20, v20
    v_lshlrev_b32 v21, 16, v33
    v_and_b32 v22, 0xffff0000, v33
    v_add_f32 v15, v15, v21
    s_waitcnt lgkmcnt(9)
    v_mfma_f32_32x32x16_bf16 v[120:135], v[48:51], v[32:35], v[120:135]
    v_fmac_f32 v16, v21, v21
    v_add_f32 v17, v17, v22
    v_fmac_f32 v18, v22, v22
    s_cmp_eq_u32 s45, 2
    s_cbranch_scc0 p1_loopB0_b2
    v_mfma_f32_16x16x32_bf16 v[168:171], v[36:39], v[248:251], v[168:171]
    v_mfma_f32_16x16x32_bf16 v[172:175], v[40:43], v[248:251], v[172:175]
    v_mfma_f32_16x16x32_bf16 v[176:179], v[44:47], v[248:251], v[176:179]
    v_mfma_f32_16x16x32_bf16 v[180:183], v[48:51], v[248:251], v[180:183]
p1_loopB0_b2:
    s_waitcnt vmcnt(8) lgkmcnt(0)
    s_barrier
    v_mfma_f32_32x32x16_bf16 v[72:87], v[56:59], v[52:55], v[72:87]
    ds_read_b128 v[32:35], v5 offset:33792
    ds_read_b64_tr_b16 v[36:37], v14 offset:0
    ds_read_b64_tr_b16 v[38:39], v14 offset:1792
    ds_read_b64_tr_b16 v[40:41], v14 offset:64
    ds_read_b64_tr_b16 v[42:43], v14 offset:1856
    ds_read_b64_tr_b16 v[44:45], v14 offset:128
    ds_read_b64_tr_b16 v[46:47], v14 offset:1920
    v_mfma_f32_32x32x16_bf16 v[88:103], v[60:63], v[52:55], v[88:103]
    ds_read_b64_tr_b16 v[48:49], v14 offset:192
    ds_read_b64_tr_b16 v[50:51], v14 offset:1984
    s_add_u32 m0, s50, 17408
    s_nop 0
    buffer_load_dwordx4 v2, s[8:11], s56 offen lds
    v_lshlrev_b32 v19, 16, v52
    v_and_b32 v20, 0xffff0000, v52
    v_add_f32 v15, v15, v19
    v_mfma_f32_32x32x16_bf16 v[104:119], v[64:67], v[52:55], v[104:119]
    s_add_u32 m0, s50, 18432
    s_nop 0
    buffer_load_dwordx4 v3, s[8:11], s56 offen lds
    s_add_u32 s56, s56, 128
    s_and_b32 s56, s56, 1023
    v_fmac_f32 v16, v19, v19
    v_add_f32 v17, v17, v20
    v_fmac_f32 v18, v20, v20
    v_mfma_f32_32x32x16_bf16 v[120:135], v[68:71], v[52:55], v[120:135]
    v_lshlrev_b32 v21, 16, v53
    v_and_b32 v22, 0xffff0000, v53
    v_add_f32 v15, v15, v21
    v_fmac_f32 v16, v21, v21
    v_add_f32 v17, v17, v22
    v_fmac_f32 v18, v22, v22
    s_cmp_eq_u32 s45, 3
    s_cbranch_scc0 p1_loopB0_a3
    v_mfma_f32_16x16x32_bf16 v[168:171], v[56:59], v[248:251], v[168:171]
    v_mfma_f32_16x16x32_bf16 v[172:175], v[60:63], v[248:251], v[172:175]
    v_mfma_f32_16x16x32_bf16 v[176:179], v[64:67], v[248:251], v[176:179]
    v_mfma_f32_16x16x32_bf16 v[180:183], v[68:71], v[248:251], v[180:183]
p1_loopB0_a3:
    s_waitcnt lgkmcnt(6)
    v_mfma_f32_32x32x16_bf16 v[72:87], v[36:39], v[32:35], v[72:87]
    ds_read_b128 v[52:55], v6 offset:33792
    ds_read_b64_tr_b16 v[56:57], v14 offset:7168
    ds_read_b64_tr_b16 v[58:59], v14 offset:8960
    ds_read_b64_tr_b16 v[60:61], v14 offset:7232
    ds_read_b64_tr_b16 v[62:63], v14 offset:9024
    ds_read_b64_tr_b16 v[64:65], v14 offset:7296
    ds_read_b64_tr_b16 v[66:67], v14 offset:9088
    ds_read_b64_tr_b16 v[68:69], v14 offset:7360
    s_waitcnt lgkmcnt(12)
    v_mfma_f32_32x32x16_bf16 v[88:103], v[40:43], v[32:35], v[88:103]
    ds_read_b64_tr_b16 v[70:71], v14 offset:9152
    v_lshlrev_b32 v19, 16, v32
    v_and_b32 v20, 0xffff0000, v32
    v_add_f32 v15, v15, v19
    v_fmac_f32 v16, v19, v19
    v_add_f32 v17, v17, v20
    v_fmac_f32 v18, v20, v20
    v_lshlrev_b32 v21, 16, v33
    s_waitcnt lgkmcnt(11)
    v_mfma_f32_32x32x16_bf16 v[104:119], v[44:47], v[32:35], v[104:119]
    s_mul_i32 s66, s57, 3584
    s_add_u32 m0, s51, 95232
    s_mov_b64 exec, s[64:65]
    buffer_load_dwordx4 v4, s[16:19], s66 offen lds
    s_add_u32 s66, s66, 7168
    s_add_u32 m0, s51, 96128
    s_nop 0
    buffer_load_dwordx4 v4, s[16:19], s66 offen lds
    s_mov_b64 exec, -1
    s_add_u32 s57, s57, 32
    s_and_b32 s57, s57, 511
    s_waitcnt lgkmcnt(9)
    v_mfma_f32_32x32x16_bf16 v[120:135], v[48:51], v[32:35], v[120:135]
    v_and_b32 v22, 0xffff0000, v33
    v_add_f32 v15, v15, v21
    v_fmac_f32 v16, v21, v21
    v_add_f32 v17, v17, v22
    v_fmac_f32 v18, v22, v22
    s_cmp_eq_u32 s45, 0
    s_cbranch_scc0 p1_loopB0_b3
    v_mfma_f32_16x16x32_bf16 v[168:171], v[36:39], v[248:251], v[168:171]
    v_mfma_f32_16x16x32_bf16 v[172:175], v[40:43], v[248:251], v[172:175]
    v_mfma_f32_16x16x32_bf16 v[176:179], v[44:47], v[248:251], v[176:179]
    v_mfma_f32_16x16x32_bf16 v[180:183], v[48:51], v[248:251], v[180:183]
p1_loopB0_b3:
    s_waitcnt lgkmcnt(6)
    v_mfma_f32_32x32x16_bf16 v[72:87], v[56:59], v[52:55], v[72:87]
    ds_read_b128 v[32:35], v7 offset:33792
    ds_read_b64_tr_b16 v[36:37], v14 offset:14336
    ds_read_b64_tr_b16 v[38:39], v14 offset:16128
    ds_read_b64_tr_b16 v[40:41], v14 offset:14400
    ds_read_b64_tr_b16 v[42:43], v14 offset:16192
    ds_read_b64_tr_b16 v[44:45], v14 offset:14464
    ds_read_b64_tr_b16 v[46:47], v14 offset:16256
    ds_read_b64_tr_b16 v[48:49], v14 offset:14528
    s_waitcnt lgkmcnt(12)
    v_mfma_f32_32x32x16_bf16 v[88:103], v[60:63], v[52:55], v[88:103]
    ds_read_b64_tr_b16 v[50:51], v14 offset:16320
    v_lshlrev_b32 v19, 16, v52
    v_and_b32 v20, 0xffff0000, v52
    v_add_f32 v15, v15, v19
    v_fmac_f32 v16, v19, v19
    v_add_f32 v17, v17, v20
    v_fmac_f32 v18, v20, v20
    v_lshlrev_b32 v21, 16, v53
    s_waitcnt lgkmcnt(11)
    v_mfma_f32_32x32x16_bf16 v[104:119], v[64:67], v[52:55], v[104:119]
    s_mul_i32 s66, s57, 3584
    s_add_u32 m0, s51, 109568
    s_mov_b64 exec, s[64:65]
    buffer_load_dwordx4 v4, s[16:19], s66 offen lds
    s_add_u32 s66, s66, 7168
    s_add_u32 m0, s51, 110464
    s_nop 0
    buffer_load_dwordx4 v4, s[16:19], s66 offen lds
    s_mov_b64 exec, -1
    s_add_u32 s57, s57, 32
    s_and_b32 s57, s57, 511
    s_waitcnt lgkmcnt(9)
    v_mfma_f32_32x32x16_bf16 v[120:135], v[68:71], v[52:55], v[120:135]
    v_and_b32 v22, 0xffff0000, v53
    v_add_f32 v15, v15, v21
    v_fmac_f32 v16, v21, v21
    v_add_f32 v17, v17, v22
    v_fmac_f32 v18, v22, v22
    s_cmp_eq_u32 s45, 1
    s_cbranch_scc0 p1_loopB0_a4
    v_mfma_f32_16x16x32_bf16 v[168:171], v[56:59], v[248:251], v[168:171]
    v_mfma_f32_16x16x32_bf16 v[172:175], v[60:63], v[248:251], v[172:175]
    v_mfma_f32_16x16x32_bf16 v[176:179], v[64:67], v[248:251], v[176:179]
    v_mfma_f32_16x16x32_bf16 v[180:183], v[68:71], v[248:251], v[180:183]
p1_loopB0_a4:
    s_waitcnt lgkmcnt(6)
    v_mfma_f32_32x32x16_bf16 v[72:87], v[36:39], v[32:35], v[72:87]
    ds_read_b128 v[52:55], v8 offset:33792
    ds_read_b64_tr_b16 v[56:57], v14 offset:21504
    ds_read_b64_tr_b16 v[58:59], v14 offset:23296
    ds_read_b64_tr_b16 v[60:61], v14 offset:21568
    ds_read_b64_tr_b16 v[62:63], v14 offset:23360
    ds_read_b64_tr_b16 v[64:65], v14 offset:21632
    s_waitcnt lgkmcnt(10)
    v_mfma_f32_32x32x16_bf16 v[88:103], v[40:43], v[32:35], v[88:103]
    ds_read_b64_tr_b16 v[66:67], v14 offset:23424
    ds_read_b64_tr_b16 v[68:69], v14 offset:21696
    ds_read_b64_tr_b16 v[70:71], v14 offset:23488
    v_lshlrev_b32 v19, 16, v32
    v_and_b32 v20, 0xffff0000, v32
    v_add_f32 v15, v15, v19
    s_waitcnt lgkmcnt(11)
    v_mfma_f32_32x32x16_bf16 v[104:119], v[44:47], v[32:35], v[104:119]
    v_fmac_f32 v16, v19, v19
    v_add_f32 v17, v17, v20
    v_fmac_f32 v18, v20, v20
    v_lshlrev_b32 v21, 16, v33
    v_and_b32 v22, 0xffff0000, v33
    v_add_f32 v15, v15, v21
    s_waitcnt lgkmcnt(9)
    v_mfma_f32_32x32x16_bf16 v[120:135], v[48:51], v[32:35], v[120:135]
    v_fmac_f32 v16, v21, v21
    v_add_f32 v17, v17, v22
    v_fmac_f32 v18, v22, v22
    s_cmp_eq_u32 s45, 2
    s_cbranch_scc0 p1_loopB0_b4
    v_mfma_f32_16x16x32_bf16 v[168:171], v[36:39], v[248:251], v[168:171]
    v_mfma_f32_16x16x32_bf16 v[172:175], v[40:43], v[248:251], v[172:175]
    v_mfma_f32_16x16x32_bf16 v[176:179], v[44:47], v[248:251], v[176:179]
    v_mfma_f32_16x16x32_bf16 v[180:183], v[48:51], v[248:251], v[180:183]
p1_loopB0_b4:
    s_waitcnt vmcnt(6) lgkmcnt(0)
    s_barrier
    v_mfma_f32_32x32x16_bf16 v[72:87], v[56:59], v[52:55], v[72:87]
    ds_read_b128 v[32:35], v5 offset:50176
    ds_read_b64_tr_b16 v[36:37], v13 offset:0
    ds_read_b64_tr_b16 v[38:39], v13 offset:1792
    ds_read_b64_tr_b16 v[40:41], v13 offset:64
    ds_read_b64_tr_b16 v[42:43], v13 offset:1856
    ds_read_b64_tr_b16 v[44:45], v13 offset:128
    ds_read_b64_tr_b16 v[46:47], v13 offset:1920
    v_mfma_f32_32x32x16_bf16 v[88:103], v[60:63], v[52:55], v[88:103]
    ds_read_b64_tr_b16 v[48:49], v13 offset:192
    ds_read_b64_tr_b16 v[50:51], v13 offset:1984
    s_add_u32 m0, s50, 33792
    s_nop 0
    buffer_load_dwordx4 v2, s[8:11], s56 offen lds
    v_lshlrev_b32 v19, 16, v52
    v_and_b32 v20, 0xffff0000, v52
    v_add_f32 v15, v15, v19
    v_mfma_f32_32x32x16_bf16 v[104:119], v[64:67], v[52:55], v[104:119]
    s_add_u32 m0, s50, 34816
    s_nop 0
    buffer_load_dwordx4 v3, s[8:11], s56 offen lds
    s_add_u32 s56, s56, 128
    s_and_b32 s56, s56, 1023
    v_fmac_f32 v16, v19, v19
    v_add_f32 v17, v17, v20
    v_fmac_f32 v18, v20, v20
    v_mfma_f32_32x32x16_bf16 v[120:135], v[68:71], v[52:55], v[120:135]
    v_lshlrev_b32 v21, 16, v53
    v_and_b32 v22, 0xffff0000, v53
    v_add_f32 v15, v15, v21
    v_fmac_f32 v16, v21, v21
    v_add_f32 v17, v17, v22
    v_fmac_f32 v18, v22, v22
    s_cmp_eq_u32 s45, 3
    s_cbranch_scc0 p1_loopB0_a5
    v_mfma_f32_16x16x32_bf16 v[168:171], v[56:59], v[248:251], v[168:171]
    v_mfma_f32_16x16x32_bf16 v[172:175], v[60:63], v[248:251], v[172:175]
    v_mfma_f32_16x16x32_bf16 v[176:179], v[64:67], v[248:251], v[176:179]
    v_mfma_f32_16x16x32_bf16 v[180:183], v[68:71], v[248:251], v[180:183]
p1_loopB0_a5:
    s_waitcnt lgkmcnt(6)
    v_mfma_f32_32x32x16_bf16 v[72:87], v[36:39], v[32:35], v[72:87]
    ds_read_b128 v[52:55], v6 offset:50176
    ds_read_b64_tr_b16 v[56:57], v13 offset:7168
    ds_read_b64_tr_b16 v[58:59], v13 offset:8960
    ds_read_b64_tr_b16 v[60:61], v13 offset:7232
    ds_read_b64_tr_b16 v[62:63], v13 offset:9024
    ds_read_b64_tr_b16 v[64:65], v13 offset:7296
    ds_read_b64_tr_b16 v[66:67], v13 offset:9088
    ds_read_b64_tr_b16 v[68:69], v13 offset:7360
    s_waitcnt lgkmcnt(12)
    v_mfma_f32_32x32x16_bf16 v[88:103], v[40:43], v[32:35], v[88:103]
    ds_read_b64_tr_b16 v[70:71], v13 offset:9152
    v_lshlrev_b32 v19, 16, v32
    v_and_b32 v20, 0xffff0000, v32
    v_add_f32 v15, v15, v19
    v_fmac_f32 v16, v19, v19
    v_add_f32 v17, v17, v20
    v_fmac_f32 v18, v20, v20
    v_lshlrev_b32 v21, 16, v33
    s_waitcnt lgkmcnt(11)
    v_mfma_f32_32x32x16_bf16 v[104:119], v[44:47], v[32:35], v[104:119]
    s_mul_i32 s66, s57, 3584
    s_add_u32 m0, s51, 123904
    s_mov_b64 exec, s[64:65]
    buffer_load_dwordx4 v4, s[16:19], s66 offen lds
    s_add_u32 s66, s66, 7168
    s_add_u32 m0, s51, 124800
    s_nop 0
    buffer_load_dwordx4 v4, s[16:19], s66 offen lds
    s_mov_b64 exec, -1
    s_add_u32 s57, s57, 32
    s_and_b32 s57, s57, 511
    s_waitcnt lgkmcnt(9)
    v_mfma_f32_32x32x16_bf16 v[120:135], v[48:51], v[32:35], v[120:135]
    v_and_b32 v22, 0xffff0000, v33
    v_add_f32 v15, v15, v21
    v_fmac_f32 v16, v21, v21
    v_add_f32 v17, v17, v22
    v_fmac_f32 v18, v22, v22
    s_cmp_eq_u32 s45, 0
    s_cbranch_scc0 p1_loopB0_b5
    v_mfma_f32_16x16x32_bf16 v[168:171], v[36:39], v[248:251], v[168:171]
    v_mfma_f32_16x16x32_bf16 v[172:175], v[40:43], v[248:251], v[172:175]
    v_mfma_f32_16x16x32_bf16 v[176:179], v[44:47], v[248:251], v[176:179]
    v_mfma_f32_16x16x32_bf16 v[180:183], v[48:51], v[248:251], v[180:183]
p1_loopB0_b5:
    s_waitcnt lgkmcnt(6)
    v_mfma_f32_32x32x16_bf16 v[72:87], v[56:59], v[52:55], v[72:87]
    ds_read_b128 v[32:35], v7 offset:50176
    ds_read_b64_tr_b16 v[36:37], v13 offset:14336
    ds_read_b64_tr_b16 v[38:39], v13 offset:16128
    ds_read_b64_tr_b16 v[40:41], v13 offset:14400
    ds_read_b64_tr_b16 v[42:43], v13 offset:16192
    ds_read_b64_tr_b16 v[44:45], v13 offset:14464
    ds_read_b64_tr_b16 v[46:47], v13 offset:16256
    ds_read_b64_tr_b16 v[48:49], v13 offset:14528
    s_waitcnt lgkmcnt(12)
    v_mfma_f32_32x32x16_bf16 v[88:103], v[60:63], v[52:55], v[88:103]
    ds_read_b64_tr_b16 v[50:51], v13 offset:16320
    v_lshlrev_b32 v19, 16, v52
    v_and_b32 v20, 0xffff0000, v52
    v_add_f32 v15, v15, v19
    v_fmac_f32 v16, v19, v19
    v_add_f32 v17, v17, v20
    v_fmac_f32 v18, v20, v20
    v_lshlrev_b32 v21, 16, v53
    s_waitcnt lgkmcnt(11)
    v_mfma_f32_32x32x16_bf16 v[104:119], v[64:67], v[52:55], v[104:119]
    s_mul_i32 s66, s57, 3584
    s_add_u32 m0, s51, 138240
    s_mov_b64 exec, s[64:65]
    buffer_load_dwordx4 v4, s[16:19], s66 offen lds
    s_add_u32 s66, s66, 7168
    s_add_u32 m0, s51, 139136
    s_nop 0
    buffer_load_dwordx4 v4, s[16:19], s66 offen lds
    s_mov_b64 exec, -1
    s_add_u32 s57, s57, 32
    s_and_b32 s57, s57, 511
    s_waitcnt lgkmcnt(9)
    v_mfma_f32_32x32x16_bf16 v[120:135], v[68:71], v[52:55], v[120:135]
    v_and_b32 v22, 0xffff0000, v53
    v_add_f32 v15, v15, v21
    v_fmac_f32 v16, v21, v21
    v_add_f32 v17, v17, v22
    v_fmac_f32 v18, v22, v22
    s_cmp_eq_u32 s45, 1
    s_cbranch_scc0 p1_loopB0_a6
    v_mfma_f32_16x16x32_bf16 v[168:171], v[56:59], v[248:251], v[168:171]
    v_mfma_f32_16x16x32_bf16 v[172:175], v[60:63], v[248:251], v[172:175]
    v_mfma_f32_16x16x32_bf16 v[176:179], v[64:67], v[248:251], v[176:179]
    v_mfma_f32_16x16x32_bf16 v[180:183], v[68:71], v[248:251], v[180:183]
p1_loopB0_a6:
    s_waitcnt lgkmcnt(6)
    v_mfma_f32_32x32x16_bf16 v[72:87], v[36:39], v[32:35], v[72:87]
    ds_read_b128 v[52:55], v8 offset:50176
    ds_read_b64_tr_b16 v[56:57], v13 offset:21504
    ds_read_b64_tr_b16 v[58:59], v13 offset:23296
    ds_read_b64_tr_b16 v[60:61], v13 offset:21568
    ds_read_b64_tr_b16 v[62:63], v13 offset:23360
    ds_read_b64_tr_b16 v[64:65], v13 offset:21632
    s_waitcnt lgkmcnt(10)
    v_mfma_f32_32x32x16_bf16 v[88:103], v[40:43], v[32:35], v[88:103]
    ds_read_b64_tr_b16 v[66:67], v13 offset:23424
    ds_read_b64_tr_b16 v[68:69], v13 offset:21696
    ds_read_b64_tr_b16 v[70:71], v13 offset:23488
    v_lshlrev_b32 v19, 16, v32
    v_and_b32 v20, 0xffff0000, v32
    v_add_f32 v15, v15, v19
    s_waitcnt lgkmcnt(11)
    v_mfma_f32_32x32x16_bf16 v[104:119], v[44:47], v[32:35], v[104:119]
    v_fmac_f32 v16, v19, v19
    v_add_f32 v17, v17, v20
    v_fmac_f32 v18, v20, v20
    v_lshlrev_b32 v21, 16, v33
    v_and_b32 v22, 0xffff0000, v33
    v_add_f32 v15, v15, v21
    s_waitcnt lgkmcnt(9)
    v_mfma_f32_32x32x16_bf16 v[120:135], v[48:51], v[32:35], v[120:135]
    v_fmac_f32 v16, v21, v21
    v_add_f32 v17, v17, v22
    v_fmac_f32 v18, v22, v22
    s_cmp_eq_u32 s45, 2
    s_cbranch_scc0 p1_loopB0_b6
    v_mfma_f32_16x16x32_bf16 v[168:171], v[36:39], v[248:251], v[168:171]
    v_mfma_f32_16x16x32_bf16 v[172:175], v[40:43], v[248:251], v[172:175]
    v_mfma_f32_16x16x32_bf16 v[176:179], v[44:47], v[248:251], v[176:179]
    v_mfma_f32_16x16x32_bf16 v[180:183], v[48:51], v[248:251], v[180:183]
p1_loopB0_b6:
    s_waitcnt vmcnt(6) lgkmcnt(0)
    s_barrier
    v_mfma_f32_32x32x16_bf16 v[72:87], v[56:59], v[52:55], v[72:87]
    ds_read_b128 v[32:35], v5 offset:1024
    ds_read_b64_tr_b16 v[36:37], v13 offset:28672
    ds_read_b64_tr_b16 v[38:39], v13 offset:30464
    ds_read_b64_tr_b16 v[40:41], v13 offset:28736
    ds_read_b64_tr_b16 v[42:43], v13 offset:30528
    ds_read_b64_tr_b16 v[44:45], v13 offset:28800
    ds_read_b64_tr_b16 v[46:47], v13 offset:30592
    v_mfma_f32_32x32x16_bf16 v[88:103], v[60:63], v[52:55], v[88:103]
    ds_read_b64_tr_b16 v[48:49], v13 offset:28864
    ds_read_b64_tr_b16 v[50:51], v13 offset:30656
    s_add_u32 m0, s50, 50176
    s_nop 0
    buffer_load_dwordx4 v2, s[8:11], s56 offen lds
    v_lshlrev_b32 v19, 16, v52
    v_and_b32 v20, 0xffff0000, v52
    v_add_f32 v15, v15, v19
    v_mfma_f32_32x32x16_bf16 v[104:119], v[64:67], v[52:55], v[104:119]
    s_add_u32 m0, s50, 51200
    s_nop 0
    buffer_load_dwordx4 v3, s[8:11], s56 offen lds
    s_add_u32 s56, s56, 128
    s_and_b32 s56, s56, 1023
    v_fmac_f32 v16, v19, v19
    v_add_f32 v17, v17, v20
    v_fmac_f32 v18, v20, v20
    v_mfma_f32_32x32x16_bf16 v[120:135], v[68:71], v[52:55], v[120:135]
    v_lshlrev_b32 v21, 16, v53
    v_and_b32 v22, 0xffff0000, v53
    v_add_f32 v15, v15, v21
    v_fmac_f32 v16, v21, v21
    v_add_f32 v17, v17, v22
    v_fmac_f32 v18, v22, v22
    s_cmp_eq_u32 s45, 3
    s_cbranch_scc0 p1_loopB0_a7
    v_mfma_f32_16x16x32_bf16 v[168:171], v[56:59], v[248:251], v[168:171]
    v_mfma_f32_16x16x32_bf16 v[172:175], v[60:63], v[248:251], v[172:175]
    v_mfma_f32_16x16x32_bf16 v[176:179], v[64:67], v[248:251], v[176:179]
    v_mfma_f32_16x16x32_bf16 v[180:183], v[68:71], v[248:251], v[180:183]
p1_loopB0_a7:
    s_waitcnt lgkmcnt(6)
    v_mfma_f32_32x32x16_bf16 v[72:87], v[36:39], v[32:35], v[72:87]
    ds_read_b128 v[52:55], v6 offset:1024
    ds_read_b64_tr_b16 v[56:57], v13 offset:35840
    ds_read_b64_tr_b16 v[58:59], v13 offset:37632
    ds_read_b64_tr_b16 v[60:61], v13 offset:35904
    ds_read_b64_tr_b16 v[62:63], v13 offset:37696
    ds_read_b64_tr_b16 v[64:65], v13 offset:35968
    ds_read_b64_tr_b16 v[66:67], v13 offset:37760
    ds_read_b64_tr_b16 v[68:69], v13 offset:36032
    s_waitcnt lgkmcnt(12)
    v_mfma_f32_32x32x16_bf16 v[88:103], v[40:43], v[32:35], v[88:103]
    ds_read_b64_tr_b16 v[70:71], v13 offset:37824
    v_lshlrev_b32 v19, 16, v32
    v_and_b32 v20, 0xffff0000, v32
    v_add_f32 v15, v15, v19
    v_fmac_f32 v16, v19, v19
    v_add_f32 v17, v17, v20
    v_fmac_f32 v18, v20, v20
    v_lshlrev_b32 v21, 16, v33
    s_waitcnt lgkmcnt(11)
    v_mfma_f32_32x32x16_bf16 v[104:119], v[44:47], v[32:35], v[104:119]
    s_mul_i32 s66, s57, 3584
    s_add_u32 m0, s51, 66560
    s_mov_b64 exec, s[64:65]
    buffer_load_dwordx4 v4, s[16:19], s66 offen lds
    s_add_u32 s66, s66, 7168
    s_add_u32 m0, s51, 67456
    s_nop 0
    buffer_load_dwordx4 v4, s[16:19], s66 offen lds
    s_mov_b64 exec, -1
    s_add_u32 s57, s57, 32
    s_and_b32 s57, s57, 511
    s_waitcnt lgkmcnt(9)
    v_mfma_f32_32x32x16_bf16 v[120:135], v[48:51], v[32:35], v[120:135]
    v_and_b32 v22, 0xffff0000, v33
    v_add_f32 v15, v15, v21
    v_fmac_f32 v16, v21, v21
    v_add_f32 v17, v17, v22
    v_fmac_f32 v18, v22, v22
    s_cmp_eq_u32 s45, 0
    s_cbranch_scc0 p1_loopB0_b7
    v_mfma_f32_16x16x32_bf16 v[168:171], v[36:39], v[248:251], v[168:171]
    v_mfma_f32_16x16x32_bf16 v[172:175], v[40:43], v[248:251], v[172:175]
    v_mfma_f32_16x16x32_bf16 v[176:179], v[44:47], v[248:251], v[176:179]
    v_mfma_f32_16x16x32_bf16 v[180:183], v[48:51], v[248:251], v[180:183]
p1_loopB0_b7:
    s_waitcnt lgkmcnt(6)
    v_mfma_f32_32x32x16_bf16 v[72:87], v[56:59], v[52:55], v[72:87]
    ds_read_b128 v[32:35], v7 offset:1024
    ds_read_b64_tr_b16 v[36:37], v13 offset:43008
    ds_read_b64_tr_b16 v[38:39], v13 offset:44800
    ds_read_b64_tr_b16 v[40:41], v13 offset:43072
    ds_read_b64_tr_b16 v[42:43], v13 offset:44864
    ds_read_b64_tr_b16 v[44:45], v13 offset:43136
    ds_read_b64_tr_b16 v[46:47], v13 offset:44928
    ds_read_b64_tr_b16 v[48:49], v13 offset:43200
    s_waitcnt lgkmcnt(12)
    v_mfma_f32_32x32x16_bf16 v[88:103], v[60:63], v[52:55], v[88:103]
    ds_read_b64_tr_b16 v[50:51], v13 offset:44992
    v_lshlrev_b32 v19, 16, v52
    v_and_b32 v20, 0xffff0000, v52
    v_add_f32 v15, v15, v19
    v_fmac_f32 v16, v19, v19
    v_add_f32 v17, v17, v20
    v_fmac_f32 v18, v20, v20
    v_lshlrev_b32 v21, 16, v53
    s_waitcnt lgkmcnt(11)
    v_mfma_f32_32x32x16_bf16 v[104:119], v[64:67], v[52:55], v[104:119]
    s_mul_i32 s66, s57, 3584
    s_add_u32 m0, s51, 80896
    s_mov_b64 exec, s[64:65]
    buffer_load_dwordx4 v4, s[16:19], s66 offen lds
    s_add_u32 s66, s66, 7168
    s_add_u32 m0, s51, 81792
    s_nop 0
    buffer_load_dwordx4 v4, s[16:19], s66 offen lds
    s_mov_b64 exec, -1
    s_add_u32 s57, s57, 32
    s_and_b32 s57, s57, 511
    s_waitcnt lgkmcnt(9)
    v_mfma_f32_32x32x16_bf16 v[120:135], v[68:71], v[52:55], v[120:135]
    v_and_b32 v22, 0xffff0000, v53
    v_add_f32 v15, v15, v21
    v_fmac_f32 v16, v21, v21
    v_add_f32 v17, v17, v22
    v_fmac_f32 v18, v22, v22
    s_cmp_eq_u32 s45, 1
    s_cbranch_scc0 p1_loopB0_a8
    v_mfma_f32_16x16x32_bf16 v[168:171], v[56:59], v[248:251], v[168:171]
    v_mfma_f32_16x16x32_bf16 v[172:175], v[60:63], v[248:251], v[172:175]
    v_mfma_f32_16x16x32_bf16 v[176:179], v[64:67], v[248:251], v[176:179]
    v_mfma_f32_16x16x32_bf16 v[180:183], v[68:71], v[248:251], v[180:183]
p1_loopB0_a8:
    s_waitcnt lgkmcnt(6)
    v_mfma_f32_32x32x16_bf16 v[72:87], v[36:39], v[32:35], v[72:87]
    ds_read_b128 v[52:55], v8 offset:1024
    ds_read_b64_tr_b16 v[56:57], v13 offset:50176
    ds_read_b64_tr_b16 v[58:59], v13 offset:51968
    ds_read_b64_tr_b16 v[60:61], v13 offset:50240
    ds_read_b64_tr_b16 v[62:63], v13 offset:52032
    ds_read_b64_tr_b16 v[64:65], v13 offset:50304
    ds_read_b64_tr_b16 v[66:67], v13 offset:52096
    s_waitcnt lgkmcnt(11)
    v_mfma_f32_32x32x16_bf16 v[88:103], v[40:43], v[32:35], v[88:103]
    ds_read_b64_tr_b16 v[68:69], v13 offset:50368
    ds_read_b64_tr_b16 v[70:71], v13 offset:52160
    s_add_u32 s66, s73, 98304
    buffer_load_dwordx4 v[184:187], v252, s[28:31], s66 offen
    s_add_u32 s66, s73, 106496
    buffer_load_dwordx4 v[188:191], v252, s[28:31], s66 offen
    v_lshlrev_b32 v19, 16, v32
    s_waitcnt lgkmcnt(11)
    v_mfma_f32_32x32x16_bf16 v[104:119], v[44:47], v[32:35], v[104:119]
    s_add_u32 s66, s73, 114688
    buffer_load_dwordx4 v[192:195], v252, s[28:31], s66 offen
    v_and_b32 v20, 0xffff0000, v32
    v_add_f32 v15, v15, v19
    v_fmac_f32 v16, v19, v19
    v_add_f32 v17, v17, v20
    v_fmac_f32 v18, v20, v20
    s_waitcnt lgkmcnt(9)
    v_mfma_f32_32x32x16_bf16 v[120:135], v[48:51], v[32:35], v[120:135]
    v_lshlrev_b32 v21, 16, v33
    v_and_b32 v22, 0xffff0000, v33
    v_add_f32 v15, v15, v21
    v_fmac_f32 v16, v21, v21
    v_add_f32 v17, v17, v22
    v_fmac_f32 v18, v22, v22
    s_cmp_eq_u32 s45, 2
    s_cbranch_scc0 p1_loopB0_b8
    v_mfma_f32_16x16x32_bf16 v[168:171], v[36:39], v[248:251], v[168:171]
    v_mfma_f32_16x16x32_bf16 v[172:175], v[40:43], v[248:251], v[172:175]
    v_mfma_f32_16x16x32_bf16 v[176:179], v[44:47], v[248:251], v[176:179]
    v_mfma_f32_16x16x32_bf16 v[180:183], v[48:51], v[248:251], v[180:183]
p1_loopB0_b8:
    s_waitcnt vmcnt(9) lgkmcnt(0)
    s_barrier
    v_mfma_f32_32x32x16_bf16 v[72:87], v[56:59], v[52:55], v[72:87]
    ds_read_b128 v[32:35], v5 offset:17408
    ds_read_b64_tr_b16 v[36:37], v14 offset:0
    ds_read_b64_tr_b16 v[38:39], v14 offset:1792
    ds_read_b64_tr_b16 v[40:41], v14 offset:64
    ds_read_b64_tr_b16 v[42:43], v14 offset:1856
    ds_read_b64_tr_b16 v[44:45], v14 offset:128
    v_mfma_f32_32x32x16_bf16 v[88:103], v[60:63], v[52:55], v[88:103]
    ds_read_b64_tr_b16 v[46:47], v14 offset:1920
    ds_read_b64_tr_b16 v[48:49], v14 offset:192
    ds_read_b64_tr_b16 v[50:51], v14 offset:1984
    v_lshlrev_b32 v19, 16, v52
    v_and_b32 v20, 0xffff0000, v52
    v_add_f32 v15, v15, v19
    v_mfma_f32_32x32x16_bf16 v[104:119], v[64:67], v[52:55], v[104:119]
    v_fmac_f32 v16, v19, v19
    v_add_f32 v17, v17, v20
    v_fmac_f32 v18, v20, v20
    v_lshlrev_b32 v21, 16, v53
    v_and_b32 v22, 0xffff0000, v53
    v_add_f32 v15, v15, v21
    v_mfma_f32_32x32x16_bf16 v[120:135], v[68:71], v[52:55], v[120:135]
    v_fmac_f32 v16, v21, v21
    v_add_f32 v17, v17, v22
    v_fmac_f32 v18, v22, v22
    s_cmp_eq_u32 s45, 3
    s_cbranch_scc0 p1_loopB0_a9
    v_mfma_f32_16x16x32_bf16 v[168:171], v[56:59], v[248:251], v[168:171]
    v_mfma_f32_16x16x32_bf16 v[172:175], v[60:63], v[248:251], v[172:175]
    v_mfma_f32_16x16x32_bf16 v[176:179], v[64:67], v[248:251], v[176:179]
    v_mfma_f32_16x16x32_bf16 v[180:183], v[68:71], v[248:251], v[180:183]
p1_loopB0_a9:
    s_or_b32 s52, s44, s67
    s_cmp_eq_u32 s52, 0
    s_cbranch_scc0 k_nonon1
    s_and_b32 s52, s2, 63
    s_lshl_b32 s52, s52, 7
    s_add_u32 s52, s52, 15319040
    s_mov_b64 exec, 1
    buffer_load_dwordx2 v[160:161], off, s[20:23], s52 sc0 sc1
    s_mov_b64 exec, -1
k_nonon1:
    s_waitcnt lgkmcnt(6)
    v_mfma_f32_32x32x16_bf16 v[72:87], v[36:39], v[32:35], v[72:87]
    ds_read_b128 v[52:55], v6 offset:17408
    ds_read_b64_tr_b16 v[56:57], v14 offset:7168
    ds_read_b64_tr_b16 v[58:59], v14 offset:8960
    ds_read_b64_tr_b16 v[60:61], v14 offset:7232
    ds_read_b64_tr_b16 v[62:63], v14 offset:9024
    ds_read_b64_tr_b16 v[64:65], v14 offset:7296
    ds_read_b64_tr_b16 v[66:67], v14 offset:9088
    ds_read_b64_tr_b16 v[68:69], v14 offset:7360
    ds_read_b64_tr_b16 v[70:71], v14 offset:9152
    v_lshlrev_b32 v19, 16, v32
    s_waitcnt lgkmcnt(13)
    v_mfma_f32_32x32x16_bf16 v[88:103], v[40:43], v[32:35], v[88:103]
    s_mul_i32 s66, s57, 3584
    s_add_u32 m0, s51, 95232
    s_mov_b64 exec, s[64:65]
    buffer_load_dwordx4 v4, s[16:19], s66 offen lds
    s_add_u32 s66, s66, 7168
    s_add_u32 m0, s51, 96128
    s_nop 0
    buffer_load_dwordx4 v4, s[16:19], s66 offen lds
    s_mov_b64 exec, -1
    s_add_u32 s57, s57, 32
    s_and_b32 s57, s57, 511
    s_waitcnt lgkmcnt(11)
    v_mfma_f32_32x32x16_bf16 v[104:119], v[44:47], v[32:35], v[104:119]
    s_add_u32 s66, s73, 122880
    buffer_load_dwordx4 v[196:199], v252, s[28:31], s66 offen
    s_add_u32 s66, s73, 131072
    buffer_load_dwordx4 v[200:203], v252, s[28:31], s66 offen
    s_add_u32 s66, s73, 139264
    buffer_load_dwordx4 v[204:207], v252, s[28:31], s66 offen
    v_and_b32 v20, 0xffff0000, v32
    v_add_f32 v15, v15, v19
    v_fmac_f32 v16, v19, v19
    v_add_f32 v17, v17, v20
    s_waitcnt lgkmcnt(9)
    v_mfma_f32_32x32x16_bf16 v[120:135], v[48:51], v[32:35], v[120:135]
    v_fmac_f32 v18, v20, v20
    v_lshlrev_b32 v21, 16, v33
    v_and_b32 v22, 0xffff0000, v33
    v_add_f32 v15, v15, v21
    v_fmac_f32 v16, v21, v21
    v_add_f32 v17, v17, v22
    v_fmac_f32 v18, v22, v22
    s_cmp_eq_u32 s45, 0
    s_cbranch_scc0 p1_loopB0_b9
    v_mfma_f32_16x16x32_bf16 v[168:171], v[36:39], v[248:251], v[168:171]
    v_mfma_f32_16x16x32_bf16 v[172:175], v[40:43], v[248:251], v[172:175]
    v_mfma_f32_16x16x32_bf16 v[176:179], v[44:47], v[248:251], v[176:179]
    v_mfma_f32_16x16x32_bf16 v[180:183], v[48:51], v[248:251], v[180:183]
p1_loopB0_b9:
    s_waitcnt lgkmcnt(6)
    v_mfma_f32_32x32x16_bf16 v[72:87], v[56:59], v[52:55], v[72:87]
    ds_read_b128 v[32:35], v7 offset:17408
    ds_read_b64_tr_b16 v[36:37], v14 offset:14336
    ds_read_b64_tr_b16 v[38:39], v14 offset:16128
    ds_read_b64_tr_b16 v[40:41], v14 offset:14400
    ds_read_b64_tr_b16 v[42:43], v14 offset:16192
    ds_read_b64_tr_b16 v[44:45], v14 offset:14464
    ds_read_b64_tr_b16 v[46:47], v14 offset:16256
    ds_read_b64_tr_b16 v[48:49], v14 offset:14528
    s_waitcnt lgkmcnt(12)
    v_mfma_f32_32x32x16_bf16 v[88:103], v[60:63], v[52:55], v[88:103]
    ds_read_b64_tr_b16 v[50:51], v14 offset:16320
    v_lshlrev_b32 v19, 16, v52
    v_and_b32 v20, 0xffff0000, v52
    v_add_f32 v15, v15, v19
    v_fmac_f32 v16, v19, v19
    v_add_f32 v17, v17, v20
    v_fmac_f32 v18, v20, v20
    v_lshlrev_b32 v21, 16, v53
    s_waitcnt lgkmcnt(11)
    v_mfma_f32_32x32x16_bf16 v[104:119], v[64:67], v[52:55], v[104:119]
    s_mul_i32 s66, s57, 3584
    s_add_u32 m0, s51, 109568
    s_mov_b64 exec, s[64:65]
    buffer_load_dwordx4 v4, s[16:19], s66 offen lds
    s_add_u32 s66, s66, 7168
    s_add_u32 m0, s51, 110464
    s_nop 0
    buffer_load_dwordx4 v4, s[16:19], s66 offen lds
    s_mov_b64 exec, -1
    s_add_u32 s57, s57, 32
    s_and_b32 s57, s57, 511
    s_waitcnt lgkmcnt(9)
    v_mfma_f32_32x32x16_bf16 v[120:135], v[68:71], v[52:55], v[120:135]
    v_and_b32 v22, 0xffff0000, v53
    v_add_f32 v15, v15, v21
    v_fmac_f32 v16, v21, v21
    v_add_f32 v17, v17, v22
    v_fmac_f32 v18, v22, v22
    s_cmp_eq_u32 s45, 1
    s_cbranch_scc0 p1_loopB0_a10
    v_mfma_f32_16x16x32_bf16 v[168:171], v[56:59], v[248:251], v[168:171]
    v_mfma_f32_16x16x32_bf16 v[172:175], v[60:63], v[248:251], v[172:175]
    v_mfma_f32_16x16x32_bf16 v[176:179], v[64:67], v[248:251], v[176:179]
    v_mfma_f32_16x16x32_bf16 v[180:183], v[68:71], v[248:251], v[180:183]
p1_loopB0_a10:
    s_waitcnt lgkmcnt(6)
    v_mfma_f32_32x32x16_bf16 v[72:87], v[36:39], v[32:35], v[72:87]
    ds_read_b128 v[52:55], v8 offset:17408
    ds_read_b64_tr_b16 v[56:57], v14 offset:21504
    ds_read_b64_tr_b16 v[58:59], v14 offset:23296
    ds_read_b64_tr_b16 v[60:61], v14 offset:21568
    ds_read_b64_tr_b16 v[62:63], v14 offset:23360
    ds_read_b64_tr_b16 v[64:65], v14 offset:21632
    ds_read_b64_tr_b16 v[66:67], v14 offset:23424
    s_waitcnt lgkmcnt(11)
    v_mfma_f32_32x32x16_bf16 v[88:103], v[40:43], v[32:35], v[88:103]
    ds_read_b64_tr_b16 v[68:69], v14 offset:21696
    ds_read_b64_tr_b16 v[70:71], v14 offset:23488
    s_add_u32 s66, s73, 147456
    buffer_load_dwordx4 v[208:211], v252, s[28:31], s66 offen
    s_add_u32 s66, s73, 155648
    buffer_load_dwordx4 v[212:215], v252, s[28:31], s66 offen
    v_lshlrev_b32 v19, 16, v32
    s_waitcnt lgkmcnt(11)
    v_mfma_f32_32x32x16_bf16 v[104:119], v[44:47], v[32:35], v[104:119]
    s_add_u32 s66, s73, 163840
    buffer_load_dwordx4 v[216:219], v252, s[28:31], s66 offen
    v_and_b32 v20, 0xffff0000, v32
    v_add_f32 v15, v15, v19
    v_fmac_f32 v16, v19, v19
    v_add_f32 v17, v17, v20
    v_fmac_f32 v18, v20, v20
    s_waitcnt lgkmcnt(9)
    v_mfma_f32_32x32x16_bf16 v[120:135], v[48:51], v[32:35], v[120:135]
    v_lshlrev_b32 v21, 16, v33
    v_and_b32 v22, 0xffff0000, v33
    v_add_f32 v15, v15, v21
    v_fmac_f32 v16, v21, v21
    v_add_f32 v17, v17, v22
    v_fmac_f32 v18, v22, v22
    s_cmp_eq_u32 s45, 2
    s_cbranch_scc0 p1_loopB0_b10
    v_mfma_f32_16x16x32_bf16 v[168:171], v[36:39], v[248:251], v[168:171]
    v_mfma_f32_16x16x32_bf16 v[172:175], v[40:43], v[248:251], v[172:175]
    v_mfma_f32_16x16x32_bf16 v[176:179], v[44:47], v[248:251], v[176:179]
    v_mfma_f32_16x16x32_bf16 v[180:183], v[48:51], v[248:251], v[180:183]
p1_loopB0_b10:
    s_waitcnt vmcnt(13) lgkmcnt(0)
    s_barrier
    v_mfma_f32_32x32x16_bf16 v[72:87], v[56:59], v[52:55], v[72:87]
    ds_read_b128 v[32:35], v5 offset:33792
    ds_read_b64_tr_b16 v[36:37], v13 offset:0
    ds_read_b64_tr_b16 v[38:39], v13 offset:1792
    ds_read_b64_tr_b16 v[40:41], v13 offset:64
    ds_read_b64_tr_b16 v[42:43], v13 offset:1856
    ds_read_b64_tr_b16 v[44:45], v13 offset:128
    v_mfma_f32_32x32x16_bf16 v[88:103], v[60:63], v[52:55], v[88:103]
    ds_read_b64_tr_b16 v[46:47], v13 offset:1920
    ds_read_b64_tr_b16 v[48:49], v13 offset:192
    ds_read_b64_tr_b16 v[50:51], v13 offset:1984
    v_lshlrev_b32 v19, 16, v52
    v_and_b32 v20, 0xffff0000, v52
    v_add_f32 v15, v15, v19
    v_mfma_f32_32x32x16_bf16 v[104:119], v[64:67], v[52:55], v[104:119]
    v_fmac_f32 v16, v19, v19
    v_add_f32 v17, v17, v20
    v_fmac_f32 v18, v20, v20
    v_lshlrev_b32 v21, 16, v53
    v_and_b32 v22, 0xffff0000, v53
    v_add_f32 v15, v15, v21
    v_mfma_f32_32x32x16_bf16 v[120:135], v[68:71], v[52:55], v[120:135]
    v_fmac_f32 v16, v21, v21
    v_add_f32 v17, v17, v22
    v_fmac_f32 v18, v22, v22
    s_cmp_eq_u32 s45, 3
    s_cbranch_scc0 p1_loopB0_a11
    v_mfma_f32_16x16x32_bf16 v[168:171], v[56:59], v[248:251], v[168:171]
    v_mfma_f32_16x16x32_bf16 v[172:175], v[60:63], v[248:251], v[172:175]
    v_mfma_f32_16x16x32_bf16 v[176:179], v[64:67], v[248:251], v[176:179]
    v_mfma_f32_16x16x32_bf16 v[180:183], v[68:71], v[248:251], v[180:183]
p1_loopB0_a11:
    s_waitcnt lgkmcnt(6)
    v_mfma_f32_32x32x16_bf16 v[72:87], v[36:39], v[32:35], v[72:87]
    ds_read_b128 v[52:55], v6 offset:33792
    ds_read_b64_tr_b16 v[56:57], v13 offset:7168
    ds_read_b64_tr_b16 v[58:59], v13 offset:8960
    ds_read_b64_tr_b16 v[60:61], v13 offset:7232
    ds_read_b64_tr_b16 v[62:63], v13 offset:9024
    ds_read_b64_tr_b16 v[64:65], v13 offset:7296
    ds_read_b64_tr_b16 v[66:67], v13 offset:9088
    s_waitcnt lgkmcnt(11)
    v_mfma_f32_32x32x16_bf16 v[88:103], v[40:43], v[32:35], v[88:103]
    ds_read_b64_tr_b16 v[68:69], v13 offset:7360
    ds_read_b64_tr_b16 v[70:71], v13 offset:9152
    s_add_u32 s66, s73, 172032
    buffer_load_dwordx4 v[220:223], v252, s[28:31], s66 offen
    s_add_u32 s66, s73, 180224
    buffer_load_dwordx4 v[224:227], v252, s[28:31], s66 offen
    v_lshlrev_b32 v19, 16, v32
    s_waitcnt lgkmcnt(11)
    v_mfma_f32_32x32x16_bf16 v[104:119], v[44:47], v[32:35], v[104:119]
    s_add_u32 s66, s73, 188416
    buffer_load_dwordx4 v[228:231], v252, s[28:31], s66 offen
    v_and_b32 v20, 0xffff0000, v32
    v_add_f32 v15, v15, v19
    v_fmac_f32 v16, v19, v19
    v_add_f32 v17, v17, v20
    v_fmac_f32 v18, v20, v20
    s_waitcnt lgkmcnt(9)
    v_mfma_f32_32x32x16_bf16 v[120:135], v[48:51], v[32:35], v[120:135]
    v_lshlrev_b32 v21, 16, v33
    v_and_b32 v22, 0xffff0000, v33
    v_add_f32 v15, v15, v21
    v_fmac_f32 v16, v21, v21
    v_add_f32 v17, v17, v22
    v_fmac_f32 v18, v22, v22
    s_cmp_eq_u32 s45, 0
    s_cbranch_scc0 p1_loopB0_b11
    v_mfma_f32_16x16x32_bf16 v[168:171], v[36:39], v[248:251], v[168:171]
    v_mfma_f32_16x16x32_bf16 v[172:175], v[40:43], v[248:251], v[172:175]
    v_mfma_f32_16x16x32_bf16 v[176:179], v[44:47], v[248:251], v[176:179]
    v_mfma_f32_16x16x32_bf16 v[180:183], v[48:51], v[248:251], v[180:183]
p1_loopB0_b11:
    s_waitcnt lgkmcnt(6)
    v_mfma_f32_32x32x16_bf16 v[72:87], v[56:59], v[52:55], v[72:87]
    ds_read_b128 v[32:35], v7 offset:33792
    ds_read_b64_tr_b16 v[36:37], v13 offset:14336
    ds_read_b64_tr_b16 v[38:39], v13 offset:16128
    ds_read_b64_tr_b16 v[40:41], v13 offset:14400
    ds_read_b64_tr_b16 v[42:43], v13 offset:16192
    ds_read_b64_tr_b16 v[44:45], v13 offset:14464
    s_waitcnt lgkmcnt(10)
    v_mfma_f32_32x32x16_bf16 v[88:103], v[60:63], v[52:55], v[88:103]
    ds_read_b64_tr_b16 v[46:47], v13 offset:16256
    ds_read_b64_tr_b16 v[48:49], v13 offset:14528
    ds_read_b64_tr_b16 v[50:51], v13 offset:16320
    v_lshlrev_b32 v19, 16, v52
    v_and_b32 v20, 0xffff0000, v52
    v_add_f32 v15, v15, v19
    s_waitcnt lgkmcnt(11)
    v_mfma_f32_32x32x16_bf16 v[104:119], v[64:67], v[52:55], v[104:119]
    v_fmac_f32 v16, v19, v19
    v_add_f32 v17, v17, v20
    v_fmac_f32 v18, v20, v20
    v_lshlrev_b32 v21, 16, v53
    v_and_b32 v22, 0xffff0000, v53
    v_add_f32 v15, v15, v21
    s_waitcnt lgkmcnt(9)
    v_mfma_f32_32x32x16_bf16 v[120:135], v[68:71], v[52:55], v[120:135]
    v_fmac_f32 v16, v21, v21
    v_add_f32 v17, v17, v22
    v_fmac_f32 v18, v22, v22
    s_cmp_eq_u32 s45, 1
    s_cbranch_scc0 p1_loopB0_a12
    v_mfma_f32_16x16x32_bf16 v[168:171], v[56:59], v[248:251], v[168:171]
    v_mfma_f32_16x16x32_bf16 v[172:175], v[60:63], v[248:251], v[172:175]
    v_mfma_f32_16x16x32_bf16 v[176:179], v[64:67], v[248:251], v[176:179]
    v_mfma_f32_16x16x32_bf16 v[180:183], v[68:71], v[248:251], v[180:183]
p1_loopB0_a12:
    s_waitcnt lgkmcnt(6)
    v_mfma_f32_32x32x16_bf16 v[72:87], v[36:39], v[32:35], v[72:87]
    ds_read_b128 v[52:55], v8 offset:33792
    ds_read_b64_tr_b16 v[56:57], v13 offset:21504
    ds_read_b64_tr_b16 v[58:59], v13 offset:23296
    ds_read_b64_tr_b16 v[60:61], v13 offset:21568
    ds_read_b64_tr_b16 v[62:63], v13 offset:23360
    ds_read_b64_tr_b16 v[64:65], v13 offset:21632
    ds_read_b64_tr_b16 v[66:67], v13 offset:23424
    s_waitcnt lgkmcnt(11)
    v_mfma_f32_32x32x16_bf16 v[88:103], v[40:43], v[32:35], v[88:103]
    ds_read_b64_tr_b16 v[68:69], v13 offset:21696
    ds_read_b64_tr_b16 v[70:71], v13 offset:23488
    s_add_u32 s66, s73, 196608
    buffer_load_dwordx4 v[232:235], v252, s[28:31], s66 offen
    s_add_u32 s66, s73, 204800
    buffer_load_dwordx4 v[236:239], v252, s[28:31], s66 offen
    v_lshlrev_b32 v19, 16, v32
    s_waitcnt lgkmcnt(11)
    v_mfma_f32_32x32x16_bf16 v[104:119], v[44:47], v[32:35], v[104:119]
    s_add_u32 s66, s73, 212992
    buffer_load_dwordx4 v[240:243], v252, s[28:31], s66 offen
    v_and_b32 v20, 0xffff0000, v32
    v_add_f32 v15, v15, v19
    v_fmac_f32 v16, v19, v19
    v_add_f32 v17, v17, v20
    v_fmac_f32 v18, v20, v20
    s_waitcnt lgkmcnt(9)
    v_mfma_f32_32x32x16_bf16 v[120:135], v[48:51], v[32:35], v[120:135]
    v_lshlrev_b32 v21, 16, v33
    v_and_b32 v22, 0xffff0000, v33
    v_add_f32 v15, v15, v21
    v_fmac_f32 v16, v21, v21
    v_add_f32 v17, v17, v22
    v_fmac_f32 v18, v22, v22
    s_cmp_eq_u32 s45, 2
    s_cbranch_scc0 p1_loopB0_b12
    v_mfma_f32_16x16x32_bf16 v[168:171], v[36:39], v[248:251], v[168:171]
    v_mfma_f32_16x16x32_bf16 v[172:175], v[40:43], v[248:251], v[172:175]
    v_mfma_f32_16x16x32_bf16 v[176:179], v[44:47], v[248:251], v[176:179]
    v_mfma_f32_16x16x32_bf16 v[180:183], v[48:51], v[248:251], v[180:183]
p1_loopB0_b12:
    s_waitcnt vmcnt(9) lgkmcnt(0)
    s_barrier
    v_mfma_f32_32x32x16_bf16 v[72:87], v[56:59], v[52:55], v[72:87]
    ds_read_b128 v[32:35], v5 offset:50176
    ds_read_b64_tr_b16 v[36:37], v13 offset:28672
    ds_read_b64_tr_b16 v[38:39], v13 offset:30464
    ds_read_b64_tr_b16 v[40:41], v13 offset:28736
    ds_read_b64_tr_b16 v[42:43], v13 offset:30528
    ds_read_b64_tr_b16 v[44:45], v13 offset:28800
    v_mfma_f32_32x32x16_bf16 v[88:103], v[60:63], v[52:55], v[88:103]
    ds_read_b64_tr_b16 v[46:47], v13 offset:30592
    ds_read_b64_tr_b16 v[48:49], v13 offset:28864
    ds_read_b64_tr_b16 v[50:51], v13 offset:30656
    v_lshlrev_b32 v19, 16, v52
    v_and_b32 v20, 0xffff0000, v52
    v_add_f32 v15, v15, v19
    v_mfma_f32_32x32x16_bf16 v[104:119], v[64:67], v[52:55], v[104:119]
    v_fmac_f32 v16, v19, v19
    v_add_f32 v17, v17, v20
    v_fmac_f32 v18, v20, v20
    v_lshlrev_b32 v21, 16, v53
    v_and_b32 v22, 0xffff0000, v53
    v_add_f32 v15, v15, v21
    v_mfma_f32_32x32x16_bf16 v[120:135], v[68:71], v[52:55], v[120:135]
    v_fmac_f32 v16, v21, v21
    v_add_f32 v17, v17, v22
    v_fmac_f32 v18, v22, v22
    s_cmp_eq_u32 s45, 3
    s_cbranch_scc0 p1_loopB0_a13
    v_mfma_f32_16x16x32_bf16 v[168:171], v[56:59], v[248:251], v[168:171]
    v_mfma_f32_16x16x32_bf16 v[172:175], v[60:63], v[248:251], v[172:175]
    v_mfma_f32_16x16x32_bf16 v[176:179], v[64:67], v[248:251], v[176:179]
    v_mfma_f32_16x16x32_bf16 v[180:183], v[68:71], v[248:251], v[180:183]
p1_loopB0_a13:
    s_waitcnt lgkmcnt(6)
    v_mfma_f32_32x32x16_bf16 v[72:87], v[36:39], v[32:35], v[72:87]
    ds_read_b128 v[52:55], v6 offset:50176
    ds_read_b64_tr_b16 v[56:57], v13 offset:35840
    ds_read_b64_tr_b16 v[58:59], v13 offset:37632
    ds_read_b64_tr_b16 v[60:61], v13 offset:35904
    ds_read_b64_tr_b16 v[62:63], v13 offset:37696
    ds_read_b64_tr_b16 v[64:65], v13 offset:35968
    ds_read_b64_tr_b16 v[66:67], v13 offset:37760
    s_waitcnt lgkmcnt(11)
    v_mfma_f32_32x32x16_bf16 v[88:103], v[40:43], v[32:35], v[88:103]
    ds_read_b64_tr_b16 v[68:69], v13 offset:36032
    ds_read_b64_tr_b16 v[70:71], v13 offset:37824
    s_add_u32 s66, s73, 221184
    buffer_load_dwordx4 v[244:247], v252, s[28:31], s66 offen
    s_add_u32 s66, s98, 0
    buffer_load_dwordx2 v[10:11], v252, s[28:31], s66 offen
    v_lshlrev_b32 v19, 16, v32
    s_waitcnt lgkmcnt(11)
    v_mfma_f32_32x32x16_bf16 v[104:119], v[44:47], v[32:35], v[104:119]
    s_add_u32 s66, s98, 32768
    buffer_load_dwordx2 v[10:11], v252, s[28:31], s66 offen
    v_and_b32 v20, 0xffff0000, v32
    v_add_f32 v15, v15, v19
    v_fmac_f32 v16, v19, v19
    v_add_f32 v17, v17, v20
    v_fmac_f32 v18, v20, v20
    s_waitcnt lgkmcnt(9)
    v_mfma_f32_32x32x16_bf16 v[120:135], v[48:51], v[32:35], v[120:135]
    v_lshlrev_b32 v21, 16, v33
    v_and_b32 v22, 0xffff0000, v33
    v_add_f32 v15, v15, v21
    v_fmac_f32 v16, v21, v21
    v_add_f32 v17, v17, v22
    v_fmac_f32 v18, v22, v22
    s_cmp_eq_u32 s45, 0
    s_cbranch_scc0 p1_loopB0_b13
    v_mfma_f32_16x16x32_bf16 v[168:171], v[36:39], v[248:251], v[168:171]
    v_mfma_f32_16x16x32_bf16 v[172:175], v[40:43], v[248:251], v[172:175]
    v_mfma_f32_16x16x32_bf16 v[176:179], v[44:47], v[248:251], v[176:179]
    v_mfma_f32_16x16x32_bf16 v[180:183], v[48:51], v[248:251], v[180:183]
p1_loopB0_b13:
    s_waitcnt lgkmcnt(6)
    v_mfma_f32_32x32x16_bf16 v[72:87], v[56:59], v[52:55], v[72:87]
    ds_read_b128 v[32:35], v7 offset:50176
    ds_read_b64_tr_b16 v[36:37], v13 offset:43008
    ds_read_b64_tr_b16 v[38:39], v13 offset:44800
    ds_read_b64_tr_b16 v[40:41], v13 offset:43072
    ds_read_b64_tr_b16 v[42:43], v13 offset:44864
    ds_read_b64_tr_b16 v[44:45], v13 offset:43136
    s_waitcnt lgkmcnt(10)
    v_mfma_f32_32x32x16_bf16 v[88:103], v[60:63], v[52:55], v[88:103]
    ds_read_b64_tr_b16 v[46:47], v13 offset:44928
    ds_read_b64_tr_b16 v[48:49], v13 offset:43200
    ds_read_b64_tr_b16 v[50:51], v13 offset:44992
    v_lshlrev_b32 v19, 16, v52
    v_and_b32 v20, 0xffff0000, v52
    v_add_f32 v15, v15, v19
    s_waitcnt lgkmcnt(11)
    v_mfma_f32_32x32x16_bf16 v[104:119], v[64:67], v[52:55], v[104:119]
    v_fmac_f32 v16, v19, v19
    v_add_f32 v17, v17, v20
    v_fmac_f32 v18, v20, v20
    v_lshlrev_b32 v21, 16, v53
    v_and_b32 v22, 0xffff0000, v53
    v_add_f32 v15, v15, v21
    s_waitcnt lgkmcnt(9)
    v_mfma_f32_32x32x16_bf16 v[120:135], v[68:71], v[52:55], v[120:135]
    v_fmac_f32 v16, v21, v21
    v_add_f32 v17, v17, v22
    v_fmac_f32 v18, v22, v22
    s_cmp_eq_u32 s45, 1
    s_cbranch_scc0 p1_loopB0_a14
    v_mfma_f32_16x16x32_bf16 v[168:171], v[56:59], v[248:251], v[168:171]
    v_mfma_f32_16x16x32_bf16 v[172:175], v[60:63], v[248:251], v[172:175]
    v_mfma_f32_16x16x32_bf16 v[176:179], v[64:67], v[248:251], v[176:179]
    v_mfma_f32_16x16x32_bf16 v[180:183], v[68:71], v[248:251], v[180:183]
p1_loopB0_a14:
    s_waitcnt lgkmcnt(6)
    v_mfma_f32_32x32x16_bf16 v[72:87], v[36:39], v[32:35], v[72:87]
    ds_read_b128 v[52:55], v8 offset:50176
    ds_read_b64_tr_b16 v[56:57], v13 offset:50176
    ds_read_b64_tr_b16 v[58:59], v13 offset:51968
    ds_read_b64_tr_b16 v[60:61], v13 offset:50240
    ds_read_b64_tr_b16 v[62:63], v13 offset:52032
    ds_read_b64_tr_b16 v[64:65], v13 offset:50304
    ds_read_b64_tr_b16 v[66:67], v13 offset:52096
    s_waitcnt lgkmcnt(11)
    v_mfma_f32_32x32x16_bf16 v[88:103], v[40:43], v[32:35], v[88:103]
    ds_read_b64_tr_b16 v[68:69], v13 offset:50368
    ds_read_b64_tr_b16 v[70:71], v13 offset:52160
    s_add_u32 s66, s98, 65536
    buffer_load_dwordx2 v[10:11], v252, s[28:31], s66 offen
    s_add_u32 s66, s99, 0
    buffer_load_dwordx2 v[10:11], v252, s[32:35], s66 offen
    v_lshlrev_b32 v19, 16, v32
    s_waitcnt lgkmcnt(11)
    v_mfma_f32_32x32x16_bf16 v[104:119], v[44:47], v[32:35], v[104:119]
    s_add_u32 s66, s99, 32768
    buffer_load_dwordx2 v[10:11], v252, s[32:35], s66 offen
    v_and_b32 v20, 0xffff0000, v32
    v_add_f32 v15, v15, v19
    v_fmac_f32 v16, v19, v19
    v_add_f32 v17, v17, v20
    v_fmac_f32 v18, v20, v20
    s_waitcnt lgkmcnt(9)
    v_mfma_f32_32x32x16_bf16 v[120:135], v[48:51], v[32:35], v[120:135]
    v_lshlrev_b32 v21, 16, v33
    v_and_b32 v22, 0xffff0000, v33
    v_add_f32 v15, v15, v21
    v_fmac_f32 v16, v21, v21
    v_add_f32 v17, v17, v22
    v_fmac_f32 v18, v22, v22
    s_cmp_eq_u32 s45, 2
    s_cbranch_scc0 p1_loopB0_b14
    v_mfma_f32_16x16x32_bf16 v[168:171], v[36:39], v[248:251], v[168:171]
    v_mfma_f32_16x16x32_bf16 v[172:175], v[40:43], v[248:251], v[172:175]
    v_mfma_f32_16x16x32_bf16 v[176:179], v[44:47], v[248:251], v[176:179]
    v_mfma_f32_16x16x32_bf16 v[180:183], v[48:51], v[248:251], v[180:183]
p1_loopB0_b14:
    s_waitcnt lgkmcnt(6)
    v_mfma_f32_32x32x16_bf16 v[72:87], v[56:59], v[52:55], v[72:87]
    v_lshlrev_b32 v19, 16, v52
    v_and_b32 v20, 0xffff0000, v52
    v_add_f32 v15, v15, v19
    s_waitcnt lgkmcnt(4)
    v_mfma_f32_32x32x16_bf16 v[88:103], v[60:63], v[52:55], v[88:103]
    v_fmac_f32 v16, v19, v19
    v_add_f32 v17, v17, v20
    v_fmac_f32 v18, v20, v20
    s_waitcnt lgkmcnt(2)
    v_mfma_f32_32x32x16_bf16 v[104:119], v[64:67], v[52:55], v[104:119]
    v_lshlrev_b32 v21, 16, v53
    v_and_b32 v22, 0xffff0000, v53
    v_add_f32 v15, v15, v21
    s_waitcnt lgkmcnt(0)
    v_mfma_f32_32x32x16_bf16 v[120:135], v[68:71], v[52:55], v[120:135]
    v_fmac_f32 v16, v21, v21
    v_add_f32 v17, v17, v22
    v_fmac_f32 v18, v22, v22
    s_cmp_eq_u32 s45, 3
    s_cbranch_scc0 p1_loopB0_a15
    v_mfma_f32_16x16x32_bf16 v[168:171], v[56:59], v[248:251], v[168:171]
    v_mfma_f32_16x16x32_bf16 v[172:175], v[60:63], v[248:251], v[172:175]
    v_mfma_f32_16x16x32_bf16 v[176:179], v[64:67], v[248:251], v[176:179]
    v_mfma_f32_16x16x32_bf16 v[180:183], v[68:71], v[248:251], v[180:183]
p1_loopB0_a15:
    s_waitcnt lgkmcnt(0)
    s_or_b32 s52, s44, s67
    s_cbranch_scc1 p1_np1
    v_readfirstlane_b32 s52, v160
    v_readfirstlane_b32 s53, v161
    s_or_b32 s5, s101, 0x80000000
    s_sub_u32 s4, s52, s100
    s_subb_u32 s5, s53, s5
    s_lshr_b32 s4, s4, 20
    s_or_b32 s4, s4, s5
    s_cbranch_scc0 p1_np1_h
    s_add_u32 s100, s100, 600
    s_addc_u32 s101, s101, 0
    s_bitset1_b32 s101, 31
    v_mov_b32 v160, s100
    v_mov_b32 v161, s101
    v_mov_b32 v162, 0
    v_mov_b32 v163, 0
    s_mov_b64 exec, 1
    buffer_atomic_cmpswap_x2 v[160:163], off, s[40:43], 0 offset:32 sc0 sc1
    s_mov_b64 exec, -1
    s_waitcnt vmcnt(0)
    v_readfirstlane_b32 s52, v160
    v_readfirstlane_b32 s53, v161
    s_nop 0
    s_cmp_eq_u32 s53, 0
    s_cselect_b32 s52, s100, s52
    s_cselect_b32 s53, s101, s53
p1_np1_h:
    v_mov_b32 v160, s52
    v_mov_b32 v161, s53
    v_mov_b32 v148, 161792
    ds_write_b64 v148, v[160:161] offset:16
p1_np1:
    v_add_f32 v15, v15, v17
    v_add_f32 v16, v16, v18
    v_mov_b32 v148, v15
    v_mov_b32 v149, v16
    s_nop 0
    v_permlane32_swap_b32 v15, v148
    v_permlane32_swap_b32 v16, v149
    v_add_f32 v150, v15, v148
    v_add_f32 v151, v16, v149
    s_lshl_b32 s52, s45, 8
    s_add_u32 s52, s52, 141312
    s_lshl_b32 s53, s46, 10
    s_add_u32 s53, s53, s52
    v_and_b32 v152, 31, v1
    v_lshlrev_b32 v153, 3, v152
    v_add_u32 v154, s53, v153
    v_add_u32 v153, s52, v153
    ds_write_b64 v154, v[150:151]
    v_and_b32 v154, 1, v1
    v_lshlrev_b32 v154, 6, v154
    v_lshrrev_b32 v155, 4, v1
    v_lshl_add_u32 v154, v155, 4, v154
    s_lshr_b32 s52, s45, 1
    s_mul_i32 s52, s52, 20480
    s_and_b32 s53, s45, 1
    s_lshl_b32 s53, s53, 10
    s_add_u32 s52, s52, s53
    s_add_u32 s53, s55, 18432
    s_add_u32 s52, s52, s53
    v_add_u32 v154, s52, v154
    v_lshlrev_b32 v152, 2, v152
    v_add_u32 v152, s53, v152
    s_mov_b32 exec_lo, 0x00030003
    s_mov_b32 exec_hi, 0x00030003
    ds_write_b128 v154, v[168:171] offset:0
    ds_write_b128 v154, v[172:175] offset:128
    ds_write_b128 v154, v[176:179] offset:256
    ds_write_b128 v154, v[180:183] offset:384
    s_mov_b64 exec, -1
    v_mov_b32 v155, 161792
    s_waitcnt lgkmcnt(0)
    s_barrier
    ds_read_b64 v[160:161], v155 offset:16
    ds_read_b64 v[148:149], v153
    ds_read_b64 v[150:151], v153 offset:1024
    ds_read_b32 v168, v152 offset:0
    ds_read_b32 v169, v152 offset:1024
    ds_read_b32 v170, v152 offset:20480
    ds_read_b32 v171, v152 offset:21504
    ds_read_b32 v172, v152 offset:128
    ds_read_b32 v173, v152 offset:1152
    ds_read_b32 v174, v152 offset:20608
    ds_read_b32 v175, v152 offset:21632
    ds_read_b32 v176, v152 offset:256
    ds_read_b32 v177, v152 offset:1280
    ds_read_b32 v178, v152 offset:20736
    ds_read_b32 v179, v152 offset:21760
    ds_read_b32 v180, v152 offset:384
    ds_read_b32 v181, v152 offset:1408
    ds_read_b32 v182, v152 offset:20864
    ds_read_b32 v183, v152 offset:21888
    s_cmp_eq_u32 s67, 0
    s_cbranch_scc0 p1_nopf0
    s_add_u32 m0, s72, 0
    s_add_u32 s52, s73, 0
    buffer_load_dwordx4 v252, s[28:31], s52 offen lds
    s_add_u32 m0, s72, 1024
    s_add_u32 s52, s73, 8192
    buffer_load_dwordx4 v252, s[28:31], s52 offen lds
    s_add_u32 m0, s72, 2048
    s_add_u32 s52, s73, 16384
    buffer_load_dwordx4 v252, s[28:31], s52 offen lds
    s_add_u32 m0, s72, 3072
    s_add_u32 s52, s73, 24576
    buffer_load_dwordx4 v252, s[28:31], s52 offen lds
    s_add_u32 m0, s72, 4096
    s_add_u32 s52, s73, 32768
    buffer_load_dwordx4 v252, s[28:31], s52 offen lds
    s_add_u32 m0, s72, 5120
    s_add_u32 s52, s73, 40960
    buffer_load_dwordx4 v252, s[28:31], s52 offen lds
    s_add_u32 m0, s72, 6144
    s_add_u32 s52, s73, 49152
    buffer_load_dwordx4 v252, s[28:31], s52 offen lds
    s_add_u32 m0, s72, 7168
    s_add_u32 s52, s73, 57344
    buffer_load_dwordx4 v252, s[28:31], s52 offen lds
p1_nopf0:
    s_waitcnt lgkmcnt(15)
    v_readfirstlane_b32 s100, v160
    v_readfirstlane_b32 s101, v161
    v_add_f32 v15, v148, v150
    v_add_f32 v16, v149, v151
    v_mul_f32 v15, 0xbb000000, v15
    v_mul_f32 v16, 0x3b000000, v16
    v_fma_f32 v16, -v15, v15, v16
    v_add_f32 v16, 0x3727c5ac, v16
    v_rsq_f32 v136, v16
    v_sqrt_f32 v166, v16
    v_cvt_pk_bf16_f32 v148, v15, v15
    v_and_b32 v148, 0xffff0000, v148
    v_sub_f32 v148, v15, v148
    v_cvt_pk_bf16_f32 v140, v15, v148
    v_mov_b32 v141, 0
    v_mov_b32 v142, 0
    v_mov_b32 v143, 0
    v_mul_f32 v138, 0xbfb8aa3b, v136
    v_mov_b32 v145, 0
    v_mov_b32 v146, 0
    v_mov_b32 v147, 0
    v_mov_b32 v153, 0
    v_mov_b32 v154, 0
    v_mov_b32 v155, 0
    s_mov_b32 s62, 0
    s_mov_b32 s63, -1
    s_waitcnt lgkmcnt(12)
    v_add_f32 v168, v168, v169
    v_add_f32 v170, v170, v171
    v_add_f32 v168, v168, v170
    v_cvt_pk_bf16_f32 v169, v168, v168
    v_and_b32 v170, 0xffff0000, v169
    v_sub_f32 v170, v168, v170
    v_cvt_pk_bf16_f32 v170, v170, v170
    v_cndmask_b32 v144, v169, v170, s[62:63]
    s_nop 1
    v_mfma_f32_32x32x16_bf16 v[72:87], v[144:147], v[140:143], v[72:87]
    s_waitcnt lgkmcnt(8)
    v_add_f32 v172, v172, v173
    v_add_f32 v174, v174, v175
    v_add_f32 v172, v172, v174
    v_cvt_pk_bf16_f32 v173, v172, v172
    v_and_b32 v174, 0xffff0000, v173
    v_sub_f32 v174, v172, v174
    v_cvt_pk_bf16_f32 v174, v174, v174
    v_cndmask_b32 v152, v173, v174, s[62:63]
    s_nop 1
    v_mfma_f32_32x32x16_bf16 v[88:103], v[152:155], v[140:143], v[88:103]
    s_waitcnt lgkmcnt(4)
    v_add_f32 v176, v176, v177
    v_add_f32 v178, v178, v179
    v_add_f32 v176, v176, v178
    v_cvt_pk_bf16_f32 v177, v176, v176
    v_and_b32 v178, 0xffff0000, v177
    v_sub_f32 v178, v176, v178
    v_cvt_pk_bf16_f32 v178, v178, v178
    v_cndmask_b32 v144, v177, v178, s[62:63]
    s_nop 1
    v_mfma_f32_32x32x16_bf16 v[104:119], v[144:147], v[140:143], v[104:119]
    s_waitcnt lgkmcnt(0)
    v_add_f32 v180, v180, v181
    v_add_f32 v182, v182, v183
    v_add_f32 v180, v180, v182
    v_cvt_pk_bf16_f32 v181, v180, v180
    v_and_b32 v182, 0xffff0000, v181
    v_sub_f32 v182, v180, v182
    v_cvt_pk_bf16_f32 v182, v182, v182
    v_cndmask_b32 v152, v181, v182, s[62:63]
    s_nop 1
    v_mfma_f32_32x32x16_bf16 v[120:135], v[152:155], v[140:143], v[120:135]
    s_lshl_b32 s52, s47, 2
    s_add_u32 s52, s52, s45
    s_mul_i32 s52, s52, 112
    s_mul_i32 s53, s48, 14
    s_add_u32 s52, s52, s53
    s_lshl_b32 s53, s46, 3
    s_add_u32 s52, s52, s53
    s_lshl_b32 s52, s52, 10
    v_lshlrev_b32 v148, 4, v1
    v_pk_mul_f32 v[32:33], v[72:73], v[138:139] op_sel_hi:[1,0]
    v_pk_mul_f32 v[34:35], v[74:75], v[138:139] op_sel_hi:[1,0]
    v_pk_mul_f32 v[36:37], v[76:77], v[138:139] op_sel_hi:[1,0]
    v_pk_mul_f32 v[38:39], v[78:79], v[138:139] op_sel_hi:[1,0]
    v_pk_mul_f32 v[40:41], v[80:81], v[138:139] op_sel_hi:[1,0]
    v_pk_mul_f32 v[42:43], v[82:83], v[138:139] op_sel_hi:[1,0]
    s_add_u32 m0, s72, 8192
    s_add_u32 s66, s73, 65536
    buffer_load_dwordx4 v252, s[28:31], s66 offen lds
    v_pk_mul_f32 v[44:45], v[84:85], v[138:139] op_sel_hi:[1,0]
    v_pk_mul_f32 v[46:47], v[86:87], v[138:139] op_sel_hi:[1,0]
    v_exp_f32 v32, v32
    s_add_u32 m0, s72, 9216
    s_add_u32 s66, s73, 73728
    buffer_load_dwordx4 v252, s[28:31], s66 offen lds
    v_exp_f32 v33, v33
    v_exp_f32 v34, v34
    s_add_u32 m0, s72, 10240
    s_add_u32 s66, s73, 81920
    buffer_load_dwordx4 v252, s[28:31], s66 offen lds
    v_exp_f32 v35, v35
    v_exp_f32 v36, v36
    s_add_u32 m0, s72, 11264
    s_add_u32 s66, s73, 90112
    buffer_load_dwordx4 v252, s[28:31], s66 offen lds
    v_exp_f32 v37, v37
    v_exp_f32 v38, v38
    v_exp_f32 v39, v39
    v_exp_f32 v40, v40
    v_exp_f32 v41, v41
    v_exp_f32 v42, v42
    v_exp_f32 v43, v43
    v_exp_f32 v44, v44
    v_exp_f32 v45, v45
    v_exp_f32 v46, v46
    v_exp_f32 v47, v47
    v_pk_fma_f32 v[32:33], v[32:33], v[166:167], v[166:167] op_sel_hi:[1,0,0]
    v_pk_fma_f32 v[34:35], v[34:35], v[166:167], v[166:167] op_sel_hi:[1,0,0]
    v_pk_fma_f32 v[36:37], v[36:37], v[166:167], v[166:167] op_sel_hi:[1,0,0]
    v_pk_fma_f32 v[38:39], v[38:39], v[166:167], v[166:167] op_sel_hi:[1,0,0]
    v_pk_fma_f32 v[40:41], v[40:41], v[166:167], v[166:167] op_sel_hi:[1,0,0]
    v_pk_fma_f32 v[42:43], v[42:43], v[166:167], v[166:167] op_sel_hi:[1,0,0]
    v_pk_fma_f32 v[44:45], v[44:45], v[166:167], v[166:167] op_sel_hi:[1,0,0]
    v_pk_fma_f32 v[46:47], v[46:47], v[166:167], v[166:167] op_sel_hi:[1,0,0]
    v_rcp_f32 v32, v32
    v_rcp_f32 v33, v33
    v_rcp_f32 v34, v34
    v_rcp_f32 v35, v35
    v_rcp_f32 v36, v36
    v_rcp_f32 v37, v37
    v_rcp_f32 v38, v38
    v_rcp_f32 v39, v39
    v_rcp_f32 v40, v40
    v_rcp_f32 v41, v41
    v_rcp_f32 v42, v42
    v_rcp_f32 v43, v43
    v_rcp_f32 v44, v44
    v_rcp_f32 v45, v45
    v_rcp_f32 v46, v46
    v_rcp_f32 v47, v47
    v_pk_mul_f32 v[72:73], v[72:73], v[32:33]
    v_pk_mul_f32 v[74:75], v[74:75], v[34:35]
    v_pk_mul_f32 v[76:77], v[76:77], v[36:37]
    v_pk_mul_f32 v[78:79], v[78:79], v[38:39]
    v_pk_mul_f32 v[80:81], v[80:81], v[40:41]
    v_pk_mul_f32 v[82:83], v[82:83], v[42:43]
    v_pk_mul_f32 v[84:85], v[84:85], v[44:45]
    v_pk_mul_f32 v[86:87], v[86:87], v[46:47]
    v_cvt_pk_bf16_f32 v24, v72, v73
    v_cvt_pk_bf16_f32 v25, v74, v75
    v_cvt_pk_bf16_f32 v26, v76, v77
    v_cvt_pk_bf16_f32 v27, v78, v79
    v_cvt_pk_bf16_f32 v28, v80, v81
    v_cvt_pk_bf16_f32 v29, v82, v83
    v_cvt_pk_bf16_f32 v30, v84, v85
    v_cvt_pk_bf16_f32 v31, v86, v87
    buffer_store_dwordx4 v[24:27], v148, s[20:23], s52 offen sc1
    buffer_store_dwordx4 v[28:31], v148, s[20:23], s52 offen offset:1024 sc1
    s_add_u32 s52, s52, 2048
    v_pk_mul_f32 v[48:49], v[88:89], v[138:139] op_sel_hi:[1,0]
    v_pk_mul_f32 v[50:51], v[90:91], v[138:139] op_sel_hi:[1,0]
    v_pk_mul_f32 v[52:53], v[92:93], v[138:139] op_sel_hi:[1,0]
    v_pk_mul_f32 v[54:55], v[94:95], v[138:139] op_sel_hi:[1,0]
    v_pk_mul_f32 v[56:57], v[96:97], v[138:139] op_sel_hi:[1,0]
    v_pk_mul_f32 v[58:59], v[98:99], v[138:139] op_sel_hi:[1,0]
    v_pk_mul_f32 v[60:61], v[100:101], v[138:139] op_sel_hi:[1,0]
    v_pk_mul_f32 v[62:63], v[102:103], v[138:139] op_sel_hi:[1,0]
    v_exp_f32 v48, v48
    v_exp_f32 v49, v49
    v_exp_f32 v50, v50
    v_exp_f32 v51, v51
    v_exp_f32 v52, v52
    v_exp_f32 v53, v53
    v_exp_f32 v54, v54
    v_exp_f32 v55, v55
    v_exp_f32 v56, v56
    v_exp_f32 v57, v57
    v_exp_f32 v58, v58
    v_exp_f32 v59, v59
    v_exp_f32 v60, v60
    v_exp_f32 v61, v61
    v_exp_f32 v62, v62
    v_exp_f32 v63, v63
    v_pk_fma_f32 v[48:49], v[48:49], v[166:167], v[166:167] op_sel_hi:[1,0,0]
    v_pk_fma_f32 v[50:51], v[50:51], v[166:167], v[166:167] op_sel_hi:[1,0,0]
    v_pk_fma_f32 v[52:53], v[52:53], v[166:167], v[166:167] op_sel_hi:[1,0,0]
    v_pk_fma_f32 v[54:55], v[54:55], v[166:167], v[166:167] op_sel_hi:[1,0,0]
    v_pk_fma_f32 v[56:57], v[56:57], v[166:167], v[166:167] op_sel_hi:[1,0,0]
    v_pk_fma_f32 v[58:59], v[58:59], v[166:167], v[166:167] op_sel_hi:[1,0,0]
    v_pk_fma_f32 v[60:61], v[60:61], v[166:167], v[166:167] op_sel_hi:[1,0,0]
    v_pk_fma_f32 v[62:63], v[62:63], v[166:167], v[166:167] op_sel_hi:[1,0,0]
    v_rcp_f32 v48, v48
    v_rcp_f32 v49, v49
    v_rcp_f32 v50, v50
    v_rcp_f32 v51, v51
    v_rcp_f32 v52, v52
    v_rcp_f32 v53, v53
    v_rcp_f32 v54, v54
    v_rcp_f32 v55, v55
    v_rcp_f32 v56, v56
    v_rcp_f32 v57, v57
    v_rcp_f32 v58, v58
    v_rcp_f32 v59, v59
    v_rcp_f32 v60, v60
    v_rcp_f32 v61, v61
    v_rcp_f32 v62, v62
    v_rcp_f32 v63, v63
    v_pk_mul_f32 v[88:89], v[88:89], v[48:49]
    v_pk_mul_f32 v[90:91], v[90:91], v[50:51]
    v_pk_mul_f32 v[92:93], v[92:93], v[52:53]
    v_pk_mul_f32 v[94:95], v[94:95], v[54:55]
    v_pk_mul_f32 v[96:97], v[96:97], v[56:57]
    v_pk_mul_f32 v[98:99], v[98:99], v[58:59]
    v_pk_mul_f32 v[100:101], v[100:101], v[60:61]
    v_pk_mul_f32 v[102:103], v[102:103], v[62:63]
    v_cvt_pk_bf16_f32 v64, v88, v89
    v_cvt_pk_bf16_f32 v65, v90, v91
    v_cvt_pk_bf16_f32 v66, v92, v93
    v_cvt_pk_bf16_f32 v67, v94, v95
    v_cvt_pk_bf16_f32 v68, v96, v97
    v_cvt_pk_bf16_f32 v69, v98, v99
    v_cvt_pk_bf16_f32 v70, v100, v101
    v_cvt_pk_bf16_f32 v71, v102, v103
    buffer_store_dwordx4 v[64:67], v148, s[20:23], s52 offen sc1
    buffer_store_dwordx4 v[68:71], v148, s[20:23], s52 offen offset:1024 sc1
    s_add_u32 s52, s52, 2048
    v_pk_mul_f32 v[32:33], v[104:105], v[138:139] op_sel_hi:[1,0]
    v_pk_mul_f32 v[34:35], v[106:107], v[138:139] op_sel_hi:[1,0]
    v_pk_mul_f32 v[36:37], v[108:109], v[138:139] op_sel_hi:[1,0]
    v_pk_mul_f32 v[38:39], v[110:111], v[138:139] op_sel_hi:[1,0]
    v_pk_mul_f32 v[40:41], v[112:113], v[138:139] op_sel_hi:[1,0]
    v_pk_mul_f32 v[42:43], v[114:115], v[138:139] op_sel_hi:[1,0]
    v_pk_mul_f32 v[44:45], v[116:117], v[138:139] op_sel_hi:[1,0]
    v_pk_mul_f32 v[46:47], v[118:119], v[138:139] op_sel_hi:[1,0]
    v_exp_f32 v32, v32
    v_exp_f32 v33, v33
    v_exp_f32 v34, v34
    v_exp_f32 v35, v35
    v_exp_f32 v36, v36
    v_exp_f32 v37, v37
    v_exp_f32 v38, v38
    v_exp_f32 v39, v39
    v_exp_f32 v40, v40
    v_exp_f32 v41, v41
    v_exp_f32 v42, v42
    v_exp_f32 v43, v43
    v_exp_f32 v44, v44
    v_exp_f32 v45, v45
    v_exp_f32 v46, v46
    v_exp_f32 v47, v47
    v_pk_fma_f32 v[32:33], v[32:33], v[166:167], v[166:167] op_sel_hi:[1,0,0]
    v_pk_fma_f32 v[34:35], v[34:35], v[166:167], v[166:167] op_sel_hi:[1,0,0]
    v_pk_fma_f32 v[36:37], v[36:37], v[166:167], v[166:167] op_sel_hi:[1,0,0]
    v_pk_fma_f32 v[38:39], v[38:39], v[166:167], v[166:167] op_sel_hi:[1,0,0]
    v_pk_fma_f32 v[40:41], v[40:41], v[166:167], v[166:167] op_sel_hi:[1,0,0]
    v_pk_fma_f32 v[42:43], v[42:43], v[166:167], v[166:167] op_sel_hi:[1,0,0]
    v_pk_fma_f32 v[44:45], v[44:45], v[166:167], v[166:167] op_sel_hi:[1,0,0]
    v_pk_fma_f32 v[46:47], v[46:47], v[166:167], v[166:167] op_sel_hi:[1,0,0]
    v_rcp_f32 v32, v32
    v_rcp_f32 v33, v33
    v_rcp_f32 v34, v34
    v_rcp_f32 v35, v35
    v_rcp_f32 v36, v36
    v_rcp_f32 v37, v37
    v_rcp_f32 v38, v38
    v_rcp_f32 v39, v39
    v_rcp_f32 v40, v40
    v_rcp_f32 v41, v41
    v_rcp_f32 v42, v42
    v_rcp_f32 v43, v43
    v_rcp_f32 v44, v44
    v_rcp_f32 v45, v45
    v_rcp_f32 v46, v46
    v_rcp_f32 v47, v47
    v_pk_mul_f32 v[104:105], v[104:105], v[32:33]
    v_pk_mul_f32 v[106:107], v[106:107], v[34:35]
    v_pk_mul_f32 v[108:109], v[108:109], v[36:37]
    v_pk_mul_f32 v[110:111], v[110:111], v[38:39]
    v_pk_mul_f32 v[112:113], v[112:113], v[40:41]
    v_pk_mul_f32 v[114:115], v[114:115], v[42:43]
    v_pk_mul_f32 v[116:117], v[116:117], v[44:45]
    v_pk_mul_f32 v[118:119], v[118:119], v[46:47]
    v_cvt_pk_bf16_f32 v24, v104, v105
    v_cvt_pk_bf16_f32 v25, v106, v107
    v_cvt_pk_bf16_f32 v26, v108, v109
    v_cvt_pk_bf16_f32 v27, v110, v111
    v_cvt_pk_bf16_f32 v28, v112, v113
    v_cvt_pk_bf16_f32 v29, v114, v115
    v_cvt_pk_bf16_f32 v30, v116, v117
    v_cvt_pk_bf16_f32 v31, v118, v119
    buffer_store_dwordx4 v[24:27], v148, s[20:23], s52 offen sc1
    buffer_store_dwordx4 v[28:31], v148, s[20:23], s52 offen offset:1024 sc1
    s_add_u32 s52, s52, 2048
    v_pk_mul_f32 v[48:49], v[120:121], v[138:139] op_sel_hi:[1,0]
    v_pk_mul_f32 v[50:51], v[122:123], v[138:139] op_sel_hi:[1,0]
    v_pk_mul_f32 v[52:53], v[124:125], v[138:139] op_sel_hi:[1,0]
    v_pk_mul_f32 v[54:55], v[126:127], v[138:139] op_sel_hi:[1,0]
    v_pk_mul_f32 v[56:57], v[128:129], v[138:139] op_sel_hi:[1,0]
    v_pk_mul_f32 v[58:59], v[130:131], v[138:139] op_sel_hi:[1,0]
    v_pk_mul_f32 v[60:61], v[132:133], v[138:139] op_sel_hi:[1,0]
    v_pk_mul_f32 v[62:63], v[134:135], v[138:139] op_sel_hi:[1,0]
    v_exp_f32 v48, v48
    v_exp_f32 v49, v49
    v_exp_f32 v50, v50
    v_exp_f32 v51, v51
    v_exp_f32 v52, v52
    v_exp_f32 v53, v53
    v_exp_f32 v54, v54
    v_exp_f32 v55, v55
    v_exp_f32 v56, v56
    v_exp_f32 v57, v57
    v_exp_f32 v58, v58
    v_exp_f32 v59, v59
    v_exp_f32 v60, v60
    v_exp_f32 v61, v61
    v_exp_f32 v62, v62
    v_exp_f32 v63, v63
    v_pk_fma_f32 v[48:49], v[48:49], v[166:167], v[166:167] op_sel_hi:[1,0,0]
    v_pk_fma_f32 v[50:51], v[50:51], v[166:167], v[166:167] op_sel_hi:[1,0,0]
    v_pk_fma_f32 v[52:53], v[52:53], v[166:167], v[166:167] op_sel_hi:[1,0,0]
    v_pk_fma_f32 v[54:55], v[54:55], v[166:167], v[166:167] op_sel_hi:[1,0,0]
    v_pk_fma_f32 v[56:57], v[56:57], v[166:167], v[166:167] op_sel_hi:[1,0,0]
    v_pk_fma_f32 v[58:59], v[58:59], v[166:167], v[166:167] op_sel_hi:[1,0,0]
    v_pk_fma_f32 v[60:61], v[60:61], v[166:167], v[166:167] op_sel_hi:[1,0,0]
    v_pk_fma_f32 v[62:63], v[62:63], v[166:167], v[166:167] op_sel_hi:[1,0,0]
    v_rcp_f32 v48, v48
    v_rcp_f32 v49, v49
    v_rcp_f32 v50, v50
    v_rcp_f32 v51, v51
    v_rcp_f32 v52, v52
    v_rcp_f32 v53, v53
    v_rcp_f32 v54, v54
    v_rcp_f32 v55, v55
    v_rcp_f32 v56, v56
    v_rcp_f32 v57, v57
    v_rcp_f32 v58, v58
    v_rcp_f32 v59, v59
    v_rcp_f32 v60, v60
    v_rcp_f32 v61, v61
    v_rcp_f32 v62, v62
    v_rcp_f32 v63, v63
    v_pk_mul_f32 v[120:121], v[120:121], v[48:49]
    v_pk_mul_f32 v[122:123], v[122:123], v[50:51]
    v_pk_mul_f32 v[124:125], v[124:125], v[52:53]
    v_pk_mul_f32 v[126:127], v[126:127], v[54:55]
    v_pk_mul_f32 v[128:129], v[128:129], v[56:57]
    v_pk_mul_f32 v[130:131], v[130:131], v[58:59]
    v_pk_mul_f32 v[132:133], v[132:133], v[60:61]
    v_pk_mul_f32 v[134:135], v[134:135], v[62:63]
    v_cvt_pk_bf16_f32 v64, v120, v121
    v_cvt_pk_bf16_f32 v65, v122, v123
    v_cvt_pk_bf16_f32 v66, v124, v125
    v_cvt_pk_bf16_f32 v67, v126, v127
    v_cvt_pk_bf16_f32 v68, v128, v129
    v_cvt_pk_bf16_f32 v69, v130, v131
    v_cvt_pk_bf16_f32 v70, v132, v133
    v_cvt_pk_bf16_f32 v71, v134, v135
    buffer_store_dwordx4 v[64:67], v148, s[20:23], s52 offen sc1
    buffer_store_dwordx4 v[68:71], v148, s[20:23], s52 offen offset:1024 sc1
    s_add_u32 s52, s52, 2048
    s_waitcnt vmcnt(0)
    s_branch p1_end
p1_typeB1:
    s_waitcnt vmcnt(6)
    s_barrier
    ds_read_b128 v[32:35], v5 offset:1024
    ds_read_b64_tr_b16 v[36:37], v13 offset:256
    ds_read_b64_tr_b16 v[38:39], v13 offset:2048
    ds_read_b64_tr_b16 v[40:41], v13 offset:320
    ds_read_b64_tr_b16 v[42:43], v13 offset:2112
    ds_read_b64_tr_b16 v[44:45], v13 offset:384
    ds_read_b64_tr_b16 v[46:47], v13 offset:2176
    ds_read_b128 v[52:55], v6 offset:1024
    ds_read_b64_tr_b16 v[56:57], v13 offset:7424
    ds_read_b64_tr_b16 v[58:59], v13 offset:9216
    ds_read_b64_tr_b16 v[60:61], v13 offset:7488
    ds_read_b64_tr_b16 v[62:63], v13 offset:9280
    ds_read_b64_tr_b16 v[64:65], v13 offset:7552
    ds_read_b64_tr_b16 v[66:67], v13 offset:9344
    s_waitcnt lgkmcnt(11)
    v_mfma_f32_32x32x16_bf16 v[72:87], v[36:39], v[32:35], 0
    s_add_u32 m0, s50, 33792
    s_nop 0
    buffer_load_dwordx4 v2, s[8:11], s56 offen lds
    s_add_u32 m0, s50, 34816
    s_nop 0
    buffer_load_dwordx4 v3, s[8:11], s56 offen lds
    s_add_u32 s56, s56, 128
    s_and_b32 s56, s56, 1023
    v_lshlrev_b32 v19, 16, v34
    v_and_b32 v20, 0xffff0000, v34
    v_add_f32 v15, v15, v19
    v_fmac_f32 v16, v19, v19
    s_waitcnt lgkmcnt(9)
    v_mfma_f32_32x32x16_bf16 v[88:103], v[40:43], v[32:35], 0
    s_mul_i32 s66, s57, 3584
    s_add_u32 m0, s51, 123904
    s_mov_b64 exec, s[64:65]
    buffer_load_dwordx4 v4, s[16:19], s66 offen lds
    s_add_u32 s66, s66, 7168
    s_add_u32 m0, s51, 124800
    s_nop 0
    buffer_load_dwordx4 v4, s[16:19], s66 offen lds
    s_mov_b64 exec, -1
    s_add_u32 s57, s57, 32
    s_and_b32 s57, s57, 511
    s_waitcnt lgkmcnt(7)
    v_mfma_f32_32x32x16_bf16 v[104:119], v[44:47], v[32:35], 0
    v_add_f32 v17, v17, v20
    v_fmac_f32 v18, v20, v20
    v_lshlrev_b32 v21, 16, v35
    v_and_b32 v22, 0xffff0000, v35
    v_add_f32 v15, v15, v21
    v_fmac_f32 v16, v21, v21
    v_add_f32 v17, v17, v22
    v_fmac_f32 v18, v22, v22
    s_cmp_eq_u32 s45, 0
    s_cbranch_scc0 p1_loopB1_p
    v_mfma_f32_16x16x32_bf16 v[168:171], v[36:39], v[248:251], v[168:171]
    v_mfma_f32_16x16x32_bf16 v[172:175], v[40:43], v[248:251], v[172:175]
    v_mfma_f32_16x16x32_bf16 v[176:179], v[44:47], v[248:251], v[176:179]
p1_loopB1_p:
    s_waitcnt lgkmcnt(4)
    v_mfma_f32_32x32x16_bf16 v[72:87], v[56:59], v[52:55], v[72:87]
    ds_read_b128 v[32:35], v7 offset:1024
    ds_read_b64_tr_b16 v[36:37], v13 offset:14592
    ds_read_b64_tr_b16 v[38:39], v13 offset:16384
    ds_read_b64_tr_b16 v[40:41], v13 offset:14656
    ds_read_b64_tr_b16 v[42:43], v13 offset:16448
    ds_read_b64_tr_b16 v[44:45], v13 offset:14720
    ds_read_b64_tr_b16 v[46:47], v13 offset:16512
    v_lshlrev_b32 v19, 16, v54
    v_and_b32 v20, 0xffff0000, v54
    v_add_f32 v15, v15, v19
    s_waitcnt lgkmcnt(9)
    v_mfma_f32_32x32x16_bf16 v[88:103], v[60:63], v[52:55], v[88:103]
    s_mul_i32 s66, s57, 3584
    s_add_u32 m0, s51, 138240
    s_mov_b64 exec, s[64:65]
    buffer_load_dwordx4 v4, s[16:19], s66 offen lds
    s_add_u32 s66, s66, 7168
    s_add_u32 m0, s51, 139136
    s_nop 0
    buffer_load_dwordx4 v4, s[16:19], s66 offen lds
    s_mov_b64 exec, -1
    s_add_u32 s57, s57, 32
    s_and_b32 s57, s57, 511
    s_waitcnt lgkmcnt(7)
    v_mfma_f32_32x32x16_bf16 v[104:119], v[64:67], v[52:55], v[104:119]
    v_fmac_f32 v16, v19, v19
    v_add_f32 v17, v17, v20
    v_fmac_f32 v18, v20, v20
    v_lshlrev_b32 v21, 16, v55
    v_and_b32 v22, 0xffff0000, v55
    v_add_f32 v15, v15, v21
    v_fmac_f32 v16, v21, v21
    v_add_f32 v17, v17, v22
    v_fmac_f32 v18, v22, v22
    s_cmp_eq_u32 s45, 1
    s_cbranch_scc0 p1_loopB1_a0
    v_mfma_f32_16x16x32_bf16 v[168:171], v[56:59], v[248:251], v[168:171]
    v_mfma_f32_16x16x32_bf16 v[172:175], v[60:63], v[248:251], v[172:175]
    v_mfma_f32_16x16x32_bf16 v[176:179], v[64:67], v[248:251], v[176:179]
p1_loopB1_a0:
    s_waitcnt lgkmcnt(4)
    v_mfma_f32_32x32x16_bf16 v[72:87], v[36:39], v[32:35], v[72:87]
    ds_read_b128 v[52:55], v8 offset:1024
    ds_read_b64_tr_b16 v[56:57], v13 offset:21760
    ds_read_b64_tr_b16 v[58:59], v13 offset:23552
    ds_read_b64_tr_b16 v[60:61], v13 offset:21824
    ds_read_b64_tr_b16 v[62:63], v13 offset:23616
    ds_read_b64_tr_b16 v[64:65], v13 offset:21888
    ds_read_b64_tr_b16 v[66:67], v13 offset:23680
    s_add_u32 m0, s50, 50176
    s_nop 0
    buffer_load_dwordx4 v2, s[8:11], s56 offen lds
    s_waitcnt lgkmcnt(9)
    v_mfma_f32_32x32x16_bf16 v[88:103], v[40:43], v[32:35], v[88:103]
    s_add_u32 m0, s50, 51200
    s_nop 0
    buffer_load_dwordx4 v3, s[8:11], s56 offen lds
    s_add_u32 s56, s56, 128
    s_and_b32 s56, s56, 1023
    v_lshlrev_b32 v19, 16, v34
    v_and_b32 v20, 0xffff0000, v34
    v_add_f32 v15, v15, v19
    v_fmac_f32 v16, v19, v19
    v_add_f32 v17, v17, v20
    s_waitcnt lgkmcnt(7)
    v_mfma_f32_32x32x16_bf16 v[104:119], v[44:47], v[32:35], v[104:119]
    v_fmac_f32 v18, v20, v20
    v_lshlrev_b32 v21, 16, v35
    v_and_b32 v22, 0xffff0000, v35
    v_add_f32 v15, v15, v21
    v_fmac_f32 v16, v21, v21
    v_add_f32 v17, v17, v22
    v_fmac_f32 v18, v22, v22
    s_cmp_eq_u32 s45, 2
    s_cbranch_scc0 p1_loopB1_b0
    v_mfma_f32_16x16x32_bf16 v[168:171], v[36:39], v[248:251], v[168:171]
    v_mfma_f32_16x16x32_bf16 v[172:175], v[40:43], v[248:251], v[172:175]
    v_mfma_f32_16x16x32_bf16 v[176:179], v[44:47], v[248:251], v[176:179]
p1_loopB1_b0:
    s_waitcnt vmcnt(8) lgkmcnt(0)
    s_barrier
    v_mfma_f32_32x32x16_bf16 v[72:87], v[56:59], v[52:55], v[72:87]
    ds_read_b128 v[32:35], v5 offset:17408
    ds_read_b64_tr_b16 v[36:37], v13 offset:28928
    ds_read_b64_tr_b16 v[38:39], v13 offset:30720
    ds_read_b64_tr_b16 v[40:41], v13 offset:28992
    ds_read_b64_tr_b16 v[42:43], v13 offset:30784
    ds_read_b64_tr_b16 v[44:45], v13 offset:29056
    ds_read_b64_tr_b16 v[46:47], v13 offset:30848
    s_add_u32 m0, s50, 1024
    s_nop 0
    buffer_load_dwordx4 v2, s[8:11], s56 offen lds
    v_mfma_f32_32x32x16_bf16 v[88:103], v[60:63], v[52:55], v[88:103]
    s_add_u32 m0, s50, 2048
    s_nop 0
    buffer_load_dwordx4 v3, s[8:11], s56 offen lds
    s_add_u32 s56, s56, 128
    s_and_b32 s56, s56, 1023
    v_lshlrev_b32 v19, 16, v54
    v_and_b32 v20, 0xffff0000, v54
    v_add_f32 v15, v15, v19
    v_fmac_f32 v16, v19, v19
    v_add_f32 v17, v17, v20
    v_mfma_f32_32x32x16_bf16 v[104:119], v[64:67], v[52:55], v[104:119]
    v_fmac_f32 v18, v20, v20
    v_lshlrev_b32 v21, 16, v55
    v_and_b32 v22, 0xffff0000, v55
    v_add_f32 v15, v15, v21
    v_fmac_f32 v16, v21, v21
    v_add_f32 v17, v17, v22
    v_fmac_f32 v18, v22, v22
    s_cmp_eq_u32 s45, 3
    s_cbranch_scc0 p1_loopB1_a1
    v_mfma_f32_16x16x32_bf16 v[168:171], v[56:59], v[248:251], v[168:171]
    v_mfma_f32_16x16x32_bf16 v[172:175], v[60:63], v[248:251], v[172:175]
    v_mfma_f32_16x16x32_bf16 v[176:179], v[64:67], v[248:251], v[176:179]
p1_loopB1_a1:
    s_waitcnt lgkmcnt(4)
    v_mfma_f32_32x32x16_bf16 v[72:87], v[36:39], v[32:35], v[72:87]
    ds_read_b128 v[52:55], v6 offset:17408
    ds_read_b64_tr_b16 v[56:57], v13 offset:36096
    ds_read_b64_tr_b16 v[58:59], v13 offset:37888
    ds_read_b64_tr_b16 v[60:61], v13 offset:36160
    ds_read_b64_tr_b16 v[62:63], v13 offset:37952
    ds_read_b64_tr_b16 v[64:65], v13 offset:36224
    ds_read_b64_tr_b16 v[66:67], v13 offset:38016
    v_lshlrev_b32 v19, 16, v34
    v_and_b32 v20, 0xffff0000, v34
    v_add_f32 v15, v15, v19
    s_waitcnt lgkmcnt(9)
    v_mfma_f32_32x32x16_bf16 v[88:103], v[40:43], v[32:35], v[88:103]
    s_mul_i32 s66, s57, 3584
    s_add_u32 m0, s51, 66560
    s_mov_b64 exec, s[64:65]
    buffer_load_dwordx4 v4, s[16:19], s66 offen lds
    s_add_u32 s66, s66, 7168
    s_add_u32 m0, s51, 67456
    s_nop 0
    buffer_load_dwordx4 v4, s[16:19], s66 offen lds
    s_mov_b64 exec, -1
    s_add_u32 s57, s57, 32
    s_and_b32 s57, s57, 511
    s_waitcnt lgkmcnt(7)
    v_mfma_f32_32x32x16_bf16 v[104:119], v[44:47], v[32:35], v[104:119]
    v_fmac_f32 v16, v19, v19
    v_add_f32 v17, v17, v20
    v_fmac_f32 v18, v20, v20
    v_lshlrev_b32 v21, 16, v35
    v_and_b32 v22, 0xffff0000, v35
    v_add_f32 v15, v15, v21
    v_fmac_f32 v16, v21, v21
    v_add_f32 v17, v17, v22
    v_fmac_f32 v18, v22, v22
    s_cmp_eq_u32 s45, 0
    s_cbranch_scc0 p1_loopB1_b1
    v_mfma_f32_16x16x32_bf16 v[168:171], v[36:39], v[248:251], v[168:171]
    v_mfma_f32_16x16x32_bf16 v[172:175], v[40:43], v[248:251], v[172:175]
    v_mfma_f32_16x16x32_bf16 v[176:179], v[44:47], v[248:251], v[176:179]
p1_loopB1_b1:
    s_waitcnt lgkmcnt(4)
    v_mfma_f32_32x32x16_bf16 v[72:87], v[56:59], v[52:55], v[72:87]
    ds_read_b128 v[32:35], v7 offset:17408
    ds_read_b64_tr_b16 v[36:37], v13 offset:43264
    ds_read_b64_tr_b16 v[38:39], v13 offset:45056
    ds_read_b64_tr_b16 v[40:41], v13 offset:43328
    ds_read_b64_tr_b16 v[42:43], v13 offset:45120
    ds_read_b64_tr_b16 v[44:45], v13 offset:43392
    ds_read_b64_tr_b16 v[46:47], v13 offset:45184
    v_lshlrev_b32 v19, 16, v54
    v_and_b32 v20, 0xffff0000, v54
    v_add_f32 v15, v15, v19
    s_waitcnt lgkmcnt(9)
    v_mfma_f32_32x32x16_bf16 v[88:103], v[60:63], v[52:55], v[88:103]
    s_mul_i32 s66, s57, 3584
    s_add_u32 m0, s51, 80896
    s_mov_b64 exec, s[64:65]
    buffer_load_dwordx4 v4, s[16:19], s66 offen lds
    s_add_u32 s66, s66, 7168
    s_add_u32 m0, s51, 81792
    s_nop 0
    buffer_load_dwordx4 v4, s[16:19], s66 offen lds
    s_mov_b64 exec, -1
    s_add_u32 s57, s57, 32
    s_and_b32 s57, s57, 511
    s_waitcnt lgkmcnt(7)
    v_mfma_f32_32x32x16_bf16 v[104:119], v[64:67], v[52:55], v[104:119]
    v_fmac_f32 v16, v19, v19
    v_add_f32 v17, v17, v20
    v_fmac_f32 v18, v20, v20
    v_lshlrev_b32 v21, 16, v55
    v_and_b32 v22, 0xffff0000, v55
    v_add_f32 v15, v15, v21
    v_fmac_f32 v16, v21, v21
    v_add_f32 v17, v17, v22
    v_fmac_f32 v18, v22, v22
    s_cmp_eq_u32 s45, 1
    s_cbranch_scc0 p1_loopB1_a2
    v_mfma_f32_16x16x32_bf16 v[168:171], v[56:59], v[248:251], v[168:171]
    v_mfma_f32_16x16x32_bf16 v[172:175], v[60:63], v[248:251], v[172:175]
    v_mfma_f32_16x16x32_bf16 v[176:179], v[64:67], v[248:251], v[176:179]
p1_loopB1_a2:
    s_waitcnt lgkmcnt(4)
    v_mfma_f32_32x32x16_bf16 v[72:87], v[36:39], v[32:35], v[72:87]
    ds_read_b128 v[52:55], v8 offset:17408
    ds_read_b64_tr_b16 v[56:57], v13 offset:50432
    ds_read_b64_tr_b16 v[58:59], v13 offset:52224
    ds_read_b64_tr_b16 v[60:61], v13 offset:50496
    ds_read_b64_tr_b16 v[62:63], v13 offset:52288
    ds_read_b64_tr_b16 v[64:65], v13 offset:50560
    ds_read_b64_tr_b16 v[66:67], v13 offset:52352
    s_waitcnt lgkmcnt(9)
    v_mfma_f32_32x32x16_bf16 v[88:103], v[40:43], v[32:35], v[88:103]
    v_lshlrev_b32 v19, 16, v34
    v_and_b32 v20, 0xffff0000, v34
    v_add_f32 v15, v15, v19
    v_fmac_f32 v16, v19, v19
    v_add_f32 v17, v17, v20
    v_fmac_f32 v18, v20, v20
    v_lshlrev_b32 v21, 16, v35
    s_waitcnt lgkmcnt(7)
    v_mfma_f32_32x32x16_bf16 v[104:119], v[44:47], v[32:35], v[104:119]
    v_and_b32 v22, 0xffff0000, v35
    v_add_f32 v15, v15, v21
    v_fmac_f32 v16, v21, v21
    v_add_f32 v17, v17, v22
    v_fmac_f32 v18, v22, v22
    s_cmp_eq_u32 s45, 2
    s_cbranch_scc0 p1_loopB1_b2
    v_mfma_f32_16x16x32_bf16 v[168:171], v[36:39], v[248:251], v[168:171]
    v_mfma_f32_16x16x32_bf16 v[172:175], v[40:43], v[248:251], v[172:175]
    v_mfma_f32_16x16x32_bf16 v[176:179], v[44:47], v[248:251], v[176:179]
p1_loopB1_b2:
    s_waitcnt vmcnt(8) lgkmcnt(0)
    s_barrier
    v_mfma_f32_32x32x16_bf16 v[72:87], v[56:59], v[52:55], v[72:87]
    ds_read_b128 v[32:35], v5 offset:33792
    ds_read_b64_tr_b16 v[36:37], v14 offset:256
    ds_read_b64_tr_b16 v[38:39], v14 offset:2048
    ds_read_b64_tr_b16 v[40:41], v14 offset:320
    ds_read_b64_tr_b16 v[42:43], v14 offset:2112
    ds_read_b64_tr_b16 v[44:45], v14 offset:384
    ds_read_b64_tr_b16 v[46:47], v14 offset:2176
    s_add_u32 m0, s50, 17408
    s_nop 0
    buffer_load_dwordx4 v2, s[8:11], s56 offen lds
    v_mfma_f32_32x32x16_bf16 v[88:103], v[60:63], v[52:55], v[88:103]
    s_add_u32 m0, s50, 18432
    s_nop 0
    buffer_load_dwordx4 v3, s[8:11], s56 offen lds
    s_add_u32 s56, s56, 128
    s_and_b32 s56, s56, 1023
    v_lshlrev_b32 v19, 16, v54
    v_and_b32 v20, 0xffff0000, v54
    v_add_f32 v15, v15, v19
    v_fmac_f32 v16, v19, v19
    v_add_f32 v17, v17, v20
    v_mfma_f32_32x32x16_bf16 v[104:119], v[64:67], v[52:55], v[104:119]
    v_fmac_f32 v18, v20, v20
    v_lshlrev_b32 v21, 16, v55
    v_and_b32 v22, 0xffff0000, v55
    v_add_f32 v15, v15, v21
    v_fmac_f32 v16, v21, v21
    v_add_f32 v17, v17, v22
    v_fmac_f32 v18, v22, v22
    s_cmp_eq_u32 s45, 3
    s_cbranch_scc0 p1_loopB1_a3
    v_mfma_f32_16x16x32_bf16 v[168:171], v[56:59], v[248:251], v[168:171]
    v_mfma_f32_16x16x32_bf16 v[172:175], v[60:63], v[248:251], v[172:175]
    v_mfma_f32_16x16x32_bf16 v[176:179], v[64:67], v[248:251], v[176:179]
p1_loopB1_a3:
    s_waitcnt lgkmcnt(4)
    v_mfma_f32_32x32x16_bf16 v[72:87], v[36:39], v[32:35], v[72:87]
    ds_read_b128 v[52:55], v6 offset:33792
    ds_read_b64_tr_b16 v[56:57], v14 offset:7424
    ds_read_b64_tr_b16 v[58:59], v14 offset:9216
    ds_read_b64_tr_b16 v[60:61], v14 offset:7488
    ds_read_b64_tr_b16 v[62:63], v14 offset:9280
    ds_read_b64_tr_b16 v[64:65], v14 offset:7552
    ds_read_b64_tr_b16 v[66:67], v14 offset:9344
    v_lshlrev_b32 v19, 16, v34
    v_and_b32 v20, 0xffff0000, v34
    v_add_f32 v15, v15, v19
    s_waitcnt lgkmcnt(9)
    v_mfma_f32_32x32x16_bf16 v[88:103], v[40:43], v[32:35], v[88:103]
    s_mul_i32 s66, s57, 3584
    s_add_u32 m0, s51, 95232
    s_mov_b64 exec, s[64:65]
    buffer_load_dwordx4 v4, s[16:19], s66 offen lds
    s_add_u32 s66, s66, 7168
    s_add_u32 m0, s51, 96128
    s_nop 0
    buffer_load_dwordx4 v4, s[16:19], s66 offen lds
    s_mov_b64 exec, -1
    s_add_u32 s57, s57, 32
    s_and_b32 s57, s57, 511
    s_waitcnt lgkmcnt(7)
    v_mfma_f32_32x32x16_bf16 v[104:119], v[44:47], v[32:35], v[104:119]
    v_fmac_f32 v16, v19, v19
    v_add_f32 v17, v17, v20
    v_fmac_f32 v18, v20, v20
    v_lshlrev_b32 v21, 16, v35
    v_and_b32 v22, 0xffff0000, v35
    v_add_f32 v15, v15, v21
    v_fmac_f32 v16, v21, v21
    v_add_f32 v17, v17, v22
    v_fmac_f32 v18, v22, v22
    s_cmp_eq_u32 s45, 0
    s_cbranch_scc0 p1_loopB1_b3
    v_mfma_f32_16x16x32_bf16 v[168:171], v[36:39], v[248:251], v[168:171]
    v_mfma_f32_16x16x32_bf16 v[172:175], v[40:43], v[248:251], v[172:175]
    v_mfma_f32_16x16x32_bf16 v[176:179], v[44:47], v[248:251], v[176:179]
p1_loopB1_b3:
    s_waitcnt lgkmcnt(4)
    v_mfma_f32_32x32x16_bf16 v[72:87], v[56:59], v[52:55], v[72:87]
    ds_read_b128 v[32:35], v7 offset:33792
    ds_read_b64_tr_b16 v[36:37], v14 offset:14592
    ds_read_b64_tr_b16 v[38:39], v14 offset:16384
    ds_read_b64_tr_b16 v[40:41], v14 offset:14656
    ds_read_b64_tr_b16 v[42:43], v14 offset:16448
    ds_read_b64_tr_b16 v[44:45], v14 offset:14720
    ds_read_b64_tr_b16 v[46:47], v14 offset:16512
    v_lshlrev_b32 v19, 16, v54
    v_and_b32 v20, 0xffff0000, v54
    v_add_f32 v15, v15, v19
    s_waitcnt lgkmcnt(9)
    v_mfma_f32_32x32x16_bf16 v[88:103], v[60:63], v[52:55], v[88:103]
    s_mul_i32 s66, s57, 3584
    s_add_u32 m0, s51, 109568
    s_mov_b64 exec, s[64:65]
    buffer_load_dwordx4 v4, s[16:19], s66 offen lds
    s_add_u32 s66, s66, 7168
    s_add_u32 m0, s51, 110464
    s_nop 0
    buffer_load_dwordx4 v4, s[16:19], s66 offen lds
    s_mov_b64 exec, -1
    s_add_u32 s57, s57, 32
    s_and_b32 s57, s57, 511
    s_waitcnt lgkmcnt(7)
    v_mfma_f32_32x32x16_bf16 v[104:119], v[64:67], v[52:55], v[104:119]
    v_fmac_f32 v16, v19, v19
    v_add_f32 v17, v17, v20
    v_fmac_f32 v18, v20, v20
    v_lshlrev_b32 v21, 16, v55
    v_and_b32 v22, 0xffff0000, v55
    v_add_f32 v15, v15, v21
    v_fmac_f32 v16, v21, v21
    v_add_f32 v17, v17, v22
    v_fmac_f32 v18, v22, v22
    s_cmp_eq_u32 s45, 1
    s_cbranch_scc0 p1_loopB1_a4
    v_mfma_f32_16x16x32_bf16 v[168:171], v[56:59], v[248:251], v[168:171]
    v_mfma_f32_16x16x32_bf16 v[172:175], v[60:63], v[248:251], v[172:175]
    v_mfma_f32_16x16x32_bf16 v[176:179], v[64:67], v[248:251], v[176:179]
p1_loopB1_a4:
    s_waitcnt lgkmcnt(4)
    v_mfma_f32_32x32x16_bf16 v[72:87], v[36:39], v[32:35], v[72:87]
    ds_read_b128 v[52:55], v8 offset:33792
    ds_read_b64_tr_b16 v[56:57], v14 offset:21760
    ds_read_b64_tr_b16 v[58:59], v14 offset:23552
    ds_read_b64_tr_b16 v[60:61], v14 offset:21824
    ds_read_b64_tr_b16 v[62:63], v14 offset:23616
    ds_read_b64_tr_b16 v[64:65], v14 offset:21888
    ds_read_b64_tr_b16 v[66:67], v14 offset:23680
    s_waitcnt lgkmcnt(9)
    v_mfma_f32_32x32x16_bf16 v[88:103], v[40:43], v[32:35], v[88:103]
    v_lshlrev_b32 v19, 16, v34
    v_and_b32 v20, 0xffff0000, v34
    v_add_f32 v15, v15, v19
    v_fmac_f32 v16, v19, v19
    v_add_f32 v17, v17, v20
    v_fmac_f32 v18, v20, v20
    v_lshlrev_b32 v21, 16, v35
    s_waitcnt lgkmcnt(7)
    v_mfma_f32_32x32x16_bf16 v[104:119], v[44:47], v[32:35], v[104:119]
    v_and_b32 v22, 0xffff0000, v35
    v_add_f32 v15, v15, v21
    v_fmac_f32 v16, v21, v21
    v_add_f32 v17, v17, v22
    v_fmac_f32 v18, v22, v22
    s_cmp_eq_u32 s45, 2
    s_cbranch_scc0 p1_loopB1_b4
    v_mfma_f32_16x16x32_bf16 v[168:171], v[36:39], v[248:251], v[168:171]
    v_mfma_f32_16x16x32_bf16 v[172:175], v[40:43], v[248:251], v[172:175]
    v_mfma_f32_16x16x32_bf16 v[176:179], v[44:47], v[248:251], v[176:179]
p1_loopB1_b4:
    s_waitcnt vmcnt(6) lgkmcnt(0)
    s_barrier
    v_mfma_f32_32x32x16_bf16 v[72:87], v[56:59], v[52:55], v[72:87]
    ds_read_b128 v[32:35], v5 offset:50176
    ds_read_b64_tr_b16 v[36:37], v13 offset:256
    ds_read_b64_tr_b16 v[38:39], v13 offset:2048
    ds_read_b64_tr_b16 v[40:41], v13 offset:320
    ds_read_b64_tr_b16 v[42:43], v13 offset:2112
    ds_read_b64_tr_b16 v[44:45], v13 offset:384
    ds_read_b64_tr_b16 v[46:47], v13 offset:2176
    s_add_u32 m0, s50, 33792
    s_nop 0
    buffer_load_dwordx4 v2, s[8:11], s56 offen lds
    v_mfma_f32_32x32x16_bf16 v[88:103], v[60:63], v[52:55], v[88:103]
    s_add_u32 m0, s50, 34816
    s_nop 0
    buffer_load_dwordx4 v3, s[8:11], s56 offen lds
    s_add_u32 s56, s56, 128
    s_and_b32 s56, s56, 1023
    v_lshlrev_b32 v19, 16, v54
    v_and_b32 v20, 0xffff0000, v54
    v_add_f32 v15, v15, v19
    v_fmac_f32 v16, v19, v19
    v_add_f32 v17, v17, v20
    v_mfma_f32_32x32x16_bf16 v[104:119], v[64:67], v[52:55], v[104:119]
    v_fmac_f32 v18, v20, v20
    v_lshlrev_b32 v21, 16, v55
    v_and_b32 v22, 0xffff0000, v55
    v_add_f32 v15, v15, v21
    v_fmac_f32 v16, v21, v21
    v_add_f32 v17, v17, v22
    v_fmac_f32 v18, v22, v22
    s_cmp_eq_u32 s45, 3
    s_cbranch_scc0 p1_loopB1_a5
    v_mfma_f32_16x16x32_bf16 v[168:171], v[56:59], v[248:251], v[168:171]
    v_mfma_f32_16x16x32_bf16 v[172:175], v[60:63], v[248:251], v[172:175]
    v_mfma_f32_16x16x32_bf16 v[176:179], v[64:67], v[248:251], v[176:179]
p1_loopB1_a5:
    s_waitcnt lgkmcnt(4)
    v_mfma_f32_32x32x16_bf16 v[72:87], v[36:39], v[32:35], v[72:87]
    ds_read_b128 v[52:55], v6 offset:50176
    ds_read_b64_tr_b16 v[56:57], v13 offset:7424
    ds_read_b64_tr_b16 v[58:59], v13 offset:9216
    ds_read_b64_tr_b16 v[60:61], v13 offset:7488
    ds_read_b64_tr_b16 v[62:63], v13 offset:9280
    ds_read_b64_tr_b16 v[64:65], v13 offset:7552
    ds_read_b64_tr_b16 v[66:67], v13 offset:9344
    v_lshlrev_b32 v19, 16, v34
    v_and_b32 v20, 0xffff0000, v34
    v_add_f32 v15, v15, v19
    s_waitcnt lgkmcnt(9)
    v_mfma_f32_32x32x16_bf16 v[88:103], v[40:43], v[32:35], v[88:103]
    s_mul_i32 s66, s57, 3584
    s_add_u32 m0, s51, 123904
    s_mov_b64 exec, s[64:65]
    buffer_load_dwordx4 v4, s[16:19], s66 offen lds
    s_add_u32 s66, s66, 7168
    s_add_u32 m0, s51, 124800
    s_nop 0
    buffer_load_dwordx4 v4, s[16:19], s66 offen lds
    s_mov_b64 exec, -1
    s_add_u32 s57, s57, 32
    s_and_b32 s57, s57, 511
    s_waitcnt lgkmcnt(7)
    v_mfma_f32_32x32x16_bf16 v[104:119], v[44:47], v[32:35], v[104:119]
    v_fmac_f32 v16, v19, v19
    v_add_f32 v17, v17, v20
    v_fmac_f32 v18, v20, v20
    v_lshlrev_b32 v21, 16, v35
    v_and_b32 v22, 0xffff0000, v35
    v_add_f32 v15, v15, v21
    v_fmac_f32 v16, v21, v21
    v_add_f32 v17, v17, v22
    v_fmac_f32 v18, v22, v22
    s_cmp_eq_u32 s45, 0
    s_cbranch_scc0 p1_loopB1_b5
    v_mfma_f32_16x16x32_bf16 v[168:171], v[36:39], v[248:251], v[168:171]
    v_mfma_f32_16x16x32_bf16 v[172:175], v[40:43], v[248:251], v[172:175]
    v_mfma_f32_16x16x32_bf16 v[176:179], v[44:47], v[248:251], v[176:179]
p1_loopB1_b5:
    s_waitcnt lgkmcnt(4)
    v_mfma_f32_32x32x16_bf16 v[72:87], v[56:59], v[52:55], v[72:87]
    ds_read_b128 v[32:35], v7 offset:50176
    ds_read_b64_tr_b16 v[36:37], v13 offset:14592
    ds_read_b64_tr_b16 v[38:39], v13 offset:16384
    ds_read_b64_tr_b16 v[40:41], v13 offset:14656
    ds_read_b64_tr_b16 v[42:43], v13 offset:16448
    ds_read_b64_tr_b16 v[44:45], v13 offset:14720
    ds_read_b64_tr_b16 v[46:47], v13 offset:16512
    v_lshlrev_b32 v19, 16, v54
    v_and_b32 v20, 0xffff0000, v54
    v_add_f32 v15, v15, v19
    s_waitcnt lgkmcnt(9)
    v_mfma_f32_32x32x16_bf16 v[88:103], v[60:63], v[52:55], v[88:103]
    s_mul_i32 s66, s57, 3584
    s_add_u32 m0, s51, 138240
    s_mov_b64 exec, s[64:65]
    buffer_load_dwordx4 v4, s[16:19], s66 offen lds
    s_add_u32 s66, s66, 7168
    s_add_u32 m0, s51, 139136
    s_nop 0
    buffer_load_dwordx4 v4, s[16:19], s66 offen lds
    s_mov_b64 exec, -1
    s_add_u32 s57, s57, 32
    s_and_b32 s57, s57, 511
    s_waitcnt lgkmcnt(7)
    v_mfma_f32_32x32x16_bf16 v[104:119], v[64:67], v[52:55], v[104:119]
    v_fmac_f32 v16, v19, v19
    v_add_f32 v17, v17, v20
    v_fmac_f32 v18, v20, v20
    v_lshlrev_b32 v21, 16, v55
    v_and_b32 v22, 0xffff0000, v55
    v_add_f32 v15, v15, v21
    v_fmac_f32 v16, v21, v21
    v_add_f32 v17, v17, v22
    v_fmac_f32 v18, v22, v22
    s_cmp_eq_u32 s45, 1
    s_cbranch_scc0 p1_loopB1_a6
    v_mfma_f32_16x16x32_bf16 v[168:171], v[56:59], v[248:251], v[168:171]
    v_mfma_f32_16x16x32_bf16 v[172:175], v[60:63], v[248:251], v[172:175]
    v_mfma_f32_16x16x32_bf16 v[176:179], v[64:67], v[248:251], v[176:179]
p1_loopB1_a6:
    s_waitcnt lgkmcnt(4)
    v_mfma_f32_32x32x16_bf16 v[72:87], v[36:39], v[32:35], v[72:87]
    ds_read_b128 v[52:55], v8 offset:50176
    ds_read_b64_tr_b16 v[56:57], v13 offset:21760
    ds_read_b64_tr_b16 v[58:59], v13 offset:23552
    ds_read_b64_tr_b16 v[60:61], v13 offset:21824
    ds_read_b64_tr_b16 v[62:63], v13 offset:23616
    ds_read_b64_tr_b16 v[64:65], v13 offset:21888
    ds_read_b64_tr_b16 v[66:67], v13 offset:23680
    s_waitcnt lgkmcnt(9)
    v_mfma_f32_32x32x16_bf16 v[88:103], v[40:43], v[32:35], v[88:103]
    v_lshlrev_b32 v19, 16, v34
    v_and_b32 v20, 0xffff0000, v34
    v_add_f32 v15, v15, v19
    v_fmac_f32 v16, v19, v19
    v_add_f32 v17, v17, v20
    v_fmac_f32 v18, v20, v20
    v_lshlrev_b32 v21, 16, v35
    s_waitcnt lgkmcnt(7)
    v_mfma_f32_32x32x16_bf16 v[104:119], v[44:47], v[32:35], v[104:119]
    v_and_b32 v22, 0xffff0000, v35
    v_add_f32 v15, v15, v21
    v_fmac_f32 v16, v21, v21
    v_add_f32 v17, v17, v22
    v_fmac_f32 v18, v22, v22
    s_cmp_eq_u32 s45, 2
    s_cbranch_scc0 p1_loopB1_b6
    v_mfma_f32_16x16x32_bf16 v[168:171], v[36:39], v[248:251], v[168:171]
    v_mfma_f32_16x16x32_bf16 v[172:175], v[40:43], v[248:251], v[172:175]
    v_mfma_f32_16x16x32_bf16 v[176:179], v[44:47], v[248:251], v[176:179]
p1_loopB1_b6:
    s_waitcnt vmcnt(6) lgkmcnt(0)
    s_barrier
    v_mfma_f32_32x32x16_bf16 v[72:87], v[56:59], v[52:55], v[72:87]
    ds_read_b128 v[32:35], v5 offset:1024
    ds_read_b64_tr_b16 v[36:37], v13 offset:28928
    ds_read_b64_tr_b16 v[38:39], v13 offset:30720
    ds_read_b64_tr_b16 v[40:41], v13 offset:28992
    ds_read_b64_tr_b16 v[42:43], v13 offset:30784
    ds_read_b64_tr_b16 v[44:45], v13 offset:29056
    ds_read_b64_tr_b16 v[46:47], v13 offset:30848
    s_add_u32 m0, s50, 50176
    s_nop 0
    buffer_load_dwordx4 v2, s[8:11], s56 offen lds
    v_mfma_f32_32x32x16_bf16 v[88:103], v[60:63], v[52:55], v[88:103]
    s_add_u32 m0, s50, 51200
    s_nop 0
    buffer_load_dwordx4 v3, s[8:11], s56 offen lds
    s_add_u32 s56, s56, 128
    s_and_b32 s56, s56, 1023
    v_lshlrev_b32 v19, 16, v54
    v_and_b32 v20, 0xffff0000, v54
    v_add_f32 v15, v15, v19
    v_fmac_f32 v16, v19, v19
    v_add_f32 v17, v17, v20
    v_mfma_f32_32x32x16_bf16 v[104:119], v[64:67], v[52:55], v[104:119]
    v_fmac_f32 v18, v20, v20
    v_lshlrev_b32 v21, 16, v55
    v_and_b32 v22, 0xffff0000, v55
    v_add_f32 v15, v15, v21
    v_fmac_f32 v16, v21, v21
    v_add_f32 v17, v17, v22
    v_fmac_f32 v18, v22, v22
    s_cmp_eq_u32 s45, 3
    s_cbranch_scc0 p1_loopB1_a7
    v_mfma_f32_16x16x32_bf16 v[168:171], v[56:59], v[248:251], v[168:171]
    v_mfma_f32_16x16x32_bf16 v[172:175], v[60:63], v[248:251], v[172:175]
    v_mfma_f32_16x16x32_bf16 v[176:179], v[64:67], v[248:251], v[176:179]
p1_loopB1_a7:
    s_waitcnt lgkmcnt(4)
    v_mfma_f32_32x32x16_bf16 v[72:87], v[36:39], v[32:35], v[72:87]
    ds_read_b128 v[52:55], v6 offset:1024
    ds_read_b64_tr_b16 v[56:57], v13 offset:36096
    ds_read_b64_tr_b16 v[58:59], v13 offset:37888
    ds_read_b64_tr_b16 v[60:61], v13 offset:36160
    ds_read_b64_tr_b16 v[62:63], v13 offset:37952
    ds_read_b64_tr_b16 v[64:65], v13 offset:36224
    ds_read_b64_tr_b16 v[66:67], v13 offset:38016
    v_lshlrev_b32 v19, 16, v34
    v_and_b32 v20, 0xffff0000, v34
    v_add_f32 v15, v15, v19
    s_waitcnt lgkmcnt(9)
    v_mfma_f32_32x32x16_bf16 v[88:103], v[40:43], v[32:35], v[88:103]
    s_mul_i32 s66, s57, 3584
    s_add_u32 m0, s51, 66560
    s_mov_b64 exec, s[64:65]
    buffer_load_dwordx4 v4, s[16:19], s66 offen lds
    s_add_u32 s66, s66, 7168
    s_add_u32 m0, s51, 67456
    s_nop 0
    buffer_load_dwordx4 v4, s[16:19], s66 offen lds
    s_mov_b64 exec, -1
    s_add_u32 s57, s57, 32
    s_and_b32 s57, s57, 511
    s_waitcnt lgkmcnt(7)
    v_mfma_f32_32x32x16_bf16 v[104:119], v[44:47], v[32:35], v[104:119]
    v_fmac_f32 v16, v19, v19
    v_add_f32 v17, v17, v20
    v_fmac_f32 v18, v20, v20
    v_lshlrev_b32 v21, 16, v35
    v_and_b32 v22, 0xffff0000, v35
    v_add_f32 v15, v15, v21
    v_fmac_f32 v16, v21, v21
    v_add_f32 v17, v17, v22
    v_fmac_f32 v18, v22, v22
    s_cmp_eq_u32 s45, 0
    s_cbranch_scc0 p1_loopB1_b7
    v_mfma_f32_16x16x32_bf16 v[168:171], v[36:39], v[248:251], v[168:171]
    v_mfma_f32_16x16x32_bf16 v[172:175], v[40:43], v[248:251], v[172:175]
    v_mfma_f32_16x16x32_bf16 v[176:179], v[44:47], v[248:251], v[176:179]
p1_loopB1_b7:
    s_waitcnt lgkmcnt(4)
    v_mfma_f32_32x32x16_bf16 v[72:87], v[56:59], v[52:55], v[72:87]
    ds_read_b128 v[32:35], v7 offset:1024
    ds_read_b64_tr_b16 v[36:37], v13 offset:43264
    ds_read_b64_tr_b16 v[38:39], v13 offset:45056
    ds_read_b64_tr_b16 v[40:41], v13 offset:43328
    ds_read_b64_tr_b16 v[42:43], v13 offset:45120
    ds_read_b64_tr_b16 v[44:45], v13 offset:43392
    ds_read_b64_tr_b16 v[46:47], v13 offset:45184
    v_lshlrev_b32 v19, 16, v54
    v_and_b32 v20, 0xffff0000, v54
    v_add_f32 v15, v15, v19
    s_waitcnt lgkmcnt(9)
    v_mfma_f32_32x32x16_bf16 v[88:103], v[60:63], v[52:55], v[88:103]
    s_mul_i32 s66, s57, 3584
    s_add_u32 m0, s51, 80896
    s_mov_b64 exec, s[64:65]
    buffer_load_dwordx4 v4, s[16:19], s66 offen lds
    s_add_u32 s66, s66, 7168
    s_add_u32 m0, s51, 81792
    s_nop 0
    buffer_load_dwordx4 v4, s[16:19], s66 offen lds
    s_mov_b64 exec, -1
    s_add_u32 s57, s57, 32
    s_and_b32 s57, s57, 511
    s_waitcnt lgkmcnt(7)
    v_mfma_f32_32x32x16_bf16 v[104:119], v[64:67], v[52:55], v[104:119]
    v_fmac_f32 v16, v19, v19
    v_add_f32 v17, v17, v20
    v_fmac_f32 v18, v20, v20
    v_lshlrev_b32 v21, 16, v55
    v_and_b32 v22, 0xffff0000, v55
    v_add_f32 v15, v15, v21
    v_fmac_f32 v16, v21, v21
    v_add_f32 v17, v17, v22
    v_fmac_f32 v18, v22, v22
    s_cmp_eq_u32 s45, 1
    s_cbranch_scc0 p1_loopB1_a8
    v_mfma_f32_16x16x32_bf16 v[168:171], v[56:59], v[248:251], v[168:171]
    v_mfma_f32_16x16x32_bf16 v[172:175], v[60:63], v[248:251], v[172:175]
    v_mfma_f32_16x16x32_bf16 v[176:179], v[64:67], v[248:251], v[176:179]
p1_loopB1_a8:
    s_waitcnt lgkmcnt(4)
    v_mfma_f32_32x32x16_bf16 v[72:87], v[36:39], v[32:35], v[72:87]
    ds_read_b128 v[52:55], v8 offset:1024
    ds_read_b64_tr_b16 v[56:57], v13 offset:50432
    ds_read_b64_tr_b16 v[58:59], v13 offset:52224
    ds_read_b64_tr_b16 v[60:61], v13 offset:50496
    ds_read_b64_tr_b16 v[62:63], v13 offset:52288
    ds_read_b64_tr_b16 v[64:65], v13 offset:50560
    ds_read_b64_tr_b16 v[66:67], v13 offset:52352
    s_add_u32 s66, s73, 98304
    buffer_load_dwordx4 v[184:187], v252, s[28:31], s66 offen
    s_waitcnt lgkmcnt(9)
    v_mfma_f32_32x32x16_bf16 v[88:103], v[40:43], v[32:35], v[88:103]
    s_add_u32 s66, s73, 106496
    buffer_load_dwordx4 v[188:191], v252, s[28:31], s66 offen
    s_add_u32 s66, s73, 114688
    buffer_load_dwordx4 v[192:195], v252, s[28:31], s66 offen
    v_lshlrev_b32 v19, 16, v34
    v_and_b32 v20, 0xffff0000, v34
    v_add_f32 v15, v15, v19
    v_fmac_f32 v16, v19, v19
    v_add_f32 v17, v17, v20
    s_waitcnt lgkmcnt(7)
    v_mfma_f32_32x32x16_bf16 v[104:119], v[44:47], v[32:35], v[104:119]
    v_fmac_f32 v18, v20, v20
    v_lshlrev_b32 v21, 16, v35
    v_and_b32 v22, 0xffff0000, v35
    v_add_f32 v15, v15, v21
    v_fmac_f32 v16, v21, v21
    v_add_f32 v17, v17, v22
    v_fmac_f32 v18, v22, v22
    s_cmp_eq_u32 s45, 2
    s_cbranch_scc0 p1_loopB1_b8
    v_mfma_f32_16x16x32_bf16 v[168:171], v[36:39], v[248:251], v[168:171]
    v_mfma_f32_16x16x32_bf16 v[172:175], v[40:43], v[248:251], v[172:175]
    v_mfma_f32_16x16x32_bf16 v[176:179], v[44:47], v[248:251], v[176:179]
p1_loopB1_b8:
    s_waitcnt vmcnt(9) lgkmcnt(0)
    s_barrier
    v_mfma_f32_32x32x16_bf16 v[72:87], v[56:59], v[52:55], v[72:87]
    ds_read_b128 v[32:35], v5 offset:17408
    ds_read_b64_tr_b16 v[36:37], v14 offset:256
    ds_read_b64_tr_b16 v[38:39], v14 offset:2048
    ds_read_b64_tr_b16 v[40:41], v14 offset:320
    ds_read_b64_tr_b16 v[42:43], v14 offset:2112
    ds_read_b64_tr_b16 v[44:45], v14 offset:384
    ds_read_b64_tr_b16 v[46:47], v14 offset:2176
    v_mfma_f32_32x32x16_bf16 v[88:103], v[60:63], v[52:55], v[88:103]
    v_lshlrev_b32 v19, 16, v54
    v_and_b32 v20, 0xffff0000, v54
    v_add_f32 v15, v15, v19
    v_fmac_f32 v16, v19, v19
    v_add_f32 v17, v17, v20
    v_fmac_f32 v18, v20, v20
    v_lshlrev_b32 v21, 16, v55
    v_mfma_f32_32x32x16_bf16 v[104:119], v[64:67], v[52:55], v[104:119]
    v_and_b32 v22, 0xffff0000, v55
    v_add_f32 v15, v15, v21
    v_fmac_f32 v16, v21, v21
    v_add_f32 v17, v17, v22
    v_fmac_f32 v18, v22, v22
    s_cmp_eq_u32 s45, 3
    s_cbranch_scc0 p1_loopB1_a9
    v_mfma_f32_16x16x32_bf16 v[168:171], v[56:59], v[248:251], v[168:171]
    v_mfma_f32_16x16x32_bf16 v[172:175], v[60:63], v[248:251], v[172:175]
    v_mfma_f32_16x16x32_bf16 v[176:179], v[64:67], v[248:251], v[176:179]
p1_loopB1_a9:
    s_waitcnt lgkmcnt(4)
    v_mfma_f32_32x32x16_bf16 v[72:87], v[36:39], v[32:35], v[72:87]
    ds_read_b128 v[52:55], v6 offset:17408
    ds_read_b64_tr_b16 v[56:57], v14 offset:7424
    ds_read_b64_tr_b16 v[58:59], v14 offset:9216
    ds_read_b64_tr_b16 v[60:61], v14 offset:7488
    ds_read_b64_tr_b16 v[62:63], v14 offset:9280
    ds_read_b64_tr_b16 v[64:65], v14 offset:7552
    ds_read_b64_tr_b16 v[66:67], v14 offset:9344
    v_lshlrev_b32 v19, 16, v34
    v_and_b32 v20, 0xffff0000, v34
    v_add_f32 v15, v15, v19
    v_fmac_f32 v16, v19, v19
    v_add_f32 v17, v17, v20
    s_waitcnt lgkmcnt(9)
    v_mfma_f32_32x32x16_bf16 v[88:103], v[40:43], v[32:35], v[88:103]
    s_mul_i32 s66, s57, 3584
    s_add_u32 m0, s51, 95232
    s_mov_b64 exec, s[64:65]
    buffer_load_dwordx4 v4, s[16:19], s66 offen lds
    s_add_u32 s66, s66, 7168
    s_add_u32 m0, s51, 96128
    s_nop 0
    buffer_load_dwordx4 v4, s[16:19], s66 offen lds
    s_mov_b64 exec, -1
    s_add_u32 s57, s57, 32
    s_and_b32 s57, s57, 511
    s_add_u32 s66, s73, 122880
    buffer_load_dwordx4 v[196:199], v252, s[28:31], s66 offen
    s_waitcnt lgkmcnt(7)
    v_mfma_f32_32x32x16_bf16 v[104:119], v[44:47], v[32:35], v[104:119]
    s_add_u32 s66, s73, 131072
    buffer_load_dwordx4 v[200:203], v252, s[28:31], s66 offen
    s_add_u32 s66, s73, 139264
    buffer_load_dwordx4 v[204:207], v252, s[28:31], s66 offen
    v_fmac_f32 v18, v20, v20
    v_lshlrev_b32 v21, 16, v35
    v_and_b32 v22, 0xffff0000, v35
    v_add_f32 v15, v15, v21
    v_fmac_f32 v16, v21, v21
    v_add_f32 v17, v17, v22
    v_fmac_f32 v18, v22, v22
    s_cmp_eq_u32 s45, 0
    s_cbranch_scc0 p1_loopB1_b9
    v_mfma_f32_16x16x32_bf16 v[168:171], v[36:39], v[248:251], v[168:171]
    v_mfma_f32_16x16x32_bf16 v[172:175], v[40:43], v[248:251], v[172:175]
    v_mfma_f32_16x16x32_bf16 v[176:179], v[44:47], v[248:251], v[176:179]
p1_loopB1_b9:
    s_waitcnt lgkmcnt(4)
    v_mfma_f32_32x32x16_bf16 v[72:87], v[56:59], v[52:55], v[72:87]
    ds_read_b128 v[32:35], v7 offset:17408
    ds_read_b64_tr_b16 v[36:37], v14 offset:14592
    ds_read_b64_tr_b16 v[38:39], v14 offset:16384
    ds_read_b64_tr_b16 v[40:41], v14 offset:14656
    ds_read_b64_tr_b16 v[42:43], v14 offset:16448
    ds_read_b64_tr_b16 v[44:45], v14 offset:14720
    ds_read_b64_tr_b16 v[46:47], v14 offset:16512
    v_lshlrev_b32 v19, 16, v54
    v_and_b32 v20, 0xffff0000, v54
    v_add_f32 v15, v15, v19
    s_waitcnt lgkmcnt(9)
    v_mfma_f32_32x32x16_bf16 v[88:103], v[60:63], v[52:55], v[88:103]
    s_mul_i32 s66, s57, 3584
    s_add_u32 m0, s51, 109568
    s_mov_b64 exec, s[64:65]
    buffer_load_dwordx4 v4, s[16:19], s66 offen lds
    s_add_u32 s66, s66, 7168
    s_add_u32 m0, s51, 110464
    s_nop 0
    buffer_load_dwordx4 v4, s[16:19], s66 offen lds
    s_mov_b64 exec, -1
    s_add_u32 s57, s57, 32
    s_and_b32 s57, s57, 511
    s_waitcnt lgkmcnt(7)
    v_mfma_f32_32x32x16_bf16 v[104:119], v[64:67], v[52:55], v[104:119]
    v_fmac_f32 v16, v19, v19
    v_add_f32 v17, v17, v20
    v_fmac_f32 v18, v20, v20
    v_lshlrev_b32 v21, 16, v55
    v_and_b32 v22, 0xffff0000, v55
    v_add_f32 v15, v15, v21
    v_fmac_f32 v16, v21, v21
    v_add_f32 v17, v17, v22
    v_fmac_f32 v18, v22, v22
    s_cmp_eq_u32 s45, 1
    s_cbranch_scc0 p1_loopB1_a10
    v_mfma_f32_16x16x32_bf16 v[168:171], v[56:59], v[248:251], v[168:171]
    v_mfma_f32_16x16x32_bf16 v[172:175], v[60:63], v[248:251], v[172:175]
    v_mfma_f32_16x16x32_bf16 v[176:179], v[64:67], v[248:251], v[176:179]
p1_loopB1_a10:
    s_waitcnt lgkmcnt(4)
    v_mfma_f32_32x32x16_bf16 v[72:87], v[36:39], v[32:35], v[72:87]
    ds_read_b128 v[52:55], v8 offset:17408
    ds_read_b64_tr_b16 v[56:57], v14 offset:21760
    ds_read_b64_tr_b16 v[58:59], v14 offset:23552
    ds_read_b64_tr_b16 v[60:61], v14 offset:21824
    ds_read_b64_tr_b16 v[62:63], v14 offset:23616
    ds_read_b64_tr_b16 v[64:65], v14 offset:21888
    ds_read_b64_tr_b16 v[66:67], v14 offset:23680
    s_add_u32 s66, s73, 147456
    buffer_load_dwordx4 v[208:211], v252, s[28:31], s66 offen
    s_waitcnt lgkmcnt(9)
    v_mfma_f32_32x32x16_bf16 v[88:103], v[40:43], v[32:35], v[88:103]
    s_add_u32 s66, s73, 155648
    buffer_load_dwordx4 v[212:215], v252, s[28:31], s66 offen
    s_add_u32 s66, s73, 163840
    buffer_load_dwordx4 v[216:219], v252, s[28:31], s66 offen
    v_lshlrev_b32 v19, 16, v34
    v_and_b32 v20, 0xffff0000, v34
    v_add_f32 v15, v15, v19
    v_fmac_f32 v16, v19, v19
    v_add_f32 v17, v17, v20
    s_waitcnt lgkmcnt(7)
    v_mfma_f32_32x32x16_bf16 v[104:119], v[44:47], v[32:35], v[104:119]
    v_fmac_f32 v18, v20, v20
    v_lshlrev_b32 v21, 16, v35
    v_and_b32 v22, 0xffff0000, v35
    v_add_f32 v15, v15, v21
    v_fmac_f32 v16, v21, v21
    v_add_f32 v17, v17, v22
    v_fmac_f32 v18, v22, v22
    s_cmp_eq_u32 s45, 2
    s_cbranch_scc0 p1_loopB1_b10
    v_mfma_f32_16x16x32_bf16 v[168:171], v[36:39], v[248:251], v[168:171]
    v_mfma_f32_16x16x32_bf16 v[172:175], v[40:43], v[248:251], v[172:175]
    v_mfma_f32_16x16x32_bf16 v[176:179], v[44:47], v[248:251], v[176:179]
p1_loopB1_b10:
    s_waitcnt vmcnt(13) lgkmcnt(0)
    s_barrier
    v_mfma_f32_32x32x16_bf16 v[72:87], v[56:59], v[52:55], v[72:87]
    ds_read_b128 v[32:35], v5 offset:33792
    ds_read_b64_tr_b16 v[36:37], v13 offset:256
    ds_read_b64_tr_b16 v[38:39], v13 offset:2048
    ds_read_b64_tr_b16 v[40:41], v13 offset:320
    ds_read_b64_tr_b16 v[42:43], v13 offset:2112
    ds_read_b64_tr_b16 v[44:45], v13 offset:384
    ds_read_b64_tr_b16 v[46:47], v13 offset:2176
    v_mfma_f32_32x32x16_bf16 v[88:103], v[60:63], v[52:55], v[88:103]
    v_lshlrev_b32 v19, 16, v54
    v_and_b32 v20, 0xffff0000, v54
    v_add_f32 v15, v15, v19
    v_fmac_f32 v16, v19, v19
    v_add_f32 v17, v17, v20
    v_fmac_f32 v18, v20, v20
    v_lshlrev_b32 v21, 16, v55
    v_mfma_f32_32x32x16_bf16 v[104:119], v[64:67], v[52:55], v[104:119]
    v_and_b32 v22, 0xffff0000, v55
    v_add_f32 v15, v15, v21
    v_fmac_f32 v16, v21, v21
    v_add_f32 v17, v17, v22
    v_fmac_f32 v18, v22, v22
    s_cmp_eq_u32 s45, 3
    s_cbranch_scc0 p1_loopB1_a11
    v_mfma_f32_16x16x32_bf16 v[168:171], v[56:59], v[248:251], v[168:171]
    v_mfma_f32_16x16x32_bf16 v[172:175], v[60:63], v[248:251], v[172:175]
    v_mfma_f32_16x16x32_bf16 v[176:179], v[64:67], v[248:251], v[176:179]
p1_loopB1_a11:
    s_waitcnt lgkmcnt(4)
    v_mfma_f32_32x32x16_bf16 v[72:87], v[36:39], v[32:35], v[72:87]
    ds_read_b128 v[52:55], v6 offset:33792
    ds_read_b64_tr_b16 v[56:57], v13 offset:7424
    ds_read_b64_tr_b16 v[58:59], v13 offset:9216
    ds_read_b64_tr_b16 v[60:61], v13 offset:7488
    ds_read_b64_tr_b16 v[62:63], v13 offset:9280
    ds_read_b64_tr_b16 v[64:65], v13 offset:7552
    ds_read_b64_tr_b16 v[66:67], v13 offset:9344
    s_add_u32 s66, s73, 172032
    buffer_load_dwordx4 v[220:223], v252, s[28:31], s66 offen
    s_waitcnt lgkmcnt(9)
    v_mfma_f32_32x32x16_bf16 v[88:103], v[40:43], v[32:35], v[88:103]
    s_add_u32 s66, s73, 180224
    buffer_load_dwordx4 v[224:227], v252, s[28:31], s66 offen
    s_add_u32 s66, s73, 188416
    buffer_load_dwordx4 v[228:231], v252, s[28:31], s66 offen
    v_lshlrev_b32 v19, 16, v34
    v_and_b32 v20, 0xffff0000, v34
    v_add_f32 v15, v15, v19
    v_fmac_f32 v16, v19, v19
    v_add_f32 v17, v17, v20
    s_waitcnt lgkmcnt(7)
    v_mfma_f32_32x32x16_bf16 v[104:119], v[44:47], v[32:35], v[104:119]
    v_fmac_f32 v18, v20, v20
    v_lshlrev_b32 v21, 16, v35
    v_and_b32 v22, 0xffff0000, v35
    v_add_f32 v15, v15, v21
    v_fmac_f32 v16, v21, v21
    v_add_f32 v17, v17, v22
    v_fmac_f32 v18, v22, v22
    s_cmp_eq_u32 s45, 0
    s_cbranch_scc0 p1_loopB1_b11
    v_mfma_f32_16x16x32_bf16 v[168:171], v[36:39], v[248:251], v[168:171]
    v_mfma_f32_16x16x32_bf16 v[172:175], v[40:43], v[248:251], v[172:175]
    v_mfma_f32_16x16x32_bf16 v[176:179], v[44:47], v[248:251], v[176:179]
p1_loopB1_b11:
    s_waitcnt lgkmcnt(4)
    v_mfma_f32_32x32x16_bf16 v[72:87], v[56:59], v[52:55], v[72:87]
    ds_read_b128 v[32:35], v7 offset:33792
    ds_read_b64_tr_b16 v[36:37], v13 offset:14592
    ds_read_b64_tr_b16 v[38:39], v13 offset:16384
    ds_read_b64_tr_b16 v[40:41], v13 offset:14656
    ds_read_b64_tr_b16 v[42:43], v13 offset:16448
    ds_read_b64_tr_b16 v[44:45], v13 offset:14720
    ds_read_b64_tr_b16 v[46:47], v13 offset:16512
    s_waitcnt lgkmcnt(9)
    v_mfma_f32_32x32x16_bf16 v[88:103], v[60:63], v[52:55], v[88:103]
    v_lshlrev_b32 v19, 16, v54
    v_and_b32 v20, 0xffff0000, v54
    v_add_f32 v15, v15, v19
    v_fmac_f32 v16, v19, v19
    v_add_f32 v17, v17, v20
    v_fmac_f32 v18, v20, v20
    v_lshlrev_b32 v21, 16, v55
    s_waitcnt lgkmcnt(7)
    v_mfma_f32_32x32x16_bf16 v[104:119], v[64:67], v[52:55], v[104:119]
    v_and_b32 v22, 0xffff0000, v55
    v_add_f32 v15, v15, v21
    v_fmac_f32 v16, v21, v21
    v_add_f32 v17, v17, v22
    v_fmac_f32 v18, v22, v22
    s_cmp_eq_u32 s45, 1
    s_cbranch_scc0 p1_loopB1_a12
    v_mfma_f32_16x16x32_bf16 v[168:171], v[56:59], v[248:251], v[168:171]
    v_mfma_f32_16x16x32_bf16 v[172:175], v[60:63], v[248:251], v[172:175]
    v_mfma_f32_16x16x32_bf16 v[176:179], v[64:67], v[248:251], v[176:179]
p1_loopB1_a12:
    s_waitcnt lgkmcnt(4)
    v_mfma_f32_32x32x16_bf16 v[72:87], v[36:39], v[32:35], v[72:87]
    ds_read_b128 v[52:55], v8 offset:33792
    ds_read_b64_tr_b16 v[56:57], v13 offset:21760
    ds_read_b64_tr_b16 v[58:59], v13 offset:23552
    ds_read_b64_tr_b16 v[60:61], v13 offset:21824
    ds_read_b64_tr_b16 v[62:63], v13 offset:23616
    ds_read_b64_tr_b16 v[64:65], v13 offset:21888
    ds_read_b64_tr_b16 v[66:67], v13 offset:23680
    s_add_u32 s66, s73, 196608
    buffer_load_dwordx4 v[232:235], v252, s[28:31], s66 offen
    s_waitcnt lgkmcnt(9)
    v_mfma_f32_32x32x16_bf16 v[88:103], v[40:43], v[32:35], v[88:103]
    s_add_u32 s66, s73, 204800
    buffer_load_dwordx4 v[236:239], v252, s[28:31], s66 offen
    s_add_u32 s66, s73, 212992
    buffer_load_dwordx4 v[240:243], v252, s[28:31], s66 offen
    v_lshlrev_b32 v19, 16, v34
    v_and_b32 v20, 0xffff0000, v34
    v_add_f32 v15, v15, v19
    v_fmac_f32 v16, v19, v19
    v_add_f32 v17, v17, v20
    s_waitcnt lgkmcnt(7)
    v_mfma_f32_32x32x16_bf16 v[104:119], v[44:47], v[32:35], v[104:119]
    v_fmac_f32 v18, v20, v20
    v_lshlrev_b32 v21, 16, v35
    v_and_b32 v22, 0xffff0000, v35
    v_add_f32 v15, v15, v21
    v_fmac_f32 v16, v21, v21
    v_add_f32 v17, v17, v22
    v_fmac_f32 v18, v22, v22
    s_cmp_eq_u32 s45, 2
    s_cbranch_scc0 p1_loopB1_b12
    v_mfma_f32_16x16x32_bf16 v[168:171], v[36:39], v[248:251], v[168:171]
    v_mfma_f32_16x16x32_bf16 v[172:175], v[40:43], v[248:251], v[172:175]
    v_mfma_f32_16x16x32_bf16 v[176:179], v[44:47], v[248:251], v[176:179]
p1_loopB1_b12:
    s_waitcnt vmcnt(9) lgkmcnt(0)
    s_barrier
    v_mfma_f32_32x32x16_bf16 v[72:87], v[56:59], v[52:55], v[72:87]
    ds_read_b128 v[32:35], v5 offset:50176
    ds_read_b64_tr_b16 v[36:37], v13 offset:28928
    ds_read_b64_tr_b16 v[38:39], v13 offset:30720
    ds_read_b64_tr_b16 v[40:41], v13 offset:28992
    ds_read_b64_tr_b16 v[42:43], v13 offset:30784
    ds_read_b64_tr_b16 v[44:45], v13 offset:29056
    ds_read_b64_tr_b16 v[46:47], v13 offset:30848
    v_mfma_f32_32x32x16_bf16 v[88:103], v[60:63], v[52:55], v[88:103]
    v_lshlrev_b32 v19, 16, v54
    v_and_b32 v20, 0xffff0000, v54
    v_add_f32 v15, v15, v19
    v_fmac_f32 v16, v19, v19
    v_add_f32 v17, v17, v20
    v_fmac_f32 v18, v20, v20
    v_lshlrev_b32 v21, 16, v55
    v_mfma_f32_32x32x16_bf16 v[104:119], v[64:67], v[52:55], v[104:119]
    v_and_b32 v22, 0xffff0000, v55
    v_add_f32 v15, v15, v21
    v_fmac_f32 v16, v21, v21
    v_add_f32 v17, v17, v22
    v_fmac_f32 v18, v22, v22
    s_cmp_eq_u32 s45, 3
    s_cbranch_scc0 p1_loopB1_a13
    v_mfma_f32_16x16x32_bf16 v[168:171], v[56:59], v[248:251], v[168:171]
    v_mfma_f32_16x16x32_bf16 v[172:175], v[60:63], v[248:251], v[172:175]
    v_mfma_f32_16x16x32_bf16 v[176:179], v[64:67], v[248:251], v[176:179]
p1_loopB1_a13:
    s_waitcnt lgkmcnt(4)
    v_mfma_f32_32x32x16_bf16 v[72:87], v[36:39], v[32:35], v[72:87]
    ds_read_b128 v[52:55], v6 offset:50176
    ds_read_b64_tr_b16 v[56:57], v13 offset:36096
    ds_read_b64_tr_b16 v[58:59], v13 offset:37888
    ds_read_b64_tr_b16 v[60:61], v13 offset:36160
    ds_read_b64_tr_b16 v[62:63], v13 offset:37952
    ds_read_b64_tr_b16 v[64:65], v13 offset:36224
    ds_read_b64_tr_b16 v[66:67], v13 offset:38016
    s_add_u32 s66, s73, 221184
    buffer_load_dwordx4 v[244:247], v252, s[28:31], s66 offen
    s_waitcnt lgkmcnt(9)
    v_mfma_f32_32x32x16_bf16 v[88:103], v[40:43], v[32:35], v[88:103]
    s_add_u32 s66, s98, 0
    buffer_load_dwordx2 v[10:11], v252, s[28:31], s66 offen
    s_add_u32 s66, s98, 32768
    buffer_load_dwordx2 v[10:11], v252, s[28:31], s66 offen
    v_lshlrev_b32 v19, 16, v34
    v_and_b32 v20, 0xffff0000, v34
    v_add_f32 v15, v15, v19
    v_fmac_f32 v16, v19, v19
    v_add_f32 v17, v17, v20
    s_waitcnt lgkmcnt(7)
    v_mfma_f32_32x32x16_bf16 v[104:119], v[44:47], v[32:35], v[104:119]
    v_fmac_f32 v18, v20, v20
    v_lshlrev_b32 v21, 16, v35
    v_and_b32 v22, 0xffff0000, v35
    v_add_f32 v15, v15, v21
    v_fmac_f32 v16, v21, v21
    v_add_f32 v17, v17, v22
    v_fmac_f32 v18, v22, v22
    s_cmp_eq_u32 s45, 0
    s_cbranch_scc0 p1_loopB1_b13
    v_mfma_f32_16x16x32_bf16 v[168:171], v[36:39], v[248:251], v[168:171]
    v_mfma_f32_16x16x32_bf16 v[172:175], v[40:43], v[248:251], v[172:175]
    v_mfma_f32_16x16x32_bf16 v[176:179], v[44:47], v[248:251], v[176:179]
p1_loopB1_b13:
    s_waitcnt lgkmcnt(4)
    v_mfma_f32_32x32x16_bf16 v[72:87], v[56:59], v[52:55], v[72:87]
    ds_read_b128 v[32:35], v7 offset:50176
    ds_read_b64_tr_b16 v[36:37], v13 offset:43264
    ds_read_b64_tr_b16 v[38:39], v13 offset:45056
    ds_read_b64_tr_b16 v[40:41], v13 offset:43328
    ds_read_b64_tr_b16 v[42:43], v13 offset:45120
    ds_read_b64_tr_b16 v[44:45], v13 offset:43392
    ds_read_b64_tr_b16 v[46:47], v13 offset:45184
    s_waitcnt lgkmcnt(9)
    v_mfma_f32_32x32x16_bf16 v[88:103], v[60:63], v[52:55], v[88:103]
    v_lshlrev_b32 v19, 16, v54
    v_and_b32 v20, 0xffff0000, v54
    v_add_f32 v15, v15, v19
    v_fmac_f32 v16, v19, v19
    v_add_f32 v17, v17, v20
    v_fmac_f32 v18, v20, v20
    v_lshlrev_b32 v21, 16, v55
    s_waitcnt lgkmcnt(7)
    v_mfma_f32_32x32x16_bf16 v[104:119], v[64:67], v[52:55], v[104:119]
    v_and_b32 v22, 0xffff0000, v55
    v_add_f32 v15, v15, v21
    v_fmac_f32 v16, v21, v21
    v_add_f32 v17, v17, v22
    v_fmac_f32 v18, v22, v22
    s_cmp_eq_u32 s45, 1
    s_cbranch_scc0 p1_loopB1_a14
    v_mfma_f32_16x16x32_bf16 v[168:171], v[56:59], v[248:251], v[168:171]
    v_mfma_f32_16x16x32_bf16 v[172:175], v[60:63], v[248:251], v[172:175]
    v_mfma_f32_16x16x32_bf16 v[176:179], v[64:67], v[248:251], v[176:179]
p1_loopB1_a14:
    s_waitcnt lgkmcnt(4)
    v_mfma_f32_32x32x16_bf16 v[72:87], v[36:39], v[32:35], v[72:87]
    ds_read_b128 v[52:55], v8 offset:50176
    ds_read_b64_tr_b16 v[56:57], v13 offset:50432
    ds_read_b64_tr_b16 v[58:59], v13 offset:52224
    ds_read_b64_tr_b16 v[60:61], v13 offset:50496
    ds_read_b64_tr_b16 v[62:63], v13 offset:52288
    ds_read_b64_tr_b16 v[64:65], v13 offset:50560
    ds_read_b64_tr_b16 v[66:67], v13 offset:52352
    s_add_u32 s66, s98, 65536
    buffer_load_dwordx2 v[10:11], v252, s[28:31], s66 offen
    s_waitcnt lgkmcnt(9)
    v_mfma_f32_32x32x16_bf16 v[88:103], v[40:43], v[32:35], v[88:103]
    s_add_u32 s66, s99, 0
    buffer_load_dwordx2 v[10:11], v252, s[32:35], s66 offen
    s_add_u32 s66, s99, 32768
    buffer_load_dwordx2 v[10:11], v252, s[32:35], s66 offen
    v_lshlrev_b32 v19, 16, v34
    v_and_b32 v20, 0xffff0000, v34
    v_add_f32 v15, v15, v19
    v_fmac_f32 v16, v19, v19
    v_add_f32 v17, v17, v20
    s_waitcnt lgkmcnt(7)
    v_mfma_f32_32x32x16_bf16 v[104:119], v[44:47], v[32:35], v[104:119]
    v_fmac_f32 v18, v20, v20
    v_lshlrev_b32 v21, 16, v35
    v_and_b32 v22, 0xffff0000, v35
    v_add_f32 v15, v15, v21
    v_fmac_f32 v16, v21, v21
    v_add_f32 v17, v17, v22
    v_fmac_f32 v18, v22, v22
    s_cmp_eq_u32 s45, 2
    s_cbranch_scc0 p1_loopB1_b14
    v_mfma_f32_16x16x32_bf16 v[168:171], v[36:39], v[248:251], v[168:171]
    v_mfma_f32_16x16x32_bf16 v[172:175], v[40:43], v[248:251], v[172:175]
    v_mfma_f32_16x16x32_bf16 v[176:179], v[44:47], v[248:251], v[176:179]
p1_loopB1_b14:
    s_waitcnt lgkmcnt(4)
    v_mfma_f32_32x32x16_bf16 v[72:87], v[56:59], v[52:55], v[72:87]
    v_lshlrev_b32 v19, 16, v54
    v_and_b32 v20, 0xffff0000, v54
    v_add_f32 v15, v15, v19
    v_fmac_f32 v16, v19, v19
    s_waitcnt lgkmcnt(2)
    v_mfma_f32_32x32x16_bf16 v[88:103], v[60:63], v[52:55], v[88:103]
    v_add_f32 v17, v17, v20
    v_fmac_f32 v18, v20, v20
    v_lshlrev_b32 v21, 16, v55
    v_and_b32 v22, 0xffff0000, v55
    s_waitcnt lgkmcnt(0)
    v_mfma_f32_32x32x16_bf16 v[104:119], v[64:67], v[52:55], v[104:119]
    v_add_f32 v15, v15, v21
    v_fmac_f32 v16, v21, v21
    v_add_f32 v17, v17, v22
    v_fmac_f32 v18, v22, v22
    s_cmp_eq_u32 s45, 3
    s_cbranch_scc0 p1_loopB1_a15
    v_mfma_f32_16x16x32_bf16 v[168:171], v[56:59], v[248:251], v[168:171]
    v_mfma_f32_16x16x32_bf16 v[172:175], v[60:63], v[248:251], v[172:175]
    v_mfma_f32_16x16x32_bf16 v[176:179], v[64:67], v[248:251], v[176:179]
p1_loopB1_a15:
    s_waitcnt lgkmcnt(0)
    s_or_b32 s52, s44, s67
    s_cbranch_scc1 p1_np2
    v_readfirstlane_b32 s52, v160
    v_readfirstlane_b32 s53, v161
    s_or_b32 s5, s101, 0x80000000
    s_sub_u32 s4, s52, s100
    s_subb_u32 s5, s53, s5
    s_lshr_b32 s4, s4, 20
    s_or_b32 s4, s4, s5
    s_cbranch_scc0 p1_np2_h
    s_add_u32 s100, s100, 600
    s_addc_u32 s101, s101, 0
    s_bitset1_b32 s101, 31
    v_mov_b32 v160, s100
    v_mov_b32 v161, s101
    v_mov_b32 v162, 0
    v_mov_b32 v163, 0
    s_mov_b64 exec, 1
    buffer_atomic_cmpswap_x2 v[160:163], off, s[40:43], 0 offset:32 sc0 sc1
    s_mov_b64 exec, -1
    s_waitcnt vmcnt(0)
    v_readfirstlane_b32 s52, v160
    v_readfirstlane_b32 s53, v161
    s_nop 0
    s_cmp_eq_u32 s53, 0
    s_cselect_b32 s52, s100, s52
    s_cselect_b32 s53, s101, s53
p1_np2_h:
    v_mov_b32 v160, s52
    v_mov_b32 v161, s53
    v_mov_b32 v148, 161792
    ds_write_b64 v148, v[160:161] offset:16
p1_np2:
    v_add_f32 v15, v15, v17
    v_add_f32 v16, v16, v18
    v_mov_b32 v148, v15
    v_mov_b32 v149, v16
    s_nop 0
    v_permlane32_swap_b32 v15, v148
    v_permlane32_swap_b32 v16, v149
    v_add_f32 v150, v15, v148
    v_add_f32 v151, v16, v149
    s_lshl_b32 s52, s45, 8
    s_add_u32 s52, s52, 141312
    s_lshl_b32 s53, s46, 10
    s_add_u32 s53, s53, s52
    v_and_b32 v152, 31, v1
    v_lshlrev_b32 v153, 3, v152
    v_add_u32 v154, s53, v153
    v_add_u32 v153, s52, v153
    ds_write_b64 v154, v[150:151]
    v_and_b32 v154, 1, v1
    v_lshlrev_b32 v154, 6, v154
    v_lshrrev_b32 v155, 4, v1
    v_lshl_add_u32 v154, v155, 4, v154
    s_lshr_b32 s52, s45, 1
    s_mul_i32 s52, s52, 20480
    s_and_b32 s53, s45, 1
    s_lshl_b32 s53, s53, 10
    s_add_u32 s52, s52, s53
    s_add_u32 s53, s55, 18432
    s_add_u32 s52, s52, s53
    v_add_u32 v154, s52, v154
    v_lshlrev_b32 v152, 2, v152
    v_add_u32 v152, s53, v152
    s_mov_b32 exec_lo, 0x00030003
    s_mov_b32 exec_hi, 0x00030003
    ds_write_b128 v154, v[168:171] offset:0
    ds_write_b128 v154, v[172:175] offset:128
    ds_write_b128 v154, v[176:179] offset:256
    s_mov_b64 exec, -1
    v_mov_b32 v155, 161792
    s_waitcnt lgkmcnt(0)
    s_barrier
    ds_read_b64 v[160:161], v155 offset:16
    ds_read_b64 v[148:149], v153
    ds_read_b64 v[150:151], v153 offset:1024
    ds_read_b32 v168, v152 offset:0
    ds_read_b32 v169, v152 offset:1024
    ds_read_b32 v170, v152 offset:20480
    ds_read_b32 v171, v152 offset:21504
    ds_read_b32 v172, v152 offset:128
    ds_read_b32 v173, v152 offset:1152
    ds_read_b32 v174, v152 offset:20608
    ds_read_b32 v175, v152 offset:21632
    ds_read_b32 v176, v152 offset:256
    ds_read_b32 v177, v152 offset:1280
    ds_read_b32 v178, v152 offset:20736
    ds_read_b32 v179, v152 offset:21760
    s_cmp_eq_u32 s67, 0
    s_cbranch_scc0 p1_nopf1
    s_add_u32 m0, s72, 0
    s_add_u32 s52, s73, 0
    buffer_load_dwordx4 v252, s[28:31], s52 offen lds
    s_add_u32 m0, s72, 1024
    s_add_u32 s52, s73, 8192
    buffer_load_dwordx4 v252, s[28:31], s52 offen lds
    s_add_u32 m0, s72, 2048
    s_add_u32 s52, s73, 16384
    buffer_load_dwordx4 v252, s[28:31], s52 offen lds
    s_add_u32 m0, s72, 3072
    s_add_u32 s52, s73, 24576
    buffer_load_dwordx4 v252, s[28:31], s52 offen lds
    s_add_u32 m0, s72, 4096
    s_add_u32 s52, s73, 32768
    buffer_load_dwordx4 v252, s[28:31], s52 offen lds
    s_add_u32 m0, s72, 5120
    s_add_u32 s52, s73, 40960
    buffer_load_dwordx4 v252, s[28:31], s52 offen lds
    s_add_u32 m0, s72, 6144
    s_add_u32 s52, s73, 49152
    buffer_load_dwordx4 v252, s[28:31], s52 offen lds
    s_add_u32 m0, s72, 7168
    s_add_u32 s52, s73, 57344
    buffer_load_dwordx4 v252, s[28:31], s52 offen lds
p1_nopf1:
    s_waitcnt lgkmcnt(12)
    v_readfirstlane_b32 s100, v160
    v_readfirstlane_b32 s101, v161
    v_add_f32 v15, v148, v150
    v_add_f32 v16, v149, v151
    v_mul_f32 v15, 0xbb000000, v15
    v_mul_f32 v16, 0x3b000000, v16
    v_fma_f32 v16, -v15, v15, v16
    v_add_f32 v16, 0x3727c5ac, v16
    v_rsq_f32 v136, v16
    v_sqrt_f32 v166, v16
    v_cvt_pk_bf16_f32 v148, v15, v15
    v_and_b32 v148, 0xffff0000, v148
    v_sub_f32 v148, v15, v148
    v_cvt_pk_bf16_f32 v140, v15, v148
    v_mov_b32 v141, 0
    v_mov_b32 v142, 0
    v_mov_b32 v143, 0
    v_mul_f32 v138, 0xbfb8aa3b, v136
    v_mov_b32 v145, 0
    v_mov_b32 v146, 0
    v_mov_b32 v147, 0
    v_mov_b32 v153, 0
    v_mov_b32 v154, 0
    v_mov_b32 v155, 0
    s_mov_b32 s62, 0
    s_mov_b32 s63, -1
    s_waitcnt lgkmcnt(8)
    v_add_f32 v168, v168, v169
    v_add_f32 v170, v170, v171
    v_add_f32 v168, v168, v170
    v_cvt_pk_bf16_f32 v169, v168, v168
    v_and_b32 v170, 0xffff0000, v169
    v_sub_f32 v170, v168, v170
    v_cvt_pk_bf16_f32 v170, v170, v170
    v_cndmask_b32 v144, v169, v170, s[62:63]
    s_nop 1
    v_mfma_f32_32x32x16_bf16 v[72:87], v[144:147], v[140:143], v[72:87]
    s_waitcnt lgkmcnt(4)
    v_add_f32 v172, v172, v173
    v_add_f32 v174, v174, v175
    v_add_f32 v172, v172, v174
    v_cvt_pk_bf16_f32 v173, v172, v172
    v_and_b32 v174, 0xffff0000, v173
    v_sub_f32 v174, v172, v174
    v_cvt_pk_bf16_f32 v174, v174, v174
    v_cndmask_b32 v152, v173, v174, s[62:63]
    s_nop 1
    v_mfma_f32_32x32x16_bf16 v[88:103], v[152:155], v[140:143], v[88:103]
    s_waitcnt lgkmcnt(0)
    v_add_f32 v176, v176, v177
    v_add_f32 v178, v178, v179
    v_add_f32 v176, v176, v178
    v_cvt_pk_bf16_f32 v177, v176, v176
    v_and_b32 v178, 0xffff0000, v177
    v_sub_f32 v178, v176, v178
    v_cvt_pk_bf16_f32 v178, v178, v178
    v_cndmask_b32 v144, v177, v178, s[62:63]
    s_nop 1
    v_mfma_f32_32x32x16_bf16 v[104:119], v[144:147], v[140:143], v[104:119]
    s_lshl_b32 s52, s47, 2
    s_add_u32 s52, s52, s45
    s_mul_i32 s52, s52, 112
    s_mul_i32 s53, s48, 14
    s_add_u32 s52, s52, s53
    s_lshl_b32 s53, s46, 3
    s_add_u32 s52, s52, s53
    s_lshl_b32 s52, s52, 10
    v_lshlrev_b32 v148, 4, v1
    v_pk_mul_f32 v[32:33], v[72:73], v[138:139] op_sel_hi:[1,0]
    v_pk_mul_f32 v[34:35], v[74:75], v[138:139] op_sel_hi:[1,0]
    v_pk_mul_f32 v[36:37], v[76:77], v[138:139] op_sel_hi:[1,0]
    v_pk_mul_f32 v[38:39], v[78:79], v[138:139] op_sel_hi:[1,0]
    v_pk_mul_f32 v[40:41], v[80:81], v[138:139] op_sel_hi:[1,0]
    v_pk_mul_f32 v[42:43], v[82:83], v[138:139] op_sel_hi:[1,0]
    s_add_u32 m0, s72, 8192
    s_add_u32 s66, s73, 65536
    buffer_load_dwordx4 v252, s[28:31], s66 offen lds
    v_pk_mul_f32 v[44:45], v[84:85], v[138:139] op_sel_hi:[1,0]
    v_pk_mul_f32 v[46:47], v[86:87], v[138:139] op_sel_hi:[1,0]
    v_exp_f32 v32, v32
    s_add_u32 m0, s72, 9216
    s_add_u32 s66, s73, 73728
    buffer_load_dwordx4 v252, s[28:31], s66 offen lds
    v_exp_f32 v33, v33
    v_exp_f32 v34, v34
    s_add_u32 m0, s72, 10240
    s_add_u32 s66, s73, 81920
    buffer_load_dwordx4 v252, s[28:31], s66 offen lds
    v_exp_f32 v35, v35
    v_exp_f32 v36, v36
    s_add_u32 m0, s72, 11264
    s_add_u32 s66, s73, 90112
    buffer_load_dwordx4 v252, s[28:31], s66 offen lds
    v_exp_f32 v37, v37
    v_exp_f32 v38, v38
    v_exp_f32 v39, v39
    v_exp_f32 v40, v40
    v_exp_f32 v41, v41
    v_exp_f32 v42, v42
    v_exp_f32 v43, v43
    v_exp_f32 v44, v44
    v_exp_f32 v45, v45
    v_exp_f32 v46, v46
    v_exp_f32 v47, v47
    v_pk_fma_f32 v[32:33], v[32:33], v[166:167], v[166:167] op_sel_hi:[1,0,0]
    v_pk_fma_f32 v[34:35], v[34:35], v[166:167], v[166:167] op_sel_hi:[1,0,0]
    v_pk_fma_f32 v[36:37], v[36:37], v[166:167], v[166:167] op_sel_hi:[1,0,0]
    v_pk_fma_f32 v[38:39], v[38:39], v[166:167], v[166:167] op_sel_hi:[1,0,0]
    v_pk_fma_f32 v[40:41], v[40:41], v[166:167], v[166:167] op_sel_hi:[1,0,0]
    v_pk_fma_f32 v[42:43], v[42:43], v[166:167], v[166:167] op_sel_hi:[1,0,0]
    v_pk_fma_f32 v[44:45], v[44:45], v[166:167], v[166:167] op_sel_hi:[1,0,0]
    v_pk_fma_f32 v[46:47], v[46:47], v[166:167], v[166:167] op_sel_hi:[1,0,0]
    v_rcp_f32 v32, v32
    v_rcp_f32 v33, v33
    v_rcp_f32 v34, v34
    v_rcp_f32 v35, v35
    v_rcp_f32 v36, v36
    v_rcp_f32 v37, v37
    v_rcp_f32 v38, v38
    v_rcp_f32 v39, v39
    v_rcp_f32 v40, v40
    v_rcp_f32 v41, v41
    v_rcp_f32 v42, v42
    v_rcp_f32 v43, v43
    v_rcp_f32 v44, v44
    v_rcp_f32 v45, v45
    v_rcp_f32 v46, v46
    v_rcp_f32 v47, v47
    v_pk_mul_f32 v[72:73], v[72:73], v[32:33]
    v_pk_mul_f32 v[74:75], v[74:75], v[34:35]
    v_pk_mul_f32 v[76:77], v[76:77], v[36:37]
    v_pk_mul_f32 v[78:79], v[78:79], v[38:39]
    v_pk_mul_f32 v[80:81], v[80:81], v[40:41]
    v_pk_mul_f32 v[82:83], v[82:83], v[42:43]
    v_pk_mul_f32 v[84:85], v[84:85], v[44:45]
    v_pk_mul_f32 v[86:87], v[86:87], v[46:47]
    v_cvt_pk_bf16_f32 v24, v72, v73
    v_cvt_pk_bf16_f32 v25, v74, v75
    v_cvt_pk_bf16_f32 v26, v76, v77
    v_cvt_pk_bf16_f32 v27, v78, v79
    v_cvt_pk_bf16_f32 v28, v80, v81
    v_cvt_pk_bf16_f32 v29, v82, v83
    v_cvt_pk_bf16_f32 v30, v84, v85
    v_cvt_pk_bf16_f32 v31, v86, v87
    buffer_store_dwordx4 v[24:27], v148, s[20:23], s52 offen sc1
    buffer_store_dwordx4 v[28:31], v148, s[20:23], s52 offen offset:1024 sc1
    s_add_u32 s52, s52, 2048
    v_pk_mul_f32 v[48:49], v[88:89], v[138:139] op_sel_hi:[1,0]
    v_pk_mul_f32 v[50:51], v[90:91], v[138:139] op_sel_hi:[1,0]
    v_pk_mul_f32 v[52:53], v[92:93], v[138:139] op_sel_hi:[1,0]
    v_pk_mul_f32 v[54:55], v[94:95], v[138:139] op_sel_hi:[1,0]
    v_pk_mul_f32 v[56:57], v[96:97], v[138:139] op_sel_hi:[1,0]
    v_pk_mul_f32 v[58:59], v[98:99], v[138:139] op_sel_hi:[1,0]
    v_pk_mul_f32 v[60:61], v[100:101], v[138:139] op_sel_hi:[1,0]
    v_pk_mul_f32 v[62:63], v[102:103], v[138:139] op_sel_hi:[1,0]
    v_exp_f32 v48, v48
    v_exp_f32 v49, v49
    v_exp_f32 v50, v50
    v_exp_f32 v51, v51
    v_exp_f32 v52, v52
    v_exp_f32 v53, v53
    v_exp_f32 v54, v54
    v_exp_f32 v55, v55
    v_exp_f32 v56, v56
    v_exp_f32 v57, v57
    v_exp_f32 v58, v58
    v_exp_f32 v59, v59
    v_exp_f32 v60, v60
    v_exp_f32 v61, v61
    v_exp_f32 v62, v62
    v_exp_f32 v63, v63
    v_pk_fma_f32 v[48:49], v[48:49], v[166:167], v[166:167] op_sel_hi:[1,0,0]
    v_pk_fma_f32 v[50:51], v[50:51], v[166:167], v[166:167] op_sel_hi:[1,0,0]
    v_pk_fma_f32 v[52:53], v[52:53], v[166:167], v[166:167] op_sel_hi:[1,0,0]
    v_pk_fma_f32 v[54:55], v[54:55], v[166:167], v[166:167] op_sel_hi:[1,0,0]
    v_pk_fma_f32 v[56:57], v[56:57], v[166:167], v[166:167] op_sel_hi:[1,0,0]
    v_pk_fma_f32 v[58:59], v[58:59], v[166:167], v[166:167] op_sel_hi:[1,0,0]
    v_pk_fma_f32 v[60:61], v[60:61], v[166:167], v[166:167] op_sel_hi:[1,0,0]
    v_pk_fma_f32 v[62:63], v[62:63], v[166:167], v[166:167] op_sel_hi:[1,0,0]
    v_rcp_f32 v48, v48
    v_rcp_f32 v49, v49
    v_rcp_f32 v50, v50
    v_rcp_f32 v51, v51
    v_rcp_f32 v52, v52
    v_rcp_f32 v53, v53
    v_rcp_f32 v54, v54
    v_rcp_f32 v55, v55
    v_rcp_f32 v56, v56
    v_rcp_f32 v57, v57
    v_rcp_f32 v58, v58
    v_rcp_f32 v59, v59
    v_rcp_f32 v60, v60
    v_rcp_f32 v61, v61
    v_rcp_f32 v62, v62
    v_rcp_f32 v63, v63
    v_pk_mul_f32 v[88:89], v[88:89], v[48:49]
    v_pk_mul_f32 v[90:91], v[90:91], v[50:51]
    v_pk_mul_f32 v[92:93], v[92:93], v[52:53]
    v_pk_mul_f32 v[94:95], v[94:95], v[54:55]
    v_pk_mul_f32 v[96:97], v[96:97], v[56:57]
    v_pk_mul_f32 v[98:99], v[98:99], v[58:59]
    v_pk_mul_f32 v[100:101], v[100:101], v[60:61]
    v_pk_mul_f32 v[102:103], v[102:103], v[62:63]
    v_cvt_pk_bf16_f32 v64, v88, v89
    v_cvt_pk_bf16_f32 v65, v90, v91
    v_cvt_pk_bf16_f32 v66, v92, v93
    v_cvt_pk_bf16_f32 v67, v94, v95
    v_cvt_pk_bf16_f32 v68, v96, v97
    v_cvt_pk_bf16_f32 v69, v98, v99
    v_cvt_pk_bf16_f32 v70, v100, v101
    v_cvt_pk_bf16_f32 v71, v102, v103
    buffer_store_dwordx4 v[64:67], v148, s[20:23], s52 offen sc1
    buffer_store_dwordx4 v[68:71], v148, s[20:23], s52 offen offset:1024 sc1
    s_add_u32 s52, s52, 2048
    v_pk_mul_f32 v[32:33], v[104:105], v[138:139] op_sel_hi:[1,0]
    v_pk_mul_f32 v[34:35], v[106:107], v[138:139] op_sel_hi:[1,0]
    v_pk_mul_f32 v[36:37], v[108:109], v[138:139] op_sel_hi:[1,0]
    v_pk_mul_f32 v[38:39], v[110:111], v[138:139] op_sel_hi:[1,0]
    v_pk_mul_f32 v[40:41], v[112:113], v[138:139] op_sel_hi:[1,0]
    v_pk_mul_f32 v[42:43], v[114:115], v[138:139] op_sel_hi:[1,0]
    v_pk_mul_f32 v[44:45], v[116:117], v[138:139] op_sel_hi:[1,0]
    v_pk_mul_f32 v[46:47], v[118:119], v[138:139] op_sel_hi:[1,0]
    v_exp_f32 v32, v32
    v_exp_f32 v33, v33
    v_exp_f32 v34, v34
    v_exp_f32 v35, v35
    v_exp_f32 v36, v36
    v_exp_f32 v37, v37
    v_exp_f32 v38, v38
    v_exp_f32 v39, v39
    v_exp_f32 v40, v40
    v_exp_f32 v41, v41
    v_exp_f32 v42, v42
    v_exp_f32 v43, v43
    v_exp_f32 v44, v44
    v_exp_f32 v45, v45
    v_exp_f32 v46, v46
    v_exp_f32 v47, v47
    v_pk_fma_f32 v[32:33], v[32:33], v[166:167], v[166:167] op_sel_hi:[1,0,0]
    v_pk_fma_f32 v[34:35], v[34:35], v[166:167], v[166:167] op_sel_hi:[1,0,0]
    v_pk_fma_f32 v[36:37], v[36:37], v[166:167], v[166:167] op_sel_hi:[1,0,0]
    v_pk_fma_f32 v[38:39], v[38:39], v[166:167], v[166:167] op_sel_hi:[1,0,0]
    v_pk_fma_f32 v[40:41], v[40:41], v[166:167], v[166:167] op_sel_hi:[1,0,0]
    v_pk_fma_f32 v[42:43], v[42:43], v[166:167], v[166:167] op_sel_hi:[1,0,0]
    v_pk_fma_f32 v[44:45], v[44:45], v[166:167], v[166:167] op_sel_hi:[1,0,0]
    v_pk_fma_f32 v[46:47], v[46:47], v[166:167], v[166:167] op_sel_hi:[1,0,0]
    v_rcp_f32 v32, v32
    v_rcp_f32 v33, v33
    v_rcp_f32 v34, v34
    v_rcp_f32 v35, v35
    v_rcp_f32 v36, v36
    v_rcp_f32 v37, v37
    v_rcp_f32 v38, v38
    v_rcp_f32 v39, v39
    v_rcp_f32 v40, v40
    v_rcp_f32 v41, v41
    v_rcp_f32 v42, v42
    v_rcp_f32 v43, v43
    v_rcp_f32 v44, v44
    v_rcp_f32 v45, v45
    v_rcp_f32 v46, v46
    v_rcp_f32 v47, v47
    v_pk_mul_f32 v[104:105], v[104:105], v[32:33]
    v_pk_mul_f32 v[106:107], v[106:107], v[34:35]
    v_pk_mul_f32 v[108:109], v[108:109], v[36:37]
    v_pk_mul_f32 v[110:111], v[110:111], v[38:39]
    v_pk_mul_f32 v[112:113], v[112:113], v[40:41]
    v_pk_mul_f32 v[114:115], v[114:115], v[42:43]
    v_pk_mul_f32 v[116:117], v[116:117], v[44:45]
    v_pk_mul_f32 v[118:119], v[118:119], v[46:47]
    v_cvt_pk_bf16_f32 v24, v104, v105
    v_cvt_pk_bf16_f32 v25, v106, v107
    v_cvt_pk_bf16_f32 v26, v108, v109
    v_cvt_pk_bf16_f32 v27, v110, v111
    v_cvt_pk_bf16_f32 v28, v112, v113
    v_cvt_pk_bf16_f32 v29, v114, v115
    v_cvt_pk_bf16_f32 v30, v116, v117
    v_cvt_pk_bf16_f32 v31, v118, v119
    buffer_store_dwordx4 v[24:27], v148, s[20:23], s52 offen sc1
    buffer_store_dwordx4 v[28:31], v148, s[20:23], s52 offen offset:1024 sc1
    s_add_u32 s52, s52, 2048
    s_waitcnt vmcnt(0)
p1_end:
    s_barrier
    s_cmp_eq_u32 s44, 4
    s_cbranch_scc0 p1_done
    s_lshl_b32 s52, s47, 3
    s_add_u32 s52, s52, s48
    s_lshl_b32 s52, s52, 7
    s_add_u32 s52, s52, 15204352
    v_mov_b32 v148, s100
    v_mov_b32 v149, s101
    s_mov_b64 exec, 1
    buffer_store_dwordx2 v[148:149], off, s[20:23], s52 offset:64 sc0 sc1
    s_mov_b64 exec, -1
p1_done:
    s_cmp_eq_u32 s67, 1
    s_cbranch_scc1 safe
p1_doneA:
p2_entry:
    v_lshlrev_b32 v2, 4, v1
    v_and_b32 v12, 7, v1
    v_bfe_u32 v13, v1, 4, 1
    v_lshlrev_b32 v13, 2, v13
    v_xor_b32 v12, v12, v13
    v_lshlrev_b32 v12, 4, v12
    s_lshl_b32 s52, s69, 7
    v_add_u32 v12, s52, v12
    v_lshrrev_b32 v13, 3, v1
    v_lshl_add_u32 v3, v13, 10, v12
    v_bfe_u32 v13, v1, 3, 2
    v_lshrrev_b32 v14, 5, v1
    v_lshl_add_u32 v13, v14, 3, v13
    v_lshl_add_u32 v4, v13, 10, v12
    v_mov_b32 v252, 161792
    v_lshlrev_b32 v253, 3, v1
    s_memrealtime s[4:5]
    s_or_b32 s55, s49, s67
    s_cselect_b32 s55, 2, 0
    s_cmp_eq_u32 s67, 0
    s_cbranch_scc1 p2_pf
    s_add_u32 m0, s72, 0
    s_add_u32 s52, s73, 0
    buffer_load_dwordx4 v3, s[28:31], s52 offen lds
    s_add_u32 m0, s72, 1024
    s_add_u32 s52, s73, 8192
    buffer_load_dwordx4 v3, s[28:31], s52 offen lds
    s_add_u32 m0, s72, 2048
    s_add_u32 s52, s73, 16384
    buffer_load_dwordx4 v3, s[28:31], s52 offen lds
    s_add_u32 m0, s72, 3072
    s_add_u32 s52, s73, 24576
    buffer_load_dwordx4 v3, s[28:31], s52 offen lds
    s_add_u32 m0, s72, 4096
    s_add_u32 s52, s73, 32768
    buffer_load_dwordx4 v3, s[28:31], s52 offen lds
    s_add_u32 m0, s72, 5120
    s_add_u32 s52, s73, 40960
    buffer_load_dwordx4 v3, s[28:31], s52 offen lds
    s_add_u32 m0, s72, 6144
    s_add_u32 s52, s73, 49152
    buffer_load_dwordx4 v3, s[28:31], s52 offen lds
    s_add_u32 m0, s72, 7168
    s_add_u32 s52, s73, 57344
    buffer_load_dwordx4 v3, s[28:31], s52 offen lds
    s_add_u32 m0, s72, 8192
    s_add_u32 s52, s73, 65536
    buffer_load_dwordx4 v3, s[28:31], s52 offen lds
    s_add_u32 m0, s72, 9216
    s_add_u32 s52, s73, 73728
    buffer_load_dwordx4 v3, s[28:31], s52 offen lds
    s_add_u32 m0, s72, 10240
    s_add_u32 s52, s73, 81920
    buffer_load_dwordx4 v3, s[28:31], s52 offen lds
    s_add_u32 m0, s72, 11264
    s_add_u32 s52, s73, 90112
    buffer_load_dwordx4 v3, s[28:31], s52 offen lds
    s_add_u32 s66, s73, 98304
    buffer_load_dwordx4 v[184:187], v3, s[28:31], s66 offen
    s_add_u32 s66, s73, 106496
    buffer_load_dwordx4 v[188:191], v3, s[28:31], s66 offen
    s_add_u32 s66, s73, 114688
    buffer_load_dwordx4 v[192:195], v3, s[28:31], s66 offen
    s_add_u32 s66, s73, 122880
    buffer_load_dwordx4 v[196:199], v3, s[28:31], s66 offen
    s_add_u32 s66, s73, 131072
    buffer_load_dwordx4 v[200:203], v3, s[28:31], s66 offen
    s_add_u32 s66, s73, 139264
    buffer_load_dwordx4 v[204:207], v3, s[28:31], s66 offen
    s_add_u32 s66, s73, 147456
    buffer_load_dwordx4 v[208:211], v3, s[28:31], s66 offen
    s_add_u32 s66, s73, 155648
    buffer_load_dwordx4 v[212:215], v3, s[28:31], s66 offen
    s_add_u32 s66, s73, 163840
    buffer_load_dwordx4 v[216:219], v3, s[28:31], s66 offen
    s_add_u32 s66, s73, 172032
    buffer_load_dwordx4 v[220:223], v3, s[28:31], s66 offen
    s_add_u32 s66, s73, 180224
    buffer_load_dwordx4 v[224:227], v3, s[28:31], s66 offen
    s_add_u32 s66, s73, 188416
    buffer_load_dwordx4 v[228:231], v3, s[28:31], s66 offen
    s_add_u32 s66, s73, 196608
    buffer_load_dwordx4 v[232:235], v3, s[28:31], s66 offen
    s_add_u32 s66, s73, 204800
    buffer_load_dwordx4 v[236:239], v3, s[28:31], s66 offen
    s_add_u32 s66, s73, 212992
    buffer_load_dwordx4 v[240:243], v3, s[28:31], s66 offen
    s_add_u32 s66, s73, 221184
    buffer_load_dwordx4 v[244:247], v3, s[28:31], s66 offen
    s_waitcnt vmcnt(0)
p2_pf:
    s_lshl_b32 s52, s68, 1
    s_mul_i32 s70, s52, 112
    s_mul_i32 s53, s59, 14
    s_add_u32 s70, s70, s53
    s_lshl_b32 s70, s70, 10
    s_add_u32 s71, s70, 114688
    s_lshl_b32 s74, s52, 5
    s_lshl_b32 s53, s59, 2
    s_add_u32 s74, s74, s53
    s_lshl_b32 s74, s74, 10
    s_add_u32 s74, s74, 8388608
    s_and_b32 s52, s52, 2
    s_lshl_b32 s75, 0x33, s52
    s_mul_i32 s76, s48, 8704
    s_add_u32 s76, s76, 14680064
    s_mov_b32 s63, 0
    s_xor_b32 s52, s44, 4
    s_or_b32 s52, s52, s55
    s_cbranch_scc1 o0_np
    s_setprio 3
    s_mov_b32 s63, 1
    buffer_load_dwordx2 v[24:25], v253, s[20:23], s79 offen sc0 sc1
    s_sleep 3
    buffer_load_dwordx2 v[26:27], v253, s[20:23], s79 offen sc0 sc1
    s_sleep 3
o0_poll:
    buffer_load_dwordx2 v[28:29], v253, s[20:23], s79 offen sc0 sc1
    s_waitcnt vmcnt(2)
    v_cmp_eq_u64 vcc, s[100:101], v[24:25]
    s_nop 0
    s_cmp_eq_u64 vcc, -1
    s_cbranch_scc1 o0_ok
    buffer_load_dwordx2 v[24:25], v253, s[20:23], s79 offen sc0 sc1
    s_waitcnt vmcnt(2)
    v_cmp_eq_u64 vcc, s[100:101], v[26:27]
    s_nop 0
    s_cmp_eq_u64 vcc, -1
    s_cbranch_scc1 o0_ok
    buffer_load_dwordx2 v[26:27], v253, s[20:23], s79 offen sc0 sc1
    s_waitcnt vmcnt(2)
    v_cmp_eq_u64 vcc, s[100:101], v[28:29]
    s_nop 0
    s_cmp_eq_u64 vcc, -1
    s_cbranch_scc1 o0_ok
    s_memrealtime s[6:7]
    s_waitcnt lgkmcnt(0)
    s_sub_u32 s52, s6, s4
    s_cmp_gt_u32 s52, 200000
    s_cbranch_scc0 o0_poll
    v_mov_b32 v20, 2
    s_branch o0_pub
o0_ok:
    s_add_u32 s52, s76, 4352
    s_lshl_b32 s53, s59, 7
    s_sub_u32 s53, s78, s53
    v_lshlrev_b32 v21, 7, v1
    s_mov_b64 exec, 0xff
    buffer_load_dwordx2 v[22:23], v21, s[20:23], s53 offen offset:64 sc0 sc1
    s_mov_b32 exec_lo, 0x0011ffff
    s_mov_b32 exec_hi, 0x0011ffff
    buffer_load_dwordx4 v[136:139], v17, s[20:23], s76 offen offset:0
    buffer_load_dwordx4 v[140:143], v17, s[20:23], s76 offen offset:16
    buffer_load_dwordx4 v[144:147], v17, s[20:23], s76 offen offset:64
    buffer_load_dwordx4 v[148:151], v17, s[20:23], s76 offen offset:80
    buffer_load_dwordx4 v[152:155], v17, s[20:23], s76 offen offset:2176
    buffer_load_dwordx4 v[156:159], v17, s[20:23], s76 offen offset:2192
    buffer_load_dwordx4 v[160:163], v17, s[20:23], s76 offen offset:2240
    buffer_load_dwordx4 v[164:167], v17, s[20:23], s76 offen offset:2256
    buffer_load_dwordx4 v[168:171], v17, s[20:23], s52 offen offset:0
    buffer_load_dwordx4 v[172:175], v17, s[20:23], s52 offen offset:16
    buffer_load_dwordx4 v[176:179], v17, s[20:23], s52 offen offset:64
    buffer_load_dwordx4 v[180:183], v17, s[20:23], s52 offen offset:80
    buffer_load_dwordx4 v[72:75], v17, s[20:23], s52 offen offset:2176
    buffer_load_dwordx4 v[76:79], v17, s[20:23], s52 offen offset:2192
    buffer_load_dwordx4 v[80:83], v17, s[20:23], s52 offen offset:2240
    buffer_load_dwordx4 v[84:87], v17, s[20:23], s52 offen offset:2256
    s_mov_b64 exec, -1
    v_add_u32 v19, 59392, v18
    s_waitcnt vmcnt(12)
    v_cvt_pk_bf16_f32 v136, v136, v137
    v_cvt_pk_bf16_f32 v137, v138, v139
    v_cvt_pk_bf16_f32 v138, v140, v141
    v_cvt_pk_bf16_f32 v139, v142, v143
    v_cvt_pk_bf16_f32 v140, v144, v145
    v_cvt_pk_bf16_f32 v141, v146, v147
    v_cvt_pk_bf16_f32 v142, v148, v149
    v_cvt_pk_bf16_f32 v143, v150, v151
    ds_write_b128 v19, v[136:139] offset:0
    ds_write_b128 v19, v[140:143] offset:1024
    s_waitcnt vmcnt(8)
    v_cmp_eq_u64 vcc, s[100:101], v[22:23]
    s_nop 0
    s_and_b32 s53, vcc_lo, 0xff
    s_lshl_b32 s53, s53, 8
    s_or_b32 s53, s53, 1
    v_mov_b32 v20, s53
    v_cvt_pk_bf16_f32 v152, v152, v153
    v_cvt_pk_bf16_f32 v153, v154, v155
    v_cvt_pk_bf16_f32 v154, v156, v157
    v_cvt_pk_bf16_f32 v155, v158, v159
    v_cvt_pk_bf16_f32 v156, v160, v161
    v_cvt_pk_bf16_f32 v157, v162, v163
    v_cvt_pk_bf16_f32 v158, v164, v165
    v_cvt_pk_bf16_f32 v159, v166, v167
    ds_write_b128 v19, v[152:155] offset:20480
    ds_write_b128 v19, v[156:159] offset:21504
    s_waitcnt vmcnt(4)
    v_cvt_pk_bf16_f32 v168, v168, v169
    v_cvt_pk_bf16_f32 v169, v170, v171
    v_cvt_pk_bf16_f32 v170, v172, v173
    v_cvt_pk_bf16_f32 v171, v174, v175
    v_cvt_pk_bf16_f32 v172, v176, v177
    v_cvt_pk_bf16_f32 v173, v178, v179
    v_cvt_pk_bf16_f32 v174, v180, v181
    v_cvt_pk_bf16_f32 v175, v182, v183
    ds_write_b128 v19, v[168:171] offset:40960
    ds_write_b128 v19, v[172:175] offset:41984
    s_waitcnt vmcnt(0)
    v_cvt_pk_bf16_f32 v72, v72, v73
    v_cvt_pk_bf16_f32 v73, v74, v75
    v_cvt_pk_bf16_f32 v74, v76, v77
    v_cvt_pk_bf16_f32 v75, v78, v79
    v_cvt_pk_bf16_f32 v76, v80, v81
    v_cvt_pk_bf16_f32 v77, v82, v83
    v_cvt_pk_bf16_f32 v78, v84, v85
    v_cvt_pk_bf16_f32 v79, v86, v87
    ds_write_b128 v19, v[72:75] offset:61440
    ds_write_b128 v19, v[76:79] offset:62464
o0_pub:
    ds_write_b32 v252, v20
    s_setprio 0
o0_np:
    s_cmp_eq_u32 s55, 0
    s_cbranch_scc0 oe_end
    s_cmp_lt_u32 s44, 4
    s_cbranch_scc1 oe_end
    s_mul_i32 s52, s46, 40960
    s_add_u32 s52, s52, 59392
    v_add_u32 v16, s52, v2
oe_spin:
    ds_read_b32 v20, v252
    s_waitcnt lgkmcnt(0)
    v_readfirstlane_b32 s53, v20
    s_nop 0
    s_and_b32 s55, s53, 3
    s_cbranch_scc0 oe_spin
    s_cmp_eq_u32 s55, 2
    s_cbranch_scc1 oe_end
    ds_read_b128 v[88:91], v16 offset:0
    ds_read_b128 v[92:95], v16 offset:1024
    ds_read_b128 v[48:51], v16 offset:20480
    ds_read_b128 v[52:55], v16 offset:21504
    s_waitcnt lgkmcnt(2)
    v_mfma_f32_32x32x16_bf16 v[72:87], v[88:91], v[56:59], 0
    v_mfma_f32_32x32x16_bf16 v[72:87], v[92:95], v[60:63], v[72:87]
    s_waitcnt lgkmcnt(0)
    v_mfma_f32_32x32x16_bf16 v[32:47], v[48:51], v[64:67], 0
    v_mfma_f32_32x32x16_bf16 v[32:47], v[52:55], v[68:71], v[32:47]
    s_nop 8
    v_add_f32 v80, s77, v80
    v_rcp_f32 v80, v80
    s_nop 0
    v_pk_mul_f32 v[72:73], v[72:73], v[80:81] op_sel_hi:[1,0]
    v_pk_mul_f32 v[74:75], v[74:75], v[80:81] op_sel_hi:[1,0]
    v_pk_mul_f32 v[76:77], v[76:77], v[80:81] op_sel_hi:[1,0]
    v_pk_mul_f32 v[78:79], v[78:79], v[80:81] op_sel_hi:[1,0]
    v_cvt_pk_bf16_f32 v88, v72, v73
    v_cvt_pk_bf16_f32 v89, v74, v75
    v_cvt_pk_bf16_f32 v90, v76, v77
    v_cvt_pk_bf16_f32 v91, v78, v79
    buffer_store_dwordx4 v[88:91], v18, s[20:23], s62 offen offset:0 sc1
    v_add_f32 v40, s77, v40
    v_rcp_f32 v40, v40
    s_nop 0
    v_pk_mul_f32 v[32:33], v[32:33], v[40:41] op_sel_hi:[1,0]
    v_pk_mul_f32 v[34:35], v[34:35], v[40:41] op_sel_hi:[1,0]
    v_pk_mul_f32 v[36:37], v[36:37], v[40:41] op_sel_hi:[1,0]
    v_pk_mul_f32 v[38:39], v[38:39], v[40:41] op_sel_hi:[1,0]
    v_cvt_pk_bf16_f32 v48, v32, v33
    v_cvt_pk_bf16_f32 v49, v34, v35
    v_cvt_pk_bf16_f32 v50, v36, v37
    v_cvt_pk_bf16_f32 v51, v38, v39
    buffer_store_dwordx4 v[48:51], v18, s[20:23], s62 offen offset:1024 sc1
    s_lshr_b32 s53, s53, 8
    s_bitcmp1_b32 s53, s59
    s_cbranch_scc0 oe_end
    s_mov_b32 s55, 3
oe_end:
    v_add_u32 v14, s72, v2
    s_cmp_eq_u32 s63, 1
    s_cbranch_scc1 o0_cp0
    s_waitcnt vmcnt(14)
    s_cmp_eq_u32 s55, 3
    s_cbranch_scc1 o0_cp0
    s_waitcnt vmcnt(12)
o0_cp0:
    ds_write_b128 v14, v[184:187] offset:12288
    ds_write_b128 v14, v[188:191] offset:13312
    ds_write_b128 v14, v[192:195] offset:14336
    ds_write_b128 v14, v[196:199] offset:15360
    ds_write_b128 v14, v[200:203] offset:16384
    ds_write_b128 v14, v[204:207] offset:17408
    v_lshrrev_b32 v12, 5, v1
    v_bfe_u32 v13, v1, 2, 2
    v_lshl_add_u32 v12, v12, 2, v13
    v_lshlrev_b32 v12, 7, v12
    v_bfe_u32 v13, v1, 3, 1
    v_lshl_add_u32 v12, v13, 6, v12
    v_bfe_u32 v13, v1, 4, 1
    v_lshl_add_u32 v12, v13, 5, v12
    v_and_b32 v13, 3, v1
    v_lshl_add_u32 v12, v13, 3, v12
    v_add_u32 v5, s72, v12
    v_xor_b32 v6, 64, v5
    s_bitcmp1_b32 s55, 0
    s_cbranch_scc0 of_no
    s_waitcnt vmcnt(0)
    s_cmp_eq_u32 s55, 3
    s_cbranch_scc1 of_e
    s_waitcnt vmcnt(0)
of_e:
    v_mov_b32 v22, s100
    v_mov_b32 v23, s101
    s_mov_b64 exec, 1
    buffer_store_dwordx2 v[22:23], off, s[20:23], s54 offset:0 sc0 sc1
    s_mov_b64 exec, -1
    s_add_u32 s55, s55, 1
of_no:
    s_cmp_eq_u32 s63, 1
    s_cbranch_scc1 o0_cp1
    s_cmp_eq_u32 s55, 4
    s_cbranch_scc1 o0_cp1
    s_waitcnt vmcnt(0)
o0_cp1:
    ds_read_b64_tr_b16 v[96:97], v5 offset:0
    ds_read_b64_tr_b16 v[98:99], v5 offset:1024
    ds_read_b64_tr_b16 v[100:101], v6 offset:0
    ds_read_b64_tr_b16 v[102:103], v6 offset:1024
    ds_read_b64_tr_b16 v[104:105], v5 offset:2048
    ds_read_b64_tr_b16 v[106:107], v5 offset:3072
    ds_read_b64_tr_b16 v[108:109], v6 offset:2048
    ds_read_b64_tr_b16 v[110:111], v6 offset:3072
    ds_read_b64_tr_b16 v[112:113], v5 offset:4096
    ds_read_b64_tr_b16 v[114:115], v5 offset:5120
    ds_read_b64_tr_b16 v[116:117], v6 offset:4096
    ds_read_b64_tr_b16 v[118:119], v6 offset:5120
    ds_read_b64_tr_b16 v[120:121], v5 offset:6144
    ds_read_b64_tr_b16 v[122:123], v5 offset:7168
    ds_read_b64_tr_b16 v[124:125], v6 offset:6144
    ds_read_b64_tr_b16 v[126:127], v6 offset:7168
    ds_read_b64_tr_b16 v[128:129], v5 offset:8192
    ds_read_b64_tr_b16 v[130:131], v5 offset:9216
    ds_read_b64_tr_b16 v[132:133], v6 offset:8192
    ds_read_b64_tr_b16 v[134:135], v6 offset:9216
    ds_write_b128 v14, v[208:211] offset:0
    ds_write_b128 v14, v[212:215] offset:1024
    ds_write_b128 v14, v[216:219] offset:2048
    ds_write_b128 v14, v[220:223] offset:3072
    ds_write_b128 v14, v[224:227] offset:4096
    ds_write_b128 v14, v[228:231] offset:5120
    ds_write_b128 v14, v[232:235] offset:6144
    ds_write_b128 v14, v[236:239] offset:7168
    ds_write_b128 v14, v[240:243] offset:8192
    ds_write_b128 v14, v[244:247] offset:9216
    ds_read_b64_tr_b16 v[216:217], v5 offset:10240
    ds_read_b64_tr_b16 v[218:219], v5 offset:11264
    ds_read_b64_tr_b16 v[220:221], v6 offset:10240
    ds_read_b64_tr_b16 v[222:223], v6 offset:11264
    ds_read_b64_tr_b16 v[224:225], v5 offset:12288
    ds_read_b64_tr_b16 v[226:227], v5 offset:13312
    ds_read_b64_tr_b16 v[228:229], v6 offset:12288
    ds_read_b64_tr_b16 v[230:231], v6 offset:13312
    ds_read_b64_tr_b16 v[232:233], v5 offset:14336
    ds_read_b64_tr_b16 v[234:235], v5 offset:15360
    ds_read_b64_tr_b16 v[236:237], v6 offset:14336
    ds_read_b64_tr_b16 v[238:239], v6 offset:15360
    ds_read_b64_tr_b16 v[240:241], v5 offset:16384
    ds_read_b64_tr_b16 v[242:243], v5 offset:17408
    ds_read_b64_tr_b16 v[244:245], v6 offset:16384
    ds_read_b64_tr_b16 v[246:247], v6 offset:17408
    s_mul_i32 s52, s46, 40960
    s_add_u32 s52, s52, 59392
    v_add_u32 v255, s52, v2
    v_mov_b32 v192, v56
    v_mov_b32 v193, v57
    v_mov_b32 v194, v58
    v_mov_b32 v195, v59
    v_mov_b32 v196, v60
    v_mov_b32 v197, v61
    v_mov_b32 v198, v62
    v_mov_b32 v199, v63
    v_mov_b32 v200, v64
    v_mov_b32 v201, v65
    v_mov_b32 v202, v66
    v_mov_b32 v203, v67
    v_mov_b32 v204, v68
    v_mov_b32 v205, v69
    v_mov_b32 v206, v70
    v_mov_b32 v207, v71
    s_mov_b64 exec, 1
    buffer_load_dwordx2 v[248:249], off, s[20:23], s78 offset:64 sc0 sc1
    s_mov_b64 exec, -1
    s_lshl_b32 s52, s68, 6
    v_lshrrev_b32 v12, 3, v0
    v_add_u32 v12, s52, v12
    v_lshlrev_b32 v12, 10, v12
    v_and_b32 v13, 7, v0
    v_lshl_add_u32 v12, v13, 4, v12
    s_lshl_b32 s52, s69, 7
    v_add_u32 v7, s52, v12
    buffer_load_dwordx4 v[8:11], v7, s[8:11], 0 offen
    s_waitcnt lgkmcnt(0)
    s_add_u32 m0, s72, 10240
    s_lshl_b32 s52, s59, 16
    s_add_u32 s52, s52, 0
    buffer_load_dwordx4 v4, s[32:35], s52 offen lds
    s_add_u32 m0, s72, 11264
    s_lshl_b32 s52, s59, 16
    s_add_u32 s52, s52, 4096
    buffer_load_dwordx4 v4, s[32:35], s52 offen lds
    s_add_u32 m0, s72, 12288
    s_lshl_b32 s52, s59, 16
    s_add_u32 s52, s52, 16384
    buffer_load_dwordx4 v4, s[32:35], s52 offen lds
    s_add_u32 m0, s72, 13312
    s_lshl_b32 s52, s59, 16
    s_add_u32 s52, s52, 20480
    buffer_load_dwordx4 v4, s[32:35], s52 offen lds
    s_add_u32 m0, s72, 14336
    s_lshl_b32 s52, s59, 16
    s_add_u32 s52, s52, 32768
    buffer_load_dwordx4 v4, s[32:35], s52 offen lds
    s_add_u32 m0, s72, 15360
    s_lshl_b32 s52, s59, 16
    s_add_u32 s52, s52, 36864
    buffer_load_dwordx4 v4, s[32:35], s52 offen lds
    s_add_u32 m0, s72, 16384
    s_lshl_b32 s52, s59, 16
    s_add_u32 s52, s52, 49152
    buffer_load_dwordx4 v4, s[32:35], s52 offen lds
    s_add_u32 m0, s72, 17408
    s_lshl_b32 s52, s59, 16
    s_add_u32 s52, s52, 53248
    buffer_load_dwordx4 v4, s[32:35], s52 offen lds
    s_cmp_eq_u32 s55, 4
    s_cbranch_scc1 p2_go
    s_cmp_eq_u32 s55, 0
    s_cbranch_scc0 op_e0
op_s0:
    ds_read_b32 v16, v252
    ds_read_b128 v[208:211], v255
    ds_read_b128 v[212:215], v255 offset:1024
    s_waitcnt lgkmcnt(2)
    v_readfirstlane_b32 s55, v16
    s_nop 0
    s_cmp_eq_u32 s55, 0
    s_cbranch_scc1 op_e0
    s_cmp_eq_u32 s55, 2
    s_cbranch_scc1 op_e0
    s_waitcnt lgkmcnt(0)
    v_mfma_f32_32x32x16_bf16 v[16:31], v[208:211], v[192:195], 0
    v_mfma_f32_32x32x16_bf16 v[16:31], v[212:215], v[196:199], v[16:31]
    s_nop 11
    v_add_f32 v24, s77, v24
    ds_read_b128 v[208:211], v255 offset:20480
    ds_read_b128 v[212:215], v255 offset:21504
    v_rcp_f32 v24, v24
    s_nop 0
    v_pk_mul_f32 v[16:17], v[16:17], v[24:25] op_sel_hi:[1,0]
    v_pk_mul_f32 v[18:19], v[18:19], v[24:25] op_sel_hi:[1,0]
    v_pk_mul_f32 v[20:21], v[20:21], v[24:25] op_sel_hi:[1,0]
    v_pk_mul_f32 v[22:23], v[22:23], v[24:25] op_sel_hi:[1,0]
    v_cvt_pk_bf16_f32 v192, v16, v17
    v_cvt_pk_bf16_f32 v193, v18, v19
    v_cvt_pk_bf16_f32 v194, v20, v21
    v_cvt_pk_bf16_f32 v195, v22, v23
    buffer_store_dwordx4 v[192:195], v2, s[20:23], s62 offen offset:0 sc1
    s_waitcnt lgkmcnt(0)
    v_mfma_f32_32x32x16_bf16 v[16:31], v[208:211], v[200:203], 0
    v_mfma_f32_32x32x16_bf16 v[16:31], v[212:215], v[204:207], v[16:31]
    s_nop 11
    v_add_f32 v24, s77, v24
    v_rcp_f32 v24, v24
    s_nop 0
    v_pk_mul_f32 v[16:17], v[16:17], v[24:25] op_sel_hi:[1,0]
    v_pk_mul_f32 v[18:19], v[18:19], v[24:25] op_sel_hi:[1,0]
    v_pk_mul_f32 v[20:21], v[20:21], v[24:25] op_sel_hi:[1,0]
    v_pk_mul_f32 v[22:23], v[22:23], v[24:25] op_sel_hi:[1,0]
    v_cvt_pk_bf16_f32 v200, v16, v17
    v_cvt_pk_bf16_f32 v201, v18, v19
    v_cvt_pk_bf16_f32 v202, v20, v21
    v_cvt_pk_bf16_f32 v203, v22, v23
    buffer_store_dwordx4 v[200:203], v2, s[20:23], s62 offen offset:1024 sc1
    s_mov_b32 s55, 10
op_e0:
    s_waitcnt vmcnt(9)
    s_branch p2_chk
p2_poll:
    s_mov_b64 exec, 1
    buffer_load_dwordx2 v[248:249], off, s[20:23], s78 offset:64 sc0 sc1
    s_mov_b64 exec, -1
    s_waitcnt vmcnt(0)
p2_chk:
    v_cmp_eq_u64 vcc, s[100:101], v[248:249]
    s_nop 0
    s_bitcmp1_b32 vcc_lo, 0
    s_cbranch_scc1 p2_go
    s_memrealtime s[6:7]
    s_waitcnt lgkmcnt(0)
    s_sub_u32 s52, s6, s4
    s_cmp_gt_u32 s52, 200000
    s_cbranch_scc1 p2_kvabort
    s_sleep 2
    s_branch p2_poll
p2_go:
    s_waitcnt lgkmcnt(0)
    s_sub_u32 s52, s100, s4
    s_add_u32 s52, s52, 100
    s_cmp_lt_u32 s52, 800
    s_cbranch_scc1 p2_early
p2_late:
    s_cmp_eq_u32 s55, 4
    s_cbranch_scc1 p2_oj
p2_oj:
    buffer_load_dwordx4 v[136:139], v2, s[20:23], s70 offen offset:0
    buffer_load_dwordx4 v[140:143], v2, s[20:23], s71 offen offset:0
    buffer_load_dwordx4 v[144:147], v2, s[20:23], s70 offen offset:1024
    buffer_load_dwordx4 v[148:151], v2, s[20:23], s71 offen offset:1024
    buffer_load_dwordx4 v[152:155], v2, s[20:23], s70 offen offset:2048
    buffer_load_dwordx4 v[156:159], v2, s[20:23], s71 offen offset:2048
    s_cmp_eq_u32 s55, 10
    s_cbranch_scc0 of_e0
    s_waitcnt vmcnt(6)
    v_mov_b32 v208, s100
    v_mov_b32 v209, s101
    s_mov_b64 exec, 1
    buffer_store_dwordx2 v[208:209], off, s[20:23], s54 offset:0 sc0 sc1
    s_mov_b64 exec, -1
    s_mov_b32 s55, 2
of_e0:
    buffer_load_dwordx4 v[160:163], v2, s[20:23], s70 offen offset:3072
    buffer_load_dwordx4 v[164:167], v2, s[20:23], s71 offen offset:3072
    s_add_u32 s70, s70, 4096
    s_add_u32 s71, s71, 4096
    buffer_load_dwordx4 v[168:171], v2, s[20:23], s70 offen offset:0
    buffer_load_dwordx4 v[172:175], v2, s[20:23], s71 offen offset:0
    buffer_load_dwordx4 v[176:179], v2, s[20:23], s70 offen offset:1024
    buffer_load_dwordx4 v[180:183], v2, s[20:23], s71 offen offset:1024
    buffer_load_dwordx4 v[184:187], v2, s[20:23], s70 offen offset:2048
    buffer_load_dwordx4 v[188:191], v2, s[20:23], s71 offen offset:2048
    s_waitcnt vmcnt(12)
    v_mfma_f32_32x32x16_bf16 v[32:47], v[96:99], v[136:139], 0
    v_mfma_f32_32x32x16_bf16 v[48:63], v[96:99], v[140:143], 0
    v_mfma_f32_32x32x16_bf16 v[64:79], v[100:103], v[136:139], 0
    v_mfma_f32_32x32x16_bf16 v[80:95], v[100:103], v[140:143], 0
    buffer_load_dwordx4 v[136:139], v2, s[20:23], s70 offen offset:3072
    buffer_load_dwordx4 v[140:143], v2, s[20:23], s71 offen offset:3072
    s_waitcnt vmcnt(12)
    v_mfma_f32_32x32x16_bf16 v[32:47], v[104:107], v[144:147], v[32:47]
    v_mfma_f32_32x32x16_bf16 v[48:63], v[104:107], v[148:151], v[48:63]
    v_mfma_f32_32x32x16_bf16 v[64:79], v[108:111], v[144:147], v[64:79]
    v_mfma_f32_32x32x16_bf16 v[80:95], v[108:111], v[148:151], v[80:95]
    s_add_u32 s70, s70, 4096
    s_add_u32 s71, s71, 4096
    buffer_load_dwordx4 v[144:147], v2, s[20:23], s70 offen offset:0
    buffer_load_dwordx4 v[148:151], v2, s[20:23], s71 offen offset:0
    s_cmp_eq_u32 s55, 0
    s_cbranch_scc0 op_e2
op_s2:
    ds_read_b32 v16, v252
    ds_read_b128 v[208:211], v255
    ds_read_b128 v[212:215], v255 offset:1024
    s_waitcnt lgkmcnt(2)
    v_readfirstlane_b32 s55, v16
    s_nop 0
    s_cmp_eq_u32 s55, 0
    s_cbranch_scc1 op_e2
    s_cmp_eq_u32 s55, 2
    s_cbranch_scc1 op_e2
    s_waitcnt lgkmcnt(0)
    v_mfma_f32_32x32x16_bf16 v[16:31], v[208:211], v[192:195], 0
    v_mfma_f32_32x32x16_bf16 v[16:31], v[212:215], v[196:199], v[16:31]
    s_nop 11
    v_add_f32 v24, s77, v24
    ds_read_b128 v[208:211], v255 offset:20480
    ds_read_b128 v[212:215], v255 offset:21504
    v_rcp_f32 v24, v24
    s_nop 0
    v_pk_mul_f32 v[16:17], v[16:17], v[24:25] op_sel_hi:[1,0]
    v_pk_mul_f32 v[18:19], v[18:19], v[24:25] op_sel_hi:[1,0]
    v_pk_mul_f32 v[20:21], v[20:21], v[24:25] op_sel_hi:[1,0]
    v_pk_mul_f32 v[22:23], v[22:23], v[24:25] op_sel_hi:[1,0]
    v_cvt_pk_bf16_f32 v192, v16, v17
    v_cvt_pk_bf16_f32 v193, v18, v19
    v_cvt_pk_bf16_f32 v194, v20, v21
    v_cvt_pk_bf16_f32 v195, v22, v23
    buffer_store_dwordx4 v[192:195], v2, s[20:23], s62 offen offset:0 sc1
    s_waitcnt lgkmcnt(0)
    v_mfma_f32_32x32x16_bf16 v[16:31], v[208:211], v[200:203], 0
    v_mfma_f32_32x32x16_bf16 v[16:31], v[212:215], v[204:207], v[16:31]
    s_nop 11
    v_add_f32 v24, s77, v24
    v_rcp_f32 v24, v24
    s_nop 0
    v_pk_mul_f32 v[16:17], v[16:17], v[24:25] op_sel_hi:[1,0]
    v_pk_mul_f32 v[18:19], v[18:19], v[24:25] op_sel_hi:[1,0]
    v_pk_mul_f32 v[20:21], v[20:21], v[24:25] op_sel_hi:[1,0]
    v_pk_mul_f32 v[22:23], v[22:23], v[24:25] op_sel_hi:[1,0]
    v_cvt_pk_bf16_f32 v200, v16, v17
    v_cvt_pk_bf16_f32 v201, v18, v19
    v_cvt_pk_bf16_f32 v202, v20, v21
    v_cvt_pk_bf16_f32 v203, v22, v23
    buffer_store_dwordx4 v[200:203], v2, s[20:23], s62 offen offset:1024 sc1
    s_mov_b32 s55, 12
op_e2:
    s_waitcnt vmcnt(12)
    v_mfma_f32_32x32x16_bf16 v[32:47], v[112:115], v[152:155], v[32:47]
    v_mfma_f32_32x32x16_bf16 v[48:63], v[112:115], v[156:159], v[48:63]
    v_mfma_f32_32x32x16_bf16 v[64:79], v[116:119], v[152:155], v[64:79]
    v_mfma_f32_32x32x16_bf16 v[80:95], v[116:119], v[156:159], v[80:95]
    buffer_load_dwordx4 v[152:155], v2, s[20:23], s70 offen offset:1024
    buffer_load_dwordx4 v[156:159], v2, s[20:23], s71 offen offset:1024
    s_waitcnt vmcnt(12)
    v_mfma_f32_32x32x16_bf16 v[32:47], v[120:123], v[160:163], v[32:47]
    v_mfma_f32_32x32x16_bf16 v[48:63], v[120:123], v[164:167], v[48:63]
    v_mfma_f32_32x32x16_bf16 v[64:79], v[124:127], v[160:163], v[64:79]
    v_mfma_f32_32x32x16_bf16 v[80:95], v[124:127], v[164:167], v[80:95]
    buffer_load_dwordx4 v[160:163], v2, s[20:23], s70 offen offset:2048
    buffer_load_dwordx4 v[164:167], v2, s[20:23], s71 offen offset:2048
    s_cmp_eq_u32 s55, 12
    s_cbranch_scc0 of_e2
    s_waitcnt vmcnt(4)
    v_mov_b32 v208, s100
    v_mov_b32 v209, s101
    s_mov_b64 exec, 1
    buffer_store_dwordx2 v[208:209], off, s[20:23], s54 offset:0 sc0 sc1
    s_mov_b64 exec, -1
    s_mov_b32 s55, 2
of_e2:
    s_cmp_eq_u32 s55, 0
    s_cbranch_scc0 op_e4
op_s4:
    ds_read_b32 v16, v252
    ds_read_b128 v[208:211], v255
    ds_read_b128 v[212:215], v255 offset:1024
    s_waitcnt lgkmcnt(2)
    v_readfirstlane_b32 s55, v16
    s_nop 0
    s_cmp_eq_u32 s55, 0
    s_cbranch_scc1 op_e4
    s_cmp_eq_u32 s55, 2
    s_cbranch_scc1 op_e4
    s_waitcnt lgkmcnt(0)
    v_mfma_f32_32x32x16_bf16 v[16:31], v[208:211], v[192:195], 0
    v_mfma_f32_32x32x16_bf16 v[16:31], v[212:215], v[196:199], v[16:31]
    s_nop 11
    v_add_f32 v24, s77, v24
    ds_read_b128 v[208:211], v255 offset:20480
    ds_read_b128 v[212:215], v255 offset:21504
    v_rcp_f32 v24, v24
    s_nop 0
    v_pk_mul_f32 v[16:17], v[16:17], v[24:25] op_sel_hi:[1,0]
    v_pk_mul_f32 v[18:19], v[18:19], v[24:25] op_sel_hi:[1,0]
    v_pk_mul_f32 v[20:21], v[20:21], v[24:25] op_sel_hi:[1,0]
    v_pk_mul_f32 v[22:23], v[22:23], v[24:25] op_sel_hi:[1,0]
    v_cvt_pk_bf16_f32 v192, v16, v17
    v_cvt_pk_bf16_f32 v193, v18, v19
    v_cvt_pk_bf16_f32 v194, v20, v21
    v_cvt_pk_bf16_f32 v195, v22, v23
    buffer_store_dwordx4 v[192:195], v2, s[20:23], s62 offen offset:0 sc1
    s_waitcnt lgkmcnt(0)
    v_mfma_f32_32x32x16_bf16 v[16:31], v[208:211], v[200:203], 0
    v_mfma_f32_32x32x16_bf16 v[16:31], v[212:215], v[204:207], v[16:31]
    s_nop 11
    v_add_f32 v24, s77, v24
    v_rcp_f32 v24, v24
    s_nop 0
    v_pk_mul_f32 v[16:17], v[16:17], v[24:25] op_sel_hi:[1,0]
    v_pk_mul_f32 v[18:19], v[18:19], v[24:25] op_sel_hi:[1,0]
    v_pk_mul_f32 v[20:21], v[20:21], v[24:25] op_sel_hi:[1,0]
    v_pk_mul_f32 v[22:23], v[22:23], v[24:25] op_sel_hi:[1,0]
    v_cvt_pk_bf16_f32 v200, v16, v17
    v_cvt_pk_bf16_f32 v201, v18, v19
    v_cvt_pk_bf16_f32 v202, v20, v21
    v_cvt_pk_bf16_f32 v203, v22, v23
    buffer_store_dwordx4 v[200:203], v2, s[20:23], s62 offen offset:1024 sc1
    s_mov_b32 s55, 14
op_e4:
    s_waitcnt vmcnt(12)
    v_mfma_f32_32x32x16_bf16 v[32:47], v[128:131], v[168:171], v[32:47]
    v_mfma_f32_32x32x16_bf16 v[48:63], v[128:131], v[172:175], v[48:63]
    v_mfma_f32_32x32x16_bf16 v[64:79], v[132:135], v[168:171], v[64:79]
    v_mfma_f32_32x32x16_bf16 v[80:95], v[132:135], v[172:175], v[80:95]
    buffer_load_dwordx4 v[168:171], v2, s[20:23], s70 offen offset:3072
    buffer_load_dwordx4 v[172:175], v2, s[20:23], s71 offen offset:3072
    s_mov_b64 exec, 0xff
    buffer_load_dwordx2 v[248:249], v253, s[20:23], s78 offen sc0 sc1
    s_mov_b64 exec, -1
    s_waitcnt vmcnt(13)
    v_mfma_f32_32x32x16_bf16 v[32:47], v[216:219], v[176:179], v[32:47]
    v_mfma_f32_32x32x16_bf16 v[48:63], v[216:219], v[180:183], v[48:63]
    v_mfma_f32_32x32x16_bf16 v[64:79], v[220:223], v[176:179], v[64:79]
    v_mfma_f32_32x32x16_bf16 v[80:95], v[220:223], v[180:183], v[80:95]
    s_add_u32 s70, s70, 4096
    s_add_u32 s71, s71, 4096
    buffer_load_dwordx4 v[176:179], v2, s[20:23], s70 offen offset:0
    buffer_load_dwordx4 v[180:183], v2, s[20:23], s71 offen offset:0
    s_cmp_eq_u32 s55, 14
    s_cbranch_scc0 of_e4
    s_waitcnt vmcnt(5)
    v_mov_b32 v208, s100
    v_mov_b32 v209, s101
    s_mov_b64 exec, 1
    buffer_store_dwordx2 v[208:209], off, s[20:23], s54 offset:0 sc0 sc1
    s_mov_b64 exec, -1
    s_mov_b32 s55, 2
of_e4:
    s_cmp_eq_u32 s55, 0
    s_cbranch_scc0 op_e6
op_s6:
    ds_read_b32 v16, v252
    ds_read_b128 v[208:211], v255
    ds_read_b128 v[212:215], v255 offset:1024
    s_waitcnt lgkmcnt(2)
    v_readfirstlane_b32 s55, v16
    s_nop 0
    s_cmp_eq_u32 s55, 0
    s_cbranch_scc1 op_e6
    s_cmp_eq_u32 s55, 2
    s_cbranch_scc1 op_e6
    s_waitcnt lgkmcnt(0)
    v_mfma_f32_32x32x16_bf16 v[16:31], v[208:211], v[192:195], 0
    v_mfma_f32_32x32x16_bf16 v[16:31], v[212:215], v[196:199], v[16:31]
    s_nop 11
    v_add_f32 v24, s77, v24
    ds_read_b128 v[208:211], v255 offset:20480
    ds_read_b128 v[212:215], v255 offset:21504
    v_rcp_f32 v24, v24
    s_nop 0
    v_pk_mul_f32 v[16:17], v[16:17], v[24:25] op_sel_hi:[1,0]
    v_pk_mul_f32 v[18:19], v[18:19], v[24:25] op_sel_hi:[1,0]
    v_pk_mul_f32 v[20:21], v[20:21], v[24:25] op_sel_hi:[1,0]
    v_pk_mul_f32 v[22:23], v[22:23], v[24:25] op_sel_hi:[1,0]
    v_cvt_pk_bf16_f32 v192, v16, v17
    v_cvt_pk_bf16_f32 v193, v18, v19
    v_cvt_pk_bf16_f32 v194, v20, v21
    v_cvt_pk_bf16_f32 v195, v22, v23
    buffer_store_dwordx4 v[192:195], v2, s[20:23], s62 offen offset:0 sc1
    s_waitcnt lgkmcnt(0)
    v_mfma_f32_32x32x16_bf16 v[16:31], v[208:211], v[200:203], 0
    v_mfma_f32_32x32x16_bf16 v[16:31], v[212:215], v[204:207], v[16:31]
    s_nop 11
    v_add_f32 v24, s77, v24
    v_rcp_f32 v24, v24
    s_nop 0
    v_pk_mul_f32 v[16:17], v[16:17], v[24:25] op_sel_hi:[1,0]
    v_pk_mul_f32 v[18:19], v[18:19], v[24:25] op_sel_hi:[1,0]
    v_pk_mul_f32 v[20:21], v[20:21], v[24:25] op_sel_hi:[1,0]
    v_pk_mul_f32 v[22:23], v[22:23], v[24:25] op_sel_hi:[1,0]
    v_cvt_pk_bf16_f32 v200, v16, v17
    v_cvt_pk_bf16_f32 v201, v18, v19
    v_cvt_pk_bf16_f32 v202, v20, v21
    v_cvt_pk_bf16_f32 v203, v22, v23
    buffer_store_dwordx4 v[200:203], v2, s[20:23], s62 offen offset:1024 sc1
    s_mov_b32 s55, 16
op_e6:
    s_waitcnt vmcnt(13)
    v_mfma_f32_32x32x16_bf16 v[32:47], v[224:227], v[184:187], v[32:47]
    v_mfma_f32_32x32x16_bf16 v[48:63], v[224:227], v[188:191], v[48:63]
    v_mfma_f32_32x32x16_bf16 v[64:79], v[228:231], v[184:187], v[64:79]
    v_mfma_f32_32x32x16_bf16 v[80:95], v[228:231], v[188:191], v[80:95]
    buffer_load_dwordx4 v[184:187], v2, s[20:23], s70 offen offset:1024
    buffer_load_dwordx4 v[188:191], v2, s[20:23], s71 offen offset:1024
    s_waitcnt vmcnt(13)
    v_mfma_f32_32x32x16_bf16 v[32:47], v[232:235], v[136:139], v[32:47]
    v_mfma_f32_32x32x16_bf16 v[48:63], v[232:235], v[140:143], v[48:63]
    v_mfma_f32_32x32x16_bf16 v[64:79], v[236:239], v[136:139], v[64:79]
    v_mfma_f32_32x32x16_bf16 v[80:95], v[236:239], v[140:143], v[80:95]
    s_cmp_eq_u32 s55, 16
    s_cbranch_scc0 of_e6
    s_waitcnt vmcnt(2)
    v_mov_b32 v208, s100
    v_mov_b32 v209, s101
    s_mov_b64 exec, 1
    buffer_store_dwordx2 v[208:209], off, s[20:23], s54 offset:0 sc0 sc1
    s_mov_b64 exec, -1
    s_mov_b32 s55, 2
of_e6:
    s_cmp_eq_u32 s55, 0
    s_cbranch_scc0 op_e8
op_s8:
    ds_read_b32 v16, v252
    ds_read_b128 v[208:211], v255
    ds_read_b128 v[212:215], v255 offset:1024
    s_waitcnt lgkmcnt(2)
    v_readfirstlane_b32 s55, v16
    s_nop 0
    s_cmp_eq_u32 s55, 0
    s_cbranch_scc1 op_s8
    s_cmp_eq_u32 s55, 2
    s_cbranch_scc1 op_e8
    s_waitcnt lgkmcnt(0)
    v_mfma_f32_32x32x16_bf16 v[16:31], v[208:211], v[192:195], 0
    v_mfma_f32_32x32x16_bf16 v[16:31], v[212:215], v[196:199], v[16:31]
    s_nop 11
    v_add_f32 v24, s77, v24
    ds_read_b128 v[208:211], v255 offset:20480
    ds_read_b128 v[212:215], v255 offset:21504
    v_rcp_f32 v24, v24
    s_nop 0
    v_pk_mul_f32 v[16:17], v[16:17], v[24:25] op_sel_hi:[1,0]
    v_pk_mul_f32 v[18:19], v[18:19], v[24:25] op_sel_hi:[1,0]
    v_pk_mul_f32 v[20:21], v[20:21], v[24:25] op_sel_hi:[1,0]
    v_pk_mul_f32 v[22:23], v[22:23], v[24:25] op_sel_hi:[1,0]
    v_cvt_pk_bf16_f32 v192, v16, v17
    v_cvt_pk_bf16_f32 v193, v18, v19
    v_cvt_pk_bf16_f32 v194, v20, v21
    v_cvt_pk_bf16_f32 v195, v22, v23
    buffer_store_dwordx4 v[192:195], v2, s[20:23], s62 offen offset:0 sc1
    s_waitcnt lgkmcnt(0)
    v_mfma_f32_32x32x16_bf16 v[16:31], v[208:211], v[200:203], 0
    v_mfma_f32_32x32x16_bf16 v[16:31], v[212:215], v[204:207], v[16:31]
    s_nop 11
    v_add_f32 v24, s77, v24
    v_rcp_f32 v24, v24
    s_nop 0
    v_pk_mul_f32 v[16:17], v[16:17], v[24:25] op_sel_hi:[1,0]
    v_pk_mul_f32 v[18:19], v[18:19], v[24:25] op_sel_hi:[1,0]
    v_pk_mul_f32 v[20:21], v[20:21], v[24:25] op_sel_hi:[1,0]
    v_pk_mul_f32 v[22:23], v[22:23], v[24:25] op_sel_hi:[1,0]
    v_cvt_pk_bf16_f32 v200, v16, v17
    v_cvt_pk_bf16_f32 v201, v18, v19
    v_cvt_pk_bf16_f32 v202, v20, v21
    v_cvt_pk_bf16_f32 v203, v22, v23
    buffer_store_dwordx4 v[200:203], v2, s[20:23], s62 offen offset:1024 sc1
    s_mov_b32 s55, 18
op_e8:
    s_waitcnt vmcnt(4)
    v_cmp_eq_u64 vcc, s[100:101], v[248:249]
    s_nop 0
    s_and_b32 s52, vcc_lo, s75
    s_cmp_eq_u32 s52, s75
    s_cselect_b32 s3, s74, 0x40000000
    s_add_u32 s52, s3, 32768
    buffer_load_dwordx4 v[96:99], v2, s[20:23], s3 offen offset:0
    buffer_load_dwordx4 v[100:103], v2, s[20:23], s52 offen offset:0
    buffer_load_dwordx4 v[104:107], v2, s[20:23], s3 offen offset:1024
    buffer_load_dwordx4 v[108:111], v2, s[20:23], s52 offen offset:1024
    buffer_load_dwordx4 v[112:115], v2, s[20:23], s3 offen offset:2048
    buffer_load_dwordx4 v[116:119], v2, s[20:23], s52 offen offset:2048
    buffer_load_dwordx4 v[120:123], v2, s[20:23], s3 offen offset:3072
    buffer_load_dwordx4 v[124:127], v2, s[20:23], s52 offen offset:3072
    ds_read_b64_tr_b16 v[24:25], v5 offset:0
    ds_read_b64_tr_b16 v[26:27], v5 offset:1024
    ds_read_b64_tr_b16 v[28:29], v6 offset:0
    ds_read_b64_tr_b16 v[30:31], v6 offset:1024
    v_mfma_f32_32x32x16_bf16 v[32:47], v[240:243], v[144:147], v[32:47]
    v_mfma_f32_32x32x16_bf16 v[48:63], v[240:243], v[148:151], v[48:63]
    v_mfma_f32_32x32x16_bf16 v[64:79], v[244:247], v[144:147], v[64:79]
    v_mfma_f32_32x32x16_bf16 v[80:95], v[244:247], v[148:151], v[80:95]
    ds_read_b64_tr_b16 v[16:17], v5 offset:2048
    ds_read_b64_tr_b16 v[18:19], v5 offset:3072
    ds_read_b64_tr_b16 v[20:21], v6 offset:2048
    ds_read_b64_tr_b16 v[22:23], v6 offset:3072
    s_waitcnt lgkmcnt(4)
    v_mfma_f32_32x32x16_bf16 v[32:47], v[24:27], v[152:155], v[32:47]
    v_mfma_f32_32x32x16_bf16 v[48:63], v[24:27], v[156:159], v[48:63]
    v_mfma_f32_32x32x16_bf16 v[64:79], v[28:31], v[152:155], v[64:79]
    v_mfma_f32_32x32x16_bf16 v[80:95], v[28:31], v[156:159], v[80:95]
    s_cmp_eq_u32 s55, 18
    s_cbranch_scc0 of_e8
    s_waitcnt vmcnt(8)
    v_mov_b32 v208, s100
    v_mov_b32 v209, s101
    s_mov_b64 exec, 1
    buffer_store_dwordx2 v[208:209], off, s[20:23], s54 offset:0 sc0 sc1
    s_mov_b64 exec, -1
    s_mov_b32 s55, 2
of_e8:
    ds_read_b64_tr_b16 v[24:25], v5 offset:4096
    ds_read_b64_tr_b16 v[26:27], v5 offset:5120
    ds_read_b64_tr_b16 v[28:29], v6 offset:4096
    ds_read_b64_tr_b16 v[30:31], v6 offset:5120
    s_waitcnt lgkmcnt(4)
    v_mfma_f32_32x32x16_bf16 v[32:47], v[16:19], v[160:163], v[32:47]
    v_mfma_f32_32x32x16_bf16 v[48:63], v[16:19], v[164:167], v[48:63]
    v_mfma_f32_32x32x16_bf16 v[64:79], v[20:23], v[160:163], v[64:79]
    v_mfma_f32_32x32x16_bf16 v[80:95], v[20:23], v[164:167], v[80:95]
    ds_read_b64_tr_b16 v[16:17], v5 offset:6144
    ds_read_b64_tr_b16 v[18:19], v5 offset:7168
    ds_read_b64_tr_b16 v[20:21], v6 offset:6144
    ds_read_b64_tr_b16 v[22:23], v6 offset:7168
    s_waitcnt lgkmcnt(4)
    v_mfma_f32_32x32x16_bf16 v[32:47], v[24:27], v[168:171], v[32:47]
    v_mfma_f32_32x32x16_bf16 v[48:63], v[24:27], v[172:175], v[48:63]
    v_mfma_f32_32x32x16_bf16 v[64:79], v[28:31], v[168:171], v[64:79]
    v_mfma_f32_32x32x16_bf16 v[80:95], v[28:31], v[172:175], v[80:95]
    ds_read_b64_tr_b16 v[24:25], v5 offset:8192
    ds_read_b64_tr_b16 v[26:27], v5 offset:9216
    ds_read_b64_tr_b16 v[28:29], v6 offset:8192
    ds_read_b64_tr_b16 v[30:31], v6 offset:9216
    s_waitcnt lgkmcnt(4)
    s_waitcnt vmcnt(10)
    v_mfma_f32_32x32x16_bf16 v[32:47], v[16:19], v[176:179], v[32:47]
    v_mfma_f32_32x32x16_bf16 v[48:63], v[16:19], v[180:183], v[48:63]
    v_mfma_f32_32x32x16_bf16 v[64:79], v[20:23], v[176:179], v[64:79]
    v_mfma_f32_32x32x16_bf16 v[80:95], v[20:23], v[180:183], v[80:95]
    ds_read_b64_tr_b16 v[16:17], v5 offset:10240
    ds_read_b64_tr_b16 v[18:19], v5 offset:11264
    ds_read_b64_tr_b16 v[20:21], v6 offset:10240
    ds_read_b64_tr_b16 v[22:23], v6 offset:11264
    s_waitcnt lgkmcnt(4)
    s_waitcnt vmcnt(8)
    v_mfma_f32_32x32x16_bf16 v[32:47], v[24:27], v[184:187], v[32:47]
    v_mfma_f32_32x32x16_bf16 v[48:63], v[24:27], v[188:191], v[48:63]
    v_mfma_f32_32x32x16_bf16 v[64:79], v[28:31], v[184:187], v[64:79]
    v_mfma_f32_32x32x16_bf16 v[80:95], v[28:31], v[188:191], v[80:95]
    s_cmp_eq_u32 s3, s74
    s_cbranch_scc0 p2_kvslow
p2_kvok:
    ds_read_b64_tr_b16 v[24:25], v5 offset:12288
    ds_read_b64_tr_b16 v[26:27], v5 offset:13312
    ds_read_b64_tr_b16 v[28:29], v6 offset:12288
    ds_read_b64_tr_b16 v[30:31], v6 offset:13312
    s_waitcnt lgkmcnt(4)
    s_waitcnt vmcnt(6)
    v_mfma_f32_32x32x16_bf16 v[32:47], v[16:19], v[96:99], v[32:47]
    v_mfma_f32_32x32x16_bf16 v[48:63], v[16:19], v[100:103], v[48:63]
    v_mfma_f32_32x32x16_bf16 v[64:79], v[20:23], v[96:99], v[64:79]
    v_mfma_f32_32x32x16_bf16 v[80:95], v[20:23], v[100:103], v[80:95]
    ds_read_b64_tr_b16 v[16:17], v5 offset:14336
    ds_read_b64_tr_b16 v[18:19], v5 offset:15360
    ds_read_b64_tr_b16 v[20:21], v6 offset:14336
    ds_read_b64_tr_b16 v[22:23], v6 offset:15360
    s_waitcnt lgkmcnt(4)
    s_waitcnt vmcnt(4)
    v_mfma_f32_32x32x16_bf16 v[32:47], v[24:27], v[104:107], v[32:47]
    v_mfma_f32_32x32x16_bf16 v[48:63], v[24:27], v[108:111], v[48:63]
    v_mfma_f32_32x32x16_bf16 v[64:79], v[28:31], v[104:107], v[64:79]
    v_mfma_f32_32x32x16_bf16 v[80:95], v[28:31], v[108:111], v[80:95]
    ds_read_b64_tr_b16 v[24:25], v5 offset:16384
    ds_read_b64_tr_b16 v[26:27], v5 offset:17408
    ds_read_b64_tr_b16 v[28:29], v6 offset:16384
    ds_read_b64_tr_b16 v[30:31], v6 offset:17408
    s_waitcnt lgkmcnt(4)
    s_waitcnt vmcnt(2)
    v_mfma_f32_32x32x16_bf16 v[32:47], v[16:19], v[112:115], v[32:47]
    v_mfma_f32_32x32x16_bf16 v[48:63], v[16:19], v[116:119], v[48:63]
    v_mfma_f32_32x32x16_bf16 v[64:79], v[20:23], v[112:115], v[64:79]
    v_mfma_f32_32x32x16_bf16 v[80:95], v[20:23], v[116:119], v[80:95]
    s_waitcnt lgkmcnt(0)
    s_waitcnt vmcnt(0)
    v_mfma_f32_32x32x16_bf16 v[32:47], v[24:27], v[120:123], v[32:47]
    v_mfma_f32_32x32x16_bf16 v[48:63], v[24:27], v[124:127], v[48:63]
    v_mfma_f32_32x32x16_bf16 v[64:79], v[28:31], v[120:123], v[64:79]
    v_mfma_f32_32x32x16_bf16 v[80:95], v[28:31], v[124:127], v[80:95]
    v_and_b32 v12, 31, v1
    v_mul_u32_u24 v12, 272, v12
    v_lshrrev_b32 v13, 5, v1
    v_lshl_add_u32 v12, v13, 4, v12
    v_add_u32 v12, s72, v12
    s_nop 3
    ds_write_b128 v12, v[32:35] offset:0
    ds_write_b128 v12, v[36:39] offset:32
    ds_write_b128 v12, v[40:43] offset:64
    ds_write_b128 v12, v[44:47] offset:96
    ds_write_b128 v12, v[48:51] offset:8704
    ds_write_b128 v12, v[52:55] offset:8736
    ds_write_b128 v12, v[56:59] offset:8768
    ds_write_b128 v12, v[60:63] offset:8800
    ds_write_b128 v12, v[64:67] offset:128
    ds_write_b128 v12, v[68:71] offset:160
    ds_write_b128 v12, v[72:75] offset:192
    ds_write_b128 v12, v[76:79] offset:224
    ds_write_b128 v12, v[80:83] offset:8832
    ds_write_b128 v12, v[84:87] offset:8864
    ds_write_b128 v12, v[88:91] offset:8896
    ds_write_b128 v12, v[92:95] offset:8928
p2_final:
    v_lshrrev_b32 v13, 3, v0
    v_mul_u32_u24 v13, 272, v13
    v_and_b32 v14, 7, v0
    v_lshl_add_u32 v13, v14, 5, v13
    v_add_u32 v14, 61440, v13
    v_add_u32 v15, 122880, v13
    s_waitcnt lgkmcnt(0)
    s_barrier
    ds_read_b32 v248, v252 offset:4
    ds_read_b128 v[136:139], v13 offset:0
    ds_read_b128 v[140:143], v13 offset:16
    ds_read_b128 v[144:147], v13 offset:20480
    ds_read_b128 v[148:151], v13 offset:20496
    ds_read_b128 v[152:155], v13 offset:40960
    ds_read_b128 v[156:159], v13 offset:40976
    ds_read_b128 v[160:163], v14 offset:0
    ds_read_b128 v[164:167], v14 offset:16
    ds_read_b128 v[168:171], v14 offset:20480
    ds_read_b128 v[172:175], v14 offset:20496
    ds_read_b128 v[176:179], v14 offset:40960
    ds_read_b128 v[180:183], v14 offset:40976
    ds_read_b128 v[184:187], v15 offset:0
    ds_read_b128 v[188:191], v15 offset:16
    ds_read_b128 v[192:195], v15 offset:20480
    ds_read_b128 v[196:199], v15 offset:20496
    v_lshlrev_b32 v96, 16, v8
    v_and_b32 v97, 0xffff0000, v8
    v_lshlrev_b32 v98, 16, v9
    v_and_b32 v99, 0xffff0000, v9
    v_lshlrev_b32 v100, 16, v10
    v_and_b32 v101, 0xffff0000, v10
    v_lshlrev_b32 v102, 16, v11
    v_and_b32 v103, 0xffff0000, v11
    s_waitcnt lgkmcnt(14)
    v_pk_add_f32 v[96:97], v[96:97], v[136:137]
    v_pk_add_f32 v[98:99], v[98:99], v[138:139]
    v_pk_add_f32 v[100:101], v[100:101], v[140:141]
    v_pk_add_f32 v[102:103], v[102:103], v[142:143]
    s_waitcnt lgkmcnt(12)
    v_pk_add_f32 v[96:97], v[96:97], v[144:145]
    v_pk_add_f32 v[98:99], v[98:99], v[146:147]
    v_pk_add_f32 v[100:101], v[100:101], v[148:149]
    v_pk_add_f32 v[102:103], v[102:103], v[150:151]
    s_waitcnt lgkmcnt(10)
    v_pk_add_f32 v[96:97], v[96:97], v[152:153]
    v_pk_add_f32 v[98:99], v[98:99], v[154:155]
    v_pk_add_f32 v[100:101], v[100:101], v[156:157]
    v_pk_add_f32 v[102:103], v[102:103], v[158:159]
    s_waitcnt lgkmcnt(8)
    v_pk_add_f32 v[96:97], v[96:97], v[160:161]
    v_pk_add_f32 v[98:99], v[98:99], v[162:163]
    v_pk_add_f32 v[100:101], v[100:101], v[164:165]
    v_pk_add_f32 v[102:103], v[102:103], v[166:167]
    s_waitcnt lgkmcnt(6)
    v_pk_add_f32 v[96:97], v[96:97], v[168:169]
    v_pk_add_f32 v[98:99], v[98:99], v[170:171]
    v_pk_add_f32 v[100:101], v[100:101], v[172:173]
    v_pk_add_f32 v[102:103], v[102:103], v[174:175]
    s_waitcnt lgkmcnt(4)
    v_pk_add_f32 v[96:97], v[96:97], v[176:177]
    v_pk_add_f32 v[98:99], v[98:99], v[178:179]
    v_pk_add_f32 v[100:101], v[100:101], v[180:181]
    v_pk_add_f32 v[102:103], v[102:103], v[182:183]
    s_waitcnt lgkmcnt(2)
    v_pk_add_f32 v[96:97], v[96:97], v[184:185]
    v_pk_add_f32 v[98:99], v[98:99], v[186:187]
    v_pk_add_f32 v[100:101], v[100:101], v[188:189]
    v_pk_add_f32 v[102:103], v[102:103], v[190:191]
    s_waitcnt lgkmcnt(0)
    v_pk_add_f32 v[96:97], v[96:97], v[192:193]
    v_pk_add_f32 v[98:99], v[98:99], v[194:195]
    v_pk_add_f32 v[100:101], v[100:101], v[196:197]
    v_pk_add_f32 v[102:103], v[102:103], v[198:199]
    v_readfirstlane_b32 s52, v248
    v_cvt_pk_bf16_f32 v128, v96, v97
    v_cvt_pk_bf16_f32 v129, v98, v99
    v_cvt_pk_bf16_f32 v130, v100, v101
    v_cvt_pk_bf16_f32 v131, v102, v103
    s_cmp_eq_u32 s52, 0
    s_cbranch_scc0 safe
    buffer_store_dwordx4 v[128:131], v7, s[36:39], 0 offen
k_dump:
k_end:
    s_endpgm
p2_early:
    s_sleep 8
    s_memrealtime s[4:5]
    s_waitcnt lgkmcnt(0)
    s_sub_u32 s52, s100, s4
    s_add_u32 s52, s52, 100
    s_cmp_lt_u32 s52, 800
    s_cbranch_scc1 p2_early
    s_branch p2_late
p2_kvslow:
    s_memrealtime s[4:5]
p2_kvpoll:
    s_mov_b64 exec, 0xff
    buffer_load_dwordx2 v[248:249], v253, s[20:23], s78 offen sc0 sc1
    s_mov_b64 exec, -1
    s_waitcnt vmcnt(0)
    v_cmp_eq_u64 vcc, s[100:101], v[248:249]
    s_nop 0
    s_and_b32 s52, vcc_lo, s75
    s_cmp_eq_u32 s52, s75
    s_cbranch_scc1 p2_kvgot
    s_memrealtime s[6:7]
    s_waitcnt lgkmcnt(0)
    s_sub_u32 s52, s6, s4
    s_cmp_gt_u32 s52, 200000
    s_cbranch_scc1 p2_kvabort
    s_sleep 2
    s_branch p2_kvpoll
p2_kvgot:
    s_mov_b32 s3, s74
    s_add_u32 s52, s3, 32768
    buffer_load_dwordx4 v[96:99], v2, s[20:23], s3 offen offset:0
    buffer_load_dwordx4 v[100:103], v2, s[20:23], s52 offen offset:0
    buffer_load_dwordx4 v[104:107], v2, s[20:23], s3 offen offset:1024
    buffer_load_dwordx4 v[108:111], v2, s[20:23], s52 offen offset:1024
    buffer_load_dwordx4 v[112:115], v2, s[20:23], s3 offen offset:2048
    buffer_load_dwordx4 v[116:119], v2, s[20:23], s52 offen offset:2048
    buffer_load_dwordx4 v[120:123], v2, s[20:23], s3 offen offset:3072
    buffer_load_dwordx4 v[124:127], v2, s[20:23], s52 offen offset:3072
    s_waitcnt vmcnt(0)
    s_branch p2_kvok
p2_kvabort:
    s_setprio 0
    v_mov_b32 v248, 1
    ds_write_b32 v252, v248 offset:4
    s_branch p2_final
safe:
    s_mov_b32 s3, 0
    s_waitcnt vmcnt(0) lgkmcnt(0)
    s_barrier
    s_cmp_eq_u32 s44, 0
    s_cbranch_scc0 safe_b
    s_mov_b32 s54, -1
    v_lshlrev_b32 v2, 3, v1
    v_lshlrev_b32 v3, 7, v1
    s_mov_b32 s66, 15220736
    buffer_load_dwordx2 v[8:9], v2, s[20:23], s66 offen sc0 sc1
    s_add_u32 s66, s66, 4096
    buffer_load_dwordx2 v[10:11], v2, s[20:23], s66 offen sc0 sc1
    s_add_u32 s66, s66, 4096
    buffer_load_dwordx2 v[12:13], v2, s[20:23], s66 offen sc0 sc1
    s_add_u32 s66, s66, 4096
    buffer_load_dwordx2 v[14:15], v2, s[20:23], s66 offen sc0 sc1
    s_add_u32 s66, s66, 4096
    buffer_load_dwordx2 v[16:17], v2, s[20:23], s66 offen sc0 sc1
    s_add_u32 s66, s66, 4096
    buffer_load_dwordx2 v[18:19], v2, s[20:23], s66 offen sc0 sc1
    s_add_u32 s66, s66, 4096
    buffer_load_dwordx2 v[20:21], v2, s[20:23], s66 offen sc0 sc1
    s_add_u32 s66, s66, 4096
    buffer_load_dwordx2 v[22:23], v2, s[20:23], s66 offen sc0 sc1
    s_add_u32 s66, s66, 4096
    s_mov_b32 s66, 15204352
    buffer_load_dwordx4 v[24:27], v3, s[20:23], s66 offen offset:0 sc0 sc1
    buffer_load_dwordx4 v[28:31], v3, s[20:23], s66 offen offset:16 sc0 sc1
    buffer_load_dwordx4 v[32:35], v3, s[20:23], s66 offen offset:32 sc0 sc1
    buffer_load_dwordx4 v[36:39], v3, s[20:23], s66 offen offset:48 sc0 sc1
    buffer_load_dwordx2 v[40:41], v3, s[20:23], s66 offen offset:64 sc0 sc1
    s_add_u32 s66, s66, 8192
    buffer_load_dwordx4 v[44:47], v3, s[20:23], s66 offen offset:0 sc0 sc1
    buffer_load_dwordx4 v[48:51], v3, s[20:23], s66 offen offset:16 sc0 sc1
    buffer_load_dwordx4 v[52:55], v3, s[20:23], s66 offen offset:32 sc0 sc1
    buffer_load_dwordx4 v[56:59], v3, s[20:23], s66 offen offset:48 sc0 sc1
    buffer_load_dwordx2 v[60:61], v3, s[20:23], s66 offen offset:64 sc0 sc1
    s_add_u32 s66, s66, 8192
    s_waitcnt vmcnt(0)
    v_cmp_ne_u64 vcc, s[100:101], v[24:25]
    v_cmp_ne_u64 s[4:5], s[100:101], v[26:27]
    s_nop 0
    s_or_b64 vcc, vcc, s[4:5]
    v_cmp_ne_u64 s[4:5], s[100:101], v[28:29]
    s_nop 0
    s_or_b64 vcc, vcc, s[4:5]
    v_cmp_ne_u64 s[4:5], s[100:101], v[30:31]
    s_nop 0
    s_or_b64 vcc, vcc, s[4:5]
    v_cmp_ne_u64 s[4:5], s[100:101], v[32:33]
    s_nop 0
    s_or_b64 vcc, vcc, s[4:5]
    v_cmp_ne_u64 s[4:5], s[100:101], v[34:35]
    s_nop 0
    s_or_b64 vcc, vcc, s[4:5]
    v_cmp_ne_u64 s[4:5], s[100:101], v[36:37]
    s_nop 0
    s_or_b64 vcc, vcc, s[4:5]
    v_cmp_ne_u64 s[4:5], s[100:101], v[38:39]
    s_nop 0
    s_or_b64 vcc, vcc, s[4:5]
    s_ff1_i32_b64 s52, vcc
    s_cmp_lt_i32 s52, 0
    s_cbranch_scc1 safe_f00
    s_lshr_b32 s53, s52, 3
    s_add_u32 s53, s53, 0
    s_lshl_b32 s54, s53, 8
    s_or_b32 s54, s54, 0
    s_and_b32 s53, s52, 7
    s_or_b32 s54, s54, s53
safe_f00:
    v_cmp_ne_u64 vcc, s[100:101], v[40:41]
    s_nop 0
    s_ff1_i32_b64 s52, vcc
    s_cmp_lt_i32 s52, 0
    s_cbranch_scc1 safe_f01
    s_lshr_b32 s53, s52, 3
    s_add_u32 s53, s53, 0
    s_lshl_b32 s54, s53, 8
    s_or_b32 s54, s54, 16
    s_and_b32 s53, s52, 7
    s_or_b32 s54, s54, s53
safe_f01:
    v_cmp_ne_u64 vcc, s[100:101], v[44:45]
    v_cmp_ne_u64 s[4:5], s[100:101], v[46:47]
    s_nop 0
    s_or_b64 vcc, vcc, s[4:5]
    v_cmp_ne_u64 s[4:5], s[100:101], v[48:49]
    s_nop 0
    s_or_b64 vcc, vcc, s[4:5]
    v_cmp_ne_u64 s[4:5], s[100:101], v[50:51]
    s_nop 0
    s_or_b64 vcc, vcc, s[4:5]
    v_cmp_ne_u64 s[4:5], s[100:101], v[52:53]
    s_nop 0
    s_or_b64 vcc, vcc, s[4:5]
    v_cmp_ne_u64 s[4:5], s[100:101], v[54:55]
    s_nop 0
    s_or_b64 vcc, vcc, s[4:5]
    v_cmp_ne_u64 s[4:5], s[100:101], v[56:57]
    s_nop 0
    s_or_b64 vcc, vcc, s[4:5]
    v_cmp_ne_u64 s[4:5], s[100:101], v[58:59]
    s_nop 0
    s_or_b64 vcc, vcc, s[4:5]
    s_ff1_i32_b64 s52, vcc
    s_cmp_lt_i32 s52, 0
    s_cbranch_scc1 safe_f10
    s_lshr_b32 s53, s52, 3
    s_add_u32 s53, s53, 8
    s_lshl_b32 s54, s53, 8
    s_or_b32 s54, s54, 0
    s_and_b32 s53, s52, 7
    s_or_b32 s54, s54, s53
safe_f10:
    v_cmp_ne_u64 vcc, s[100:101], v[60:61]
    s_nop 0
    s_ff1_i32_b64 s52, vcc
    s_cmp_lt_i32 s52, 0
    s_cbranch_scc1 safe_f11
    s_lshr_b32 s53, s52, 3
    s_add_u32 s53, s53, 8
    s_lshl_b32 s54, s53, 8
    s_or_b32 s54, s54, 16
    s_and_b32 s53, s52, 7
    s_or_b32 s54, s54, s53
safe_f11:
    v_cmp_ne_u64 vcc, s[100:101], v[8:9]
    s_nop 0
    s_ff1_i32_b64 s52, vcc
    s_cmp_lt_i32 s52, 0
    s_cbranch_scc1 safe_m0
    s_lshr_b32 s52, s52, 2
    s_lshl_b32 s54, s52, 8
    s_or_b32 s54, s54, 0
safe_m0:
    v_cmp_ne_u64 vcc, s[100:101], v[10:11]
    s_nop 0
    s_ff1_i32_b64 s52, vcc
    s_cmp_lt_i32 s52, 0
    s_cbranch_scc1 safe_m1
    s_lshr_b32 s52, s52, 2
    s_lshl_b32 s54, s52, 8
    s_or_b32 s54, s54, 1
safe_m1:
    v_cmp_ne_u64 vcc, s[100:101], v[12:13]
    s_nop 0
    s_ff1_i32_b64 s52, vcc
    s_cmp_lt_i32 s52, 0
    s_cbranch_scc1 safe_m2
    s_lshr_b32 s52, s52, 2
    s_lshl_b32 s54, s52, 8
    s_or_b32 s54, s54, 2
safe_m2:
    v_cmp_ne_u64 vcc, s[100:101], v[14:15]
    s_nop 0
    s_ff1_i32_b64 s52, vcc
    s_cmp_lt_i32 s52, 0
    s_cbranch_scc1 safe_m3
    s_lshr_b32 s52, s52, 2
    s_lshl_b32 s54, s52, 8
    s_or_b32 s54, s54, 3
safe_m3:
    v_cmp_ne_u64 vcc, s[100:101], v[16:17]
    s_nop 0
    s_ff1_i32_b64 s52, vcc
    s_cmp_lt_i32 s52, 0
    s_cbranch_scc1 safe_m4
    s_lshr_b32 s52, s52, 2
    s_lshl_b32 s54, s52, 8
    s_or_b32 s54, s54, 4
safe_m4:
    v_cmp_ne_u64 vcc, s[100:101], v[18:19]
    s_nop 0
    s_ff1_i32_b64 s52, vcc
    s_cmp_lt_i32 s52, 0
    s_cbranch_scc1 safe_m5
    s_lshr_b32 s52, s52, 2
    s_lshl_b32 s54, s52, 8
    s_or_b32 s54, s54, 5
safe_m5:
    v_cmp_ne_u64 vcc, s[100:101], v[20:21]
    s_nop 0
    s_ff1_i32_b64 s52, vcc
    s_cmp_lt_i32 s52, 0
    s_cbranch_scc1 safe_m6
    s_lshr_b32 s52, s52, 2
    s_lshl_b32 s54, s52, 8
    s_or_b32 s54, s54, 6
safe_m6:
    v_cmp_ne_u64 vcc, s[100:101], v[22:23]
    s_nop 0
    s_ff1_i32_b64 s52, vcc
    s_cmp_lt_i32 s52, 0
    s_cbranch_scc1 safe_m7
    s_lshr_b32 s52, s52, 2
    s_lshl_b32 s54, s52, 8
    s_or_b32 s54, s54, 7
safe_m7:
    v_mov_b32 v2, 161792
    v_mov_b32 v4, 0
    v_mov_b32 v5, 0
    v_mov_b32 v6, s54
    ds_write_b96 v2, v[4:6]
    s_waitcnt lgkmcnt(0)
safe_b:
    s_barrier
    v_mov_b32 v2, 161792
    ds_read_b32 v3, v2 offset:8
    s_waitcnt lgkmcnt(0)
    v_readfirstlane_b32 s54, v3
    s_mov_b32 s67, 2
    s_cmp_lt_i32 s54, 0
    s_cbranch_scc1 p2_entry
    s_mov_b32 s67, 1
    s_lshr_b32 s47, s54, 8
    s_bfe_u32 s49, s54, 0x10004
    s_and_b32 s48, s54, 7
    s_branch p1_start
k_code_end:
.section .rodata,"a"
.p2align 6
.amdhsa_kernel parallel_sum__linear_kernel_hedgehog__dense_activation_silu__prompt_kernel
  .amdhsa_next_free_vgpr 256
  .amdhsa_next_free_sgpr 102
  .amdhsa_accum_offset 256
  .amdhsa_group_segment_fixed_size 0
  .amdhsa_kernarg_size 80
  .amdhsa_user_sgpr_count 2
  .amdhsa_user_sgpr_kernarg_segment_ptr 1
  .amdhsa_system_sgpr_workgroup_id_x 1
.end_amdhsa_kernel
```
